```python
import torch

def _softmax(x, axis=-1):
    return torch.softmax(x, dim=axis)

def _gelu(x):
    return torch.nn.functional.gelu(x, approximate='tanh')

def _silu(x):
    return torch.nn.functional.silu(x)

def _sigmoid(x):
    return torch.sigmoid(x)

def _layernorm(x, axis=-1, eps=1e-05):
    m = x.mean(dim=axis, keepdim=True)
    v = x.var(dim=axis, keepdim=True, unbiased=False)
    return (x - m) / torch.sqrt(v + eps)

def _scatter_add(tgt, idx, src, axis=0):
    return tgt.clone().index_add_(axis, idx, src)

def _segment_sum(src, seg, n):
    out = torch.zeros((n,) + src.shape[1:], dtype=src.dtype)
    return out.index_add_(0, seg, src)

def _pad(x, pw):
    flat = tuple((v for pair in reversed(pw) for v in pair))
    return torch.nn.functional.pad(x, flat)
kernel_name = 'gated_mix__memory_aug_recurrent_mem_tr__glu_gated_bilinear__prompt'

def setup_inputs():

    _w = lambda a: (lambda t: t.to(torch.bfloat16) if t.is_floating_point() else t)(torch.as_tensor(a))

    def _A_setup():
        B, S, Dm = (1, 2048, 576)
        H, Dh = (32, 128)
        M, seg = (8, 32)
        seg = min(seg, S)
        S = S // seg * seg
        return {'x': _w((lambda *s: torch.randn(*s, dtype=torch.bfloat16) * 0.05)(B, S, Dm)), 'mem0': _w((lambda *s: torch.randn(*s, dtype=torch.bfloat16) * 0.4)(B, M, Dm)), 'Wq': _w((lambda *s: torch.randn(*s, dtype=torch.bfloat16) * 6.4)(Dm, H, Dh) * Dm ** (-0.5)), 'Wk': _w((lambda *s: torch.randn(*s, dtype=torch.bfloat16) * 6.4)(Dm, H, Dh) * Dm ** (-0.5)), 'Wv': _w((lambda *s: torch.randn(*s, dtype=torch.bfloat16) * 0.4)(Dm, H, Dh) * Dm ** (-0.5)), 'Wo': _w((lambda *s: torch.randn(*s, dtype=torch.bfloat16) * 0.4)(H, Dh, Dm) * (H * Dh) ** (-0.5)), 'seg_len': seg}
    _A_in = _A_setup()

    def _B_setup():
        B, S, D, F = (1, 2048, 576, 4608)
        return {'x': _w((lambda *s: torch.randn(*s, dtype=torch.bfloat16) * 0.05)(B, S, D)), 'w_gate': _w((lambda *s: torch.randn(*s, dtype=torch.bfloat16) * 1.6)(D, F) * D ** (-0.5)), 'w_up': _w((lambda *s: torch.randn(*s, dtype=torch.bfloat16) * 1.6)(D, F) * D ** (-0.5)), 'w_down': _w((lambda *s: torch.randn(*s, dtype=torch.bfloat16) * 1.6)(F, D) * F ** (-0.5))}
    _B_in = _B_setup()
    return {'A_x': _A_in['x'], 'A_mem0': _A_in['mem0'], 'A_Wq': _A_in['Wq'], 'A_Wk': _A_in['Wk'], 'A_Wv': _A_in['Wv'], 'A_Wo': _A_in['Wo'], 'A_seg_len': _A_in['seg_len'], 'B_x': _B_in['x'], 'B_w_gate': _B_in['w_gate'], 'B_w_up': _B_in['w_up'], 'B_w_down': _B_in['w_down'], 'gate_w': _w((lambda *s: torch.randn(*s, dtype=torch.bfloat16) * 0.05)(576) * 16.0)}

def reference(A_x, A_mem0, A_Wq, A_Wk, A_Wv, A_Wo, A_seg_len, B_x, B_w_gate, B_w_up, B_w_down, gate_w):

    def _A_ref(x, mem0, Wq, Wk, Wv, Wo, seg_len):
        B, S, Dm = x.shape
        H, Dh = (Wq.shape[1], Wq.shape[2])
        M = mem0.shape[1]
        scale = Dh ** (-0.5)
        n_seg = S // seg_len
        L = M + seg_len
        idx = torch.arange(L)
        mask = (idx[:, None] < M) | (idx[:, None] >= idx[None, :])
        mem = mem0
        outs = []
        for s in range(n_seg):
            xs = x[:, s * seg_len:(s + 1) * seg_len, :].clone()
            h = torch.concatenate([mem, xs], axis=1)
            q = torch.einsum('btd,dhe->bhte', h, Wq)
            k = torch.einsum('btd,dhe->bhte', h, Wk)
            v = torch.einsum('btd,dhe->bhte', h, Wv)
            scores = torch.einsum('bhqe,bhke->bhqk', q, k) * scale
            scores = torch.where(mask[None, None], scores, -1000000000.0)
            p = _softmax(scores, axis=-1)
            o = torch.einsum('bhqk,bhke->bhqe', p, v)
            o = torch.einsum('bhte,hed->btd', o, Wo)
            mem = o[:, :M, :].clone()
            outs.append(o[:, M:, :])
        return torch.concatenate(outs, axis=1)

    def _B_ref(x, w_gate, w_up, w_down):
        g = torch.einsum('bsd,df->bsf', x, w_gate)
        u = torch.einsum('bsd,df->bsf', x, w_up)
        h = g * u
        return torch.einsum('bsf,fd->bsd', h, w_down)
    x = A_x
    g = _sigmoid((x * gate_w).sum(-1, keepdims=True))
    a = _A_ref(x, A_mem0, A_Wq, A_Wk, A_Wv, A_Wo, A_seg_len)
    b = _B_ref(x, B_w_gate, B_w_up, B_w_down)
    return g * a + (1 - g) * b
```

```asm
; @launch grid=(256,1,1) block=(256,1,1) lds=163840
.amdgcn_target "amdgcn-amd-amdhsa--gfx950"
.text
.globl gated_mix__memory_aug_recurrent_mem_tr__glu_gated_bilinear__prompt_kernel
.p2align 8
.type gated_mix__memory_aug_recurrent_mem_tr__glu_gated_bilinear__prompt_kernel,@function
gated_mix__memory_aug_recurrent_mem_tr__glu_gated_bilinear__prompt_kernel:
  s_cmp_ge_u32 s2, 256
  s_cbranch_scc1 L_exit
  s_load_dwordx2 s[4:5], s[0:1], 112
  s_load_dwordx2 s[6:7], s[0:1], 104
  s_getreg_b32 s3, hwreg(HW_REG_XCC_ID)
  s_and_b32 s3, s3, 15
  s_getpc_b64 s[12:13]
        L_pc:
  s_mov_b32 s14, L_code_end-L_pc
  s_and_b32 s13, s13, 0xffff
  s_mov_b32 s15, 0x20000
  v_readfirstlane_b32 s20, v0
  v_subrev_u32 v16, 64, v0
  v_lshlrev_b32 v16, 7, v16
  s_cmp_lt_u32 s20, 64
  s_cbranch_scc1 L_nopf
  buffer_load_dword v250, v16, s[12:15], 0 offen
  v_add_u32 v16, 0x6000, v16
  buffer_load_dword v251, v16, s[12:15], 0 offen
  v_add_u32 v16, 0x6000, v16
  buffer_load_dword v252, v16, s[12:15], 0 offen
  v_add_u32 v16, 0x6000, v16
  buffer_load_dword v253, v16, s[12:15], 0 offen
  v_add_u32 v16, 0x6000, v16
L_nopf:
  s_xor_b32 s3, s3, 0
  s_waitcnt lgkmcnt(0)
  s_mov_b32 s8, s4
  s_and_b32 s9, s5, 0xffff
  s_mov_b32 s10, 268435456
  s_mov_b32 s11, 0x20000
  s_mov_b32 s16, s6
  s_and_b32 s17, s7, 0xffff
  s_mov_b32 s18, 256
  s_mov_b32 s19, 0x20000
  v_readfirstlane_b32 s100, v0
  s_lshr_b32 s22, s2, 3
  s_lshl_b32 s24, s3, 5
  s_add_u32 s24, s24, s22
  s_lshl_b32 s92, s3, 2
  s_lshl_b32 s93, 1, s22
  s_cmp_lt_u32 s3, 8
  s_cbranch_scc1 L_role_done
    L_conflict:
  s_waitcnt vmcnt(0) lgkmcnt(0)
  s_barrier
  v_mbcnt_lo_u32_b32 v0, -1, 0
  v_mbcnt_hi_u32_b32 v0, -1, v0
  v_add_u32 v0, s100, v0
  s_mov_b32 s93, 0
  s_mov_b32 s92, 0
  v_lshrrev_b32 v16, 6, v0
  s_nop 0
  v_readfirstlane_b32 s20, v16
  s_nop 0
  s_cmp_lg_u32 s20, 0
  s_cbranch_scc1 L_role_wait
  s_min_u32 s21, s3, 8
  s_lshl_b32 s22, s21, 2
  v_mov_b32 v16, 1
  s_mov_b64 exec, 1
  buffer_atomic_add v16, off, s[16:19], s22 offset:128 sc0
  s_waitcnt vmcnt(0)
  v_readfirstlane_b32 s23, v16
  s_mov_b32 s27, 0
    L_role_poll:
  s_add_u32 s27, s27, 1
  s_cmp_gt_u32 s27, 0x20000
  s_cbranch_scc1 L_abort
  buffer_load_dwordx4 v[20:23], off, s[16:19], 0 offset:0 sc1
  buffer_load_dwordx4 v[24:27], off, s[16:19], 0 offset:16 sc1
  buffer_load_dwordx4 v[28:31], off, s[16:19], 0 offset:128 sc1
  buffer_load_dwordx4 v[32:35], off, s[16:19], 0 offset:144 sc1
  buffer_load_dword v36, off, s[16:19], 0 offset:160 sc1
  s_waitcnt vmcnt(0)
  v_bcnt_u32_b32 v36, v20, v36
  v_add_u32 v36, v36, v28
  v_bcnt_u32_b32 v36, v21, v36
  v_add_u32 v36, v36, v29
  v_bcnt_u32_b32 v36, v22, v36
  v_add_u32 v36, v36, v30
  v_bcnt_u32_b32 v36, v23, v36
  v_add_u32 v36, v36, v31
  v_bcnt_u32_b32 v36, v24, v36
  v_add_u32 v36, v36, v32
  v_bcnt_u32_b32 v36, v25, v36
  v_add_u32 v36, v36, v33
  v_bcnt_u32_b32 v36, v26, v36
  v_add_u32 v36, v36, v34
  v_bcnt_u32_b32 v36, v27, v36
  v_add_u32 v36, v36, v35
  s_nop 0
  v_readfirstlane_b32 s26, v36
  s_nop 0
  s_cmp_lt_u32 s26, 256
  s_cbranch_scc1 L_role_poll
  s_mov_b32 s24, 8
  v_readfirstlane_b32 s26, v20
  s_nop 0
  s_bcnt0_i32_b32 s28, s26
  s_cmp_eq_u32 s21, 0
  s_cselect_b32 s28, s28, 0
  s_cmp_lt_u32 s23, s28
  s_cselect_b32 s24, 0, s24
  s_cselect_b32 s29, s26, s29
  v_readfirstlane_b32 s26, v21
  s_nop 0
  s_bcnt0_i32_b32 s28, s26
  s_cmp_eq_u32 s21, 1
  s_cselect_b32 s28, s28, 0
  s_cmp_lt_u32 s23, s28
  s_cselect_b32 s24, 1, s24
  s_cselect_b32 s29, s26, s29
  v_readfirstlane_b32 s26, v22
  s_nop 0
  s_bcnt0_i32_b32 s28, s26
  s_cmp_eq_u32 s21, 2
  s_cselect_b32 s28, s28, 0
  s_cmp_lt_u32 s23, s28
  s_cselect_b32 s24, 2, s24
  s_cselect_b32 s29, s26, s29
  v_readfirstlane_b32 s26, v23
  s_nop 0
  s_bcnt0_i32_b32 s28, s26
  s_cmp_eq_u32 s21, 3
  s_cselect_b32 s28, s28, 0
  s_cmp_lt_u32 s23, s28
  s_cselect_b32 s24, 3, s24
  s_cselect_b32 s29, s26, s29
  v_readfirstlane_b32 s26, v24
  s_nop 0
  s_bcnt0_i32_b32 s28, s26
  s_cmp_eq_u32 s21, 4
  s_cselect_b32 s28, s28, 0
  s_cmp_lt_u32 s23, s28
  s_cselect_b32 s24, 4, s24
  s_cselect_b32 s29, s26, s29
  v_readfirstlane_b32 s26, v25
  s_nop 0
  s_bcnt0_i32_b32 s28, s26
  s_cmp_eq_u32 s21, 5
  s_cselect_b32 s28, s28, 0
  s_cmp_lt_u32 s23, s28
  s_cselect_b32 s24, 5, s24
  s_cselect_b32 s29, s26, s29
  v_readfirstlane_b32 s26, v26
  s_nop 0
  s_bcnt0_i32_b32 s28, s26
  s_cmp_eq_u32 s21, 6
  s_cselect_b32 s28, s28, 0
  s_cmp_lt_u32 s23, s28
  s_cselect_b32 s24, 6, s24
  s_cselect_b32 s29, s26, s29
  v_readfirstlane_b32 s26, v27
  s_nop 0
  s_bcnt0_i32_b32 s28, s26
  s_cmp_eq_u32 s21, 7
  s_cselect_b32 s28, s28, 0
  s_cmp_lt_u32 s23, s28
  s_cselect_b32 s24, 7, s24
  s_cselect_b32 s29, s26, s29
  s_cmp_lt_u32 s24, 8
  s_cbranch_scc1 L_role_nth
  v_mov_b32 v16, 1
  buffer_atomic_add v16, off, s[16:19], 0 offset:44 sc0
  s_waitcnt vmcnt(0)
  v_readfirstlane_b32 s25, v16
  v_readfirstlane_b32 s26, v20
  v_readfirstlane_b32 s30, v28
  s_bcnt0_i32_b32 s28, s26
  s_min_u32 s30, s30, s28
  s_sub_u32 s28, s28, s30
  s_add_u32 s30, s30, s25
  s_cmp_lt_u32 s25, s28
  s_cselect_b32 s24, 0, s24
  s_cselect_b32 s29, s26, s29
  s_cselect_b32 s23, s30, s23
  s_sub_u32 s25, s25, s28
  v_readfirstlane_b32 s26, v21
  v_readfirstlane_b32 s30, v29
  s_bcnt0_i32_b32 s28, s26
  s_min_u32 s30, s30, s28
  s_sub_u32 s28, s28, s30
  s_add_u32 s30, s30, s25
  s_cmp_lt_u32 s25, s28
  s_cselect_b32 s24, 1, s24
  s_cselect_b32 s29, s26, s29
  s_cselect_b32 s23, s30, s23
  s_sub_u32 s25, s25, s28
  v_readfirstlane_b32 s26, v22
  v_readfirstlane_b32 s30, v30
  s_bcnt0_i32_b32 s28, s26
  s_min_u32 s30, s30, s28
  s_sub_u32 s28, s28, s30
  s_add_u32 s30, s30, s25
  s_cmp_lt_u32 s25, s28
  s_cselect_b32 s24, 2, s24
  s_cselect_b32 s29, s26, s29
  s_cselect_b32 s23, s30, s23
  s_sub_u32 s25, s25, s28
  v_readfirstlane_b32 s26, v23
  v_readfirstlane_b32 s30, v31
  s_bcnt0_i32_b32 s28, s26
  s_min_u32 s30, s30, s28
  s_sub_u32 s28, s28, s30
  s_add_u32 s30, s30, s25
  s_cmp_lt_u32 s25, s28
  s_cselect_b32 s24, 3, s24
  s_cselect_b32 s29, s26, s29
  s_cselect_b32 s23, s30, s23
  s_sub_u32 s25, s25, s28
  v_readfirstlane_b32 s26, v24
  v_readfirstlane_b32 s30, v32
  s_bcnt0_i32_b32 s28, s26
  s_min_u32 s30, s30, s28
  s_sub_u32 s28, s28, s30
  s_add_u32 s30, s30, s25
  s_cmp_lt_u32 s25, s28
  s_cselect_b32 s24, 4, s24
  s_cselect_b32 s29, s26, s29
  s_cselect_b32 s23, s30, s23
  s_sub_u32 s25, s25, s28
  v_readfirstlane_b32 s26, v25
  v_readfirstlane_b32 s30, v33
  s_bcnt0_i32_b32 s28, s26
  s_min_u32 s30, s30, s28
  s_sub_u32 s28, s28, s30
  s_add_u32 s30, s30, s25
  s_cmp_lt_u32 s25, s28
  s_cselect_b32 s24, 5, s24
  s_cselect_b32 s29, s26, s29
  s_cselect_b32 s23, s30, s23
  s_sub_u32 s25, s25, s28
  v_readfirstlane_b32 s26, v26
  v_readfirstlane_b32 s30, v34
  s_bcnt0_i32_b32 s28, s26
  s_min_u32 s30, s30, s28
  s_sub_u32 s28, s28, s30
  s_add_u32 s30, s30, s25
  s_cmp_lt_u32 s25, s28
  s_cselect_b32 s24, 6, s24
  s_cselect_b32 s29, s26, s29
  s_cselect_b32 s23, s30, s23
  s_sub_u32 s25, s25, s28
  v_readfirstlane_b32 s26, v27
  v_readfirstlane_b32 s30, v35
  s_bcnt0_i32_b32 s28, s26
  s_min_u32 s30, s30, s28
  s_sub_u32 s28, s28, s30
  s_add_u32 s30, s30, s25
  s_cmp_lt_u32 s25, s28
  s_cselect_b32 s24, 7, s24
  s_cselect_b32 s29, s26, s29
  s_cselect_b32 s23, s30, s23
  s_sub_u32 s25, s25, s28
  s_cmp_lt_u32 s24, 8
  s_cbranch_scc1 L_role_nth
  s_mov_b32 s24, 256
  s_branch L_role_wr
    L_role_nth:
  s_ff0_i32_b32 s26, s29
  s_cmp_eq_u32 s23, 0
  s_cbranch_scc1 L_role_pub
  s_bitset1_b32 s29, s26
  s_sub_u32 s23, s23, 1
  s_branch L_role_nth
    L_role_pub:
  s_and_b32 s24, s24, 7
  s_and_b32 s26, s26, 31
  s_lshl_b32 s24, s24, 5
  s_add_u32 s24, s24, s26
    L_role_wr:
  v_mov_b32 v16, s24
  v_mov_b32 v17, 0
  ds_write_b32 v17, v16
  s_waitcnt lgkmcnt(0)
  s_mov_b64 exec, -1
    L_role_wait:
  s_barrier
  v_mov_b32 v17, 0
  ds_read_b32 v16, v17
  s_waitcnt lgkmcnt(0)
  v_readfirstlane_b32 s24, v16
  s_barrier
  s_cmp_ge_u32 s24, 256
  s_cbranch_scc1 L_exit
    L_role_done:
  s_mov_b32 s99, s24
  s_cmp_ge_u32 s24, 32
  s_cbranch_scc1 L_nonchain
  s_mov_b32 s20, s24
  s_cmp_lg_u32 s3, 0
  s_cselect_b32 s35, 1, 0
  v_mov_b32 v71, v0
  v_lshrrev_b32 v16, 6, v71
  s_nop 0
  v_readfirstlane_b32 s21, v16
  v_mov_b32 v65, s93
  s_cmp_lg_u32 s21, 3
  s_cbranch_scc1 L_reg_c
  s_mov_b64 exec, 1
  buffer_atomic_or v65, off, s[16:19], s92 offset:0 sc0
  s_mov_b64 exec, -1
    L_reg_c:
  s_lshl_b32 s23, s20, 13
  s_add_u32 s33, s23, 16514048
  s_cmp_lt_u32 s21, 2
  s_cselect_b32 s33, 1879048192, s33
  s_add_u32 s34, s23, 133955584
  s_add_u32 s31, s23, 50331648
  s_add_u32 s32, s23, 67108864
  s_load_dwordx2 s[60:61], s[0:1], 16
  s_load_dwordx2 s[72:73], s[0:1], 24
  s_load_dwordx2 s[64:65], s[0:1], 32
  s_load_dwordx2 s[68:69], s[0:1], 40
  v_and_b32 v26, 63, v71
  v_and_b32 v27, 15, v26
  v_lshrrev_b32 v18, 4, v26
  v_lshrrev_b32 v19, 1, v18
  v_and_b32 v20, 1, v18
  v_lshlrev_b32 v20, 2, v20
  v_lshl_add_u32 v22, v19, 4, v20
  v_lshl_add_u32 v23, v19, 3, v20
  s_lshl_b32 s23, s20, 8
  s_and_b32 s24, s21, 1
  s_lshl_b32 s24, s24, 7
  s_add_u32 s24, s24, s23
  v_lshlrev_b32 v21, 13, v22
  v_lshlrev_b32 v24, 3, v27
  v_add3_u32 v63, v21, v24, s24
  v_add_u32 v62, v21, v63
  s_lshl_b32 s24, s21, 6
  s_add_u32 s24, s24, s23
  v_lshlrev_b32 v24, 2, v27
  v_add3_u32 v68, v21, v24, s24
  v_add_u32 v64, v21, v68
  s_mul_i32 s23, s20, 147456
  s_lshl_b32 s24, s21, 8
  s_add_u32 s24, s24, s23
  v_mul_u32_u24 v21, 1152, v23
  v_lshlrev_b32 v24, 4, v27
  v_add3_u32 v66, v21, v24, s24
  s_lshl_b32 s24, s21, 5
  s_add_u32 s24, s24, s23
  v_mul_u32_u24 v21, 1152, v22
  v_add_u32 v21, s24, v21
  v_lshl_add_u32 v67, v27, 1, v21
  v_mov_b32 v69, 0x05040100
  v_mov_b32 v70, 0x07060302
  s_waitcnt lgkmcnt(0)
  s_cmp_ge_u32 s21, 2
  s_cselect_b64 s[60:61], s[72:73], s[60:61]
  s_and_b32 s61, s61, 0xffff
  s_mov_b32 s62, 4718592
  s_mov_b32 s63, 0x20000
  s_and_b32 s65, s65, 0xffff
  s_mov_b32 s66, 4718592
  s_mov_b32 s67, 0x20000
  s_and_b32 s69, s69, 0xffff
  s_mov_b32 s70, 4718592
  s_mov_b32 s71, 0x20000
  s_xor_b32 s24, s21, 0
  s_mul_i32 s24, s24, 36864
  s_add_u32 s23, s24, 0
  buffer_load_dwordx4 v[112:115], v66, s[68:71], s23 offen
  s_add_u32 s23, s24, 1152
  buffer_load_dwordx4 v[116:119], v66, s[68:71], s23 offen
  s_add_u32 s23, s24, 2304
  buffer_load_dwordx4 v[144:147], v66, s[68:71], s23 offen
  s_add_u32 s23, s24, 3456
  buffer_load_dwordx4 v[148:151], v66, s[68:71], s23 offen
  s_add_u32 s23, s24, 18432
  buffer_load_dwordx4 v[176:179], v66, s[68:71], s23 offen
  s_add_u32 s23, s24, 19584
  buffer_load_dwordx4 v[180:183], v66, s[68:71], s23 offen
  s_add_u32 s23, s24, 20736
  buffer_load_dwordx4 v[208:211], v66, s[68:71], s23 offen
  s_add_u32 s23, s24, 21888
  buffer_load_dwordx4 v[212:215], v66, s[68:71], s23 offen
  s_xor_b32 s24, s21, 1
  s_mul_i32 s24, s24, 36864
  s_add_u32 s23, s24, 0
  buffer_load_dwordx4 v[120:123], v66, s[68:71], s23 offen
  s_add_u32 s23, s24, 1152
  buffer_load_dwordx4 v[124:127], v66, s[68:71], s23 offen
  s_add_u32 s23, s24, 2304
  buffer_load_dwordx4 v[152:155], v66, s[68:71], s23 offen
  s_add_u32 s23, s24, 3456
  buffer_load_dwordx4 v[156:159], v66, s[68:71], s23 offen
  s_add_u32 s23, s24, 18432
  buffer_load_dwordx4 v[184:187], v66, s[68:71], s23 offen
  s_add_u32 s23, s24, 19584
  buffer_load_dwordx4 v[188:191], v66, s[68:71], s23 offen
  s_add_u32 s23, s24, 20736
  buffer_load_dwordx4 v[216:219], v66, s[68:71], s23 offen
  s_add_u32 s23, s24, 21888
  buffer_load_dwordx4 v[220:223], v66, s[68:71], s23 offen
  s_xor_b32 s24, s21, 2
  s_mul_i32 s24, s24, 36864
  s_add_u32 s23, s24, 0
  buffer_load_dwordx4 v[128:131], v66, s[68:71], s23 offen
  s_add_u32 s23, s24, 1152
  buffer_load_dwordx4 v[132:135], v66, s[68:71], s23 offen
  s_add_u32 s23, s24, 2304
  buffer_load_dwordx4 v[160:163], v66, s[68:71], s23 offen
  s_add_u32 s23, s24, 3456
  buffer_load_dwordx4 v[164:167], v66, s[68:71], s23 offen
  s_add_u32 s23, s24, 18432
  buffer_load_dwordx4 v[192:195], v66, s[68:71], s23 offen
  s_add_u32 s23, s24, 19584
  buffer_load_dwordx4 v[196:199], v66, s[68:71], s23 offen
  s_add_u32 s23, s24, 20736
  buffer_load_dwordx4 v[224:227], v66, s[68:71], s23 offen
  s_add_u32 s23, s24, 21888
  buffer_load_dwordx4 v[228:231], v66, s[68:71], s23 offen
  s_xor_b32 s24, s21, 3
  s_mul_i32 s24, s24, 36864
  s_add_u32 s23, s24, 0
  buffer_load_dwordx4 v[136:139], v66, s[68:71], s23 offen
  s_add_u32 s23, s24, 1152
  buffer_load_dwordx4 v[140:143], v66, s[68:71], s23 offen
  s_add_u32 s23, s24, 2304
  buffer_load_dwordx4 v[168:171], v66, s[68:71], s23 offen
  s_add_u32 s23, s24, 3456
  buffer_load_dwordx4 v[172:175], v66, s[68:71], s23 offen
  s_add_u32 s23, s24, 18432
  buffer_load_dwordx4 v[200:203], v66, s[68:71], s23 offen
  s_add_u32 s23, s24, 19584
  buffer_load_dwordx4 v[204:207], v66, s[68:71], s23 offen
  s_add_u32 s23, s24, 20736
  buffer_load_dwordx4 v[232:235], v66, s[68:71], s23 offen
  s_add_u32 s23, s24, 21888
  buffer_load_dwordx4 v[236:239], v66, s[68:71], s23 offen
  v_and_b32 v16, 63, v71
  v_and_b32 v17, 15, v16
  v_lshrrev_b32 v18, 4, v16
  v_lshrrev_b32 v19, 2, v17
  v_and_b32 v20, 1, v17
  v_lshl_add_u32 v21, v19, 1, v20
  v_bfe_u32 v22, v17, 1, 1
  s_lshl_b32 s36, s21, 11
  v_lshlrev_b32 v23, 4, v16
  v_add_u32 v1, s36, v23
  s_lshl_b32 s23, s21, 8
  v_lshlrev_b32 v24, 2, v16
  v_add_u32 v2, s23, v24
  v_mov_b32 v24, 0xeeeeeeee
  v_mov_b32 v25, 0x44444444
  v_cmp_eq_u32 vcc, 0, v22
  s_nop 1
  v_cndmask_b32 v0, v24, v25, vcc
  v_bfe_u32 v24, v17, 1, 2
  v_lshrrev_b32 v25, 3, v17
  v_mul_u32_u24 v26, 12, v25
  v_or_b32 v26, v26, v24
  s_lshr_b32 s23, s21, 1
  v_lshl_add_u32 v27, v18, 2, s23
  v_xor_b32 v26, v26, v27
  v_lshlrev_b32 v26, 4, v26
  v_lshl_add_u32 v26, v20, 3, v26
  v_lshl_add_u32 v26, v24, 8, v26
  v_lshl_add_u32 v26, v25, 10, v26
  s_and_b32 s24, s21, 1
  s_lshl_b32 s24, s24, 11
  s_add_u32 s24, s24, 9216
  v_add_u32 v3, s24, v26
  v_lshl_add_u32 v24, v21, 1, v22
  v_xor_b32 v24, v24, v18
  v_lshlrev_b32 v24, 4, v24
  v_lshl_add_u32 v24, v18, 8, v24
  v_add_u32 v4, 9216, v24
  v_and_b32 v24, 1, v18
  v_lshl_add_u32 v24, v24, 1, v20
  v_lshl_add_u32 v24, v19, 2, v24
  v_lshlrev_b32 v24, 4, v24
  v_lshrrev_b32 v25, 1, v18
  v_lshl_add_u32 v24, v25, 8, v24
  s_lshl_b32 s23, s21, 9
  s_add_u32 s23, s23, 14336
  v_add_u32 v5, s23, v24
  v_lshrrev_b32 v24, 3, v16
  v_mul_u32_u24 v24, 4224, v24
  v_and_b32 v26, 7, v16
  v_lshl_add_u32 v24, v26, 4, v24
  s_mul_i32 s23, s21, 33792
  s_lshl_b32 s24, s20, 7
  s_add_u32 s23, s23, s24
  v_add_u32 v6, s23, v24
  v_mul_u32_u24 v24, 4224, v25
  v_and_b32 v26, 31, v16
  v_lshl_add_u32 v24, v26, 2, v24
  s_mul_i32 s23, s21, 8448
  s_add_u32 s23, s23, s24
  s_add_u32 s23, s23, 270336
  v_add_u32 v7, s23, v24
  s_lshl_b32 s23, s21, 5
  s_add_u32 s23, s23, s20
  s_cmp_lt_u32 s23, 72
  s_cselect_b32 s29, 1, 0
  s_mul_i32 s38, s23, 4224
  s_sub_u32 s38, s38, s36
  s_add_u32 s38, s38, 262144
  s_lshr_b32 s24, s20, 3
  s_lshl_b32 s24, s24, 11
  s_lshl_b32 s25, s21, 10
  s_add_u32 s24, s24, s25
  s_and_b32 s25, s20, 1
  s_lshl_b32 s25, s25, 9
  s_add_u32 s24, s24, s25
  s_bfe_u32 s25, s20, 0x20001
  s_lshl_b32 s25, s25, 6
  s_add_u32 s24, s24, s25
  s_lshl_b32 s25, s20, 7
  s_add_u32 s25, s25, 8192
  s_cmp_eq_u32 s21, 2
  s_cselect_b32 s24, s25, s24
  s_cselect_b32 s49, 256, 0
  s_cselect_b64 vcc, -1, 0
  s_cselect_b32 s25, 6, 8
  v_bfe_u32 v24, v17, 2, 1
  v_and_b32 v26, 1, v18
  v_lshlrev_b32 v24, s25, v24
  v_lshl_add_u32 v24, v22, 5, v24
  v_lshl_add_u32 v24, v20, 3, v24
  v_lshl_add_u32 v24, v25, 2, v24
  v_lshl_add_u32 v24, v26, 4, v24
  v_add_u32 v8, s24, v24
  s_mov_b32 s28, 0x3e0293ee
  s_lshl_b32 s23, s20, 7
  s_add_u32 s23, s23, 1376256
  s_mov_b32 s45, 237568
  s_cmp_eq_u32 s21, 3
  s_cselect_b32 s37, s23, 1879048192
  s_cselect_b32 s54, 0x1000, 0
  s_cselect_b32 s4, -1, 0
  s_cselect_b32 s7, 1379584, s37
  s_lshl_b32 s6, s20, 2
  s_add_u32 s6, s6, 1380352
  s_cmp_eq_u32 s21, 3
  s_cselect_b32 s6, s6, s37
  s_mov_b32 s5, 0
  s_mov_b32 s52, s8
  s_or_b32 s53, s9, 2097152
  s_mov_b32 s55, 0x20000
  s_mov_b32 s39, 262144
  s_mov_b32 s40, 279040
  s_mov_b32 s41, 397312
  s_mov_b32 s42, 414208
  s_mov_b32 s43, 1310720
  s_mov_b32 s44, 1318912
  s_mov_b32 s48, s36
  s_add_u32 s56, s36, 1024
  s_lshl_b32 s57, s21, 8
  s_add_u32 s57, s57, 8192
  v_lshrrev_b32 v24, 1, v19
  v_and_b32 v26, 1, v19
  v_lshl_add_u32 v24, v24, 2, v26
  v_lshl_add_u32 v24, v20, 1, v24
  v_lshlrev_b32 v27, 4, v17
  v_add_u32 v27, 13824, v27
  v_and_b32 v28, 1, v21
  v_lshlrev_b32 v28, 4, v28
  v_mov_b32 v29, 0x3f80
  v_lshlrev_b32 v28, v28, v29
  v_lshrrev_b32 v29, 1, v21
  v_cmp_eq_u32 vcc, 0, v29
  s_nop 1
  v_cndmask_b32 v32, 0, v28, vcc
  v_cmp_eq_u32 vcc, 1, v29
  s_nop 1
  v_cndmask_b32 v33, 0, v28, vcc
  v_cmp_eq_u32 vcc, 2, v29
  s_nop 1
  v_cndmask_b32 v34, 0, v28, vcc
  v_cmp_eq_u32 vcc, 3, v29
  s_nop 1
  v_cndmask_b32 v35, 0, v28, vcc
  ds_write_b128 v27, v[32:35] offset:0
  v_and_b32 v28, 1, v24
  v_lshlrev_b32 v28, 4, v28
  v_mov_b32 v29, 0x3f80
  v_lshlrev_b32 v28, v28, v29
  v_lshrrev_b32 v29, 1, v24
  v_cmp_eq_u32 vcc, 0, v29
  s_nop 1
  v_cndmask_b32 v32, 0, v28, vcc
  v_cmp_eq_u32 vcc, 1, v29
  s_nop 1
  v_cndmask_b32 v33, 0, v28, vcc
  v_cmp_eq_u32 vcc, 2, v29
  s_nop 1
  v_cndmask_b32 v34, 0, v28, vcc
  v_cmp_eq_u32 vcc, 3, v29
  s_nop 1
  v_cndmask_b32 v35, 0, v28, vcc
  ds_write_b128 v27, v[32:35] offset:256
  v_and_b32 v16, 63, v71
  v_and_b32 v17, 15, v16
  v_lshrrev_b32 v18, 4, v16
  v_mul_u32_u24 v24, 1088, v18
  v_lshl_add_u32 v24, v17, 3, v24
  s_lshr_b32 s23, s21, 1
  s_mul_i32 s23, s23, 272
  s_and_b32 s24, s21, 1
  s_lshl_b32 s24, s24, 7
  s_add_u32 s23, s23, s24
  s_add_u32 s23, s23, 9216
  v_add_u32 v3, s23, v24
  v_mul_u32_u24 v24, 544, v21
  v_lshl_add_u32 v24, v18, 4, v24
  v_mul_u32_u24 v25, 272, v22
  v_add3_u32 v4, v24, v25, 0
  v_add_u32 v4, 9216, v4
  s_load_dwordx2 s[46:47], s[0:1], 8
  s_waitcnt lgkmcnt(0)
  s_mov_b32 s12, s46
  s_and_b32 s13, s47, 0xffff
  s_mov_b32 s14, 9216
  s_mov_b32 s15, 0x20000
  v_add_u32 v17, 0, v71
  v_bfe_u32 v18, v17, 2, 2
  v_and_b32 v19, 1, v17
  v_lshl_add_u32 v18, v18, 1, v19
  v_mul_u32_u24 v18, 1152, v18
  v_bfe_u32 v19, v17, 4, 2
  v_bfe_u32 v20, v17, 1, 1
  v_lshl_add_u32 v19, v19, 1, v20
  v_lshrrev_b32 v20, 7, v17
  v_lshl_add_u32 v18, v20, 8, v18
  v_bfe_u32 v20, v17, 6, 1
  v_lshl_add_u32 v18, v20, 3, v18
  v_lshl_add_u32 v18, v19, 5, v18
  buffer_load_dwordx2 a[136:137], v18, s[12:15], 0 offen
  buffer_load_dwordx2 a[138:139], v18, s[12:15], 0 offen offset:16
  v_add_u32 v17, 256, v71
  v_bfe_u32 v18, v17, 2, 2
  v_and_b32 v19, 1, v17
  v_lshl_add_u32 v18, v18, 1, v19
  v_mul_u32_u24 v18, 1152, v18
  v_bfe_u32 v19, v17, 4, 2
  v_bfe_u32 v20, v17, 1, 1
  v_lshl_add_u32 v19, v19, 1, v20
  v_lshrrev_b32 v20, 7, v17
  v_lshl_add_u32 v18, v20, 8, v18
  v_bfe_u32 v20, v17, 6, 1
  v_lshl_add_u32 v18, v20, 3, v18
  v_lshl_add_u32 v18, v19, 5, v18
  buffer_load_dwordx2 a[140:141], v18, s[12:15], 0 offen
  buffer_load_dwordx2 a[142:143], v18, s[12:15], 0 offen offset:16
  v_add_u32 v17, 512, v71
  v_bfe_u32 v18, v17, 2, 2
  v_and_b32 v19, 1, v17
  v_lshl_add_u32 v18, v18, 1, v19
  v_mul_u32_u24 v18, 1152, v18
  v_bfe_u32 v19, v17, 4, 2
  v_bfe_u32 v20, v17, 1, 1
  v_lshl_add_u32 v19, v19, 1, v20
  v_lshl_add_u32 v18, v19, 4, v18
  buffer_load_dwordx4 a[144:147], v18, s[12:15], 0 offen offset:1024
  v_add_u32 v26, 0x10000, v1
  v_add_u32 v27, 0x20000, v1
  s_mov_b32 s23, 0
  buffer_load_ushort v240, v67, s[68:71], s23 offen offset:1024
  s_mov_b32 s23, 1152
  buffer_load_ushort v241, v67, s[68:71], s23 offen offset:1024
  s_mov_b32 s23, 9216
  buffer_load_ushort v242, v67, s[68:71], s23 offen offset:1024
  s_mov_b32 s23, 10368
  buffer_load_ushort v243, v67, s[68:71], s23 offen offset:1024
  s_mov_b32 s23, 2304
  buffer_load_ushort v244, v67, s[68:71], s23 offen offset:1024
  s_mov_b32 s23, 3456
  buffer_load_ushort v245, v67, s[68:71], s23 offen offset:1024
  s_mov_b32 s23, 11520
  buffer_load_ushort v246, v67, s[68:71], s23 offen offset:1024
  s_mov_b32 s23, 12672
  buffer_load_ushort v247, v67, s[68:71], s23 offen offset:1024
  s_mov_b32 s23, 36864
  buffer_load_ushort v44, v67, s[68:71], s23 offen offset:1024
  s_mov_b32 s23, 38016
  buffer_load_ushort v45, v67, s[68:71], s23 offen offset:1024
  s_mov_b32 s23, 46080
  buffer_load_ushort v46, v67, s[68:71], s23 offen offset:1024
  s_mov_b32 s23, 47232
  buffer_load_ushort v47, v67, s[68:71], s23 offen offset:1024
  s_mov_b32 s23, 39168
  buffer_load_ushort v48, v67, s[68:71], s23 offen offset:1024
  s_mov_b32 s23, 40320
  buffer_load_ushort v49, v67, s[68:71], s23 offen offset:1024
  s_mov_b32 s23, 48384
  buffer_load_ushort v50, v67, s[68:71], s23 offen offset:1024
  s_mov_b32 s23, 49536
  buffer_load_ushort v51, v67, s[68:71], s23 offen offset:1024
  s_waitcnt vmcnt(40)
  v_mov_b64 v[10:11], v[112:113]
  v_mov_b64 v[12:13], v[114:115]
  v_mov_b64 v[14:15], v[116:117]
  v_mov_b64 v[16:17], v[118:119]
  v_mov_b64 v[18:19], v[144:145]
  v_mov_b64 v[20:21], v[146:147]
  v_mov_b64 v[22:23], v[148:149]
  v_mov_b64 v[24:25], v[150:151]
  v_mov_b64 v[28:29], v[176:177]
  v_mov_b64 v[30:31], v[178:179]
  v_mov_b64 v[32:33], v[180:181]
  v_mov_b64 v[34:35], v[182:183]
  v_mov_b64 v[36:37], v[208:209]
  v_mov_b64 v[38:39], v[210:211]
  v_mov_b64 v[40:41], v[212:213]
  v_mov_b64 v[42:43], v[214:215]
  v_perm_b32 v112, v14, v10, v69
  v_perm_b32 v113, v14, v10, v70
  v_perm_b32 v114, v22, v18, v69
  v_perm_b32 v115, v22, v18, v70
  v_perm_b32 v116, v32, v28, v69
  v_perm_b32 v117, v32, v28, v70
  v_perm_b32 v118, v40, v36, v69
  v_perm_b32 v119, v40, v36, v70
  v_perm_b32 v144, v15, v11, v69
  v_perm_b32 v145, v15, v11, v70
  v_perm_b32 v146, v23, v19, v69
  v_perm_b32 v147, v23, v19, v70
  v_perm_b32 v148, v33, v29, v69
  v_perm_b32 v149, v33, v29, v70
  v_perm_b32 v150, v41, v37, v69
  v_perm_b32 v151, v41, v37, v70
  v_perm_b32 v176, v16, v12, v69
  v_perm_b32 v177, v16, v12, v70
  v_perm_b32 v178, v24, v20, v69
  v_perm_b32 v179, v24, v20, v70
  v_perm_b32 v180, v34, v30, v69
  v_perm_b32 v181, v34, v30, v70
  v_perm_b32 v182, v42, v38, v69
  v_perm_b32 v183, v42, v38, v70
  v_perm_b32 v208, v17, v13, v69
  v_perm_b32 v209, v17, v13, v70
  v_perm_b32 v210, v25, v21, v69
  v_perm_b32 v211, v25, v21, v70
  v_perm_b32 v212, v35, v31, v69
  v_perm_b32 v213, v35, v31, v70
  v_perm_b32 v214, v43, v39, v69
  v_perm_b32 v215, v43, v39, v70
  s_waitcnt vmcnt(32)
  v_mov_b64 v[10:11], v[120:121]
  v_mov_b64 v[12:13], v[122:123]
  v_mov_b64 v[14:15], v[124:125]
  v_mov_b64 v[16:17], v[126:127]
  v_mov_b64 v[18:19], v[152:153]
  v_mov_b64 v[20:21], v[154:155]
  v_mov_b64 v[22:23], v[156:157]
  v_mov_b64 v[24:25], v[158:159]
  v_mov_b64 v[28:29], v[184:185]
  v_mov_b64 v[30:31], v[186:187]
  v_mov_b64 v[32:33], v[188:189]
  v_mov_b64 v[34:35], v[190:191]
  v_mov_b64 v[36:37], v[216:217]
  v_mov_b64 v[38:39], v[218:219]
  v_mov_b64 v[40:41], v[220:221]
  v_mov_b64 v[42:43], v[222:223]
  v_perm_b32 v120, v14, v10, v69
  v_perm_b32 v121, v14, v10, v70
  v_perm_b32 v122, v22, v18, v69
  v_perm_b32 v123, v22, v18, v70
  v_perm_b32 v124, v32, v28, v69
  v_perm_b32 v125, v32, v28, v70
  v_perm_b32 v126, v40, v36, v69
  v_perm_b32 v127, v40, v36, v70
  v_perm_b32 v152, v15, v11, v69
  v_perm_b32 v153, v15, v11, v70
  v_perm_b32 v154, v23, v19, v69
  v_perm_b32 v155, v23, v19, v70
  v_perm_b32 v156, v33, v29, v69
  v_perm_b32 v157, v33, v29, v70
  v_perm_b32 v158, v41, v37, v69
  v_perm_b32 v159, v41, v37, v70
  v_perm_b32 v184, v16, v12, v69
  v_perm_b32 v185, v16, v12, v70
  v_perm_b32 v186, v24, v20, v69
  v_perm_b32 v187, v24, v20, v70
  v_perm_b32 v188, v34, v30, v69
  v_perm_b32 v189, v34, v30, v70
  v_perm_b32 v190, v42, v38, v69
  v_perm_b32 v191, v42, v38, v70
  v_perm_b32 v216, v17, v13, v69
  v_perm_b32 v217, v17, v13, v70
  v_perm_b32 v218, v25, v21, v69
  v_perm_b32 v219, v25, v21, v70
  v_perm_b32 v220, v35, v31, v69
  v_perm_b32 v221, v35, v31, v70
  v_perm_b32 v222, v43, v39, v69
  v_perm_b32 v223, v43, v39, v70
  s_mov_b32 s23, 73728
  buffer_load_ushort v248, v67, s[68:71], s23 offen offset:1024
  s_mov_b32 s23, 74880
  buffer_load_ushort v249, v67, s[68:71], s23 offen offset:1024
  s_mov_b32 s23, 82944
  buffer_load_ushort v250, v67, s[68:71], s23 offen offset:1024
  s_mov_b32 s23, 84096
  buffer_load_ushort v251, v67, s[68:71], s23 offen offset:1024
  s_mov_b32 s23, 76032
  buffer_load_ushort v252, v67, s[68:71], s23 offen offset:1024
  s_mov_b32 s23, 77184
  buffer_load_ushort v253, v67, s[68:71], s23 offen offset:1024
  s_mov_b32 s23, 85248
  buffer_load_ushort v254, v67, s[68:71], s23 offen offset:1024
  s_mov_b32 s23, 86400
  buffer_load_ushort v255, v67, s[68:71], s23 offen offset:1024
  s_mov_b32 s23, 110592
  buffer_load_ushort v52, v67, s[68:71], s23 offen offset:1024
  s_mov_b32 s23, 111744
  buffer_load_ushort v53, v67, s[68:71], s23 offen offset:1024
  s_mov_b32 s23, 119808
  buffer_load_ushort v54, v67, s[68:71], s23 offen offset:1024
  s_mov_b32 s23, 120960
  buffer_load_ushort v55, v67, s[68:71], s23 offen offset:1024
  s_mov_b32 s23, 112896
  buffer_load_ushort v56, v67, s[68:71], s23 offen offset:1024
  s_mov_b32 s23, 114048
  buffer_load_ushort v57, v67, s[68:71], s23 offen offset:1024
  s_mov_b32 s23, 122112
  buffer_load_ushort v58, v67, s[68:71], s23 offen offset:1024
  s_mov_b32 s23, 123264
  buffer_load_ushort v59, v67, s[68:71], s23 offen offset:1024
  s_waitcnt vmcnt(40)
  v_mov_b64 v[10:11], v[128:129]
  v_mov_b64 v[12:13], v[130:131]
  v_mov_b64 v[14:15], v[132:133]
  v_mov_b64 v[16:17], v[134:135]
  v_mov_b64 v[18:19], v[160:161]
  v_mov_b64 v[20:21], v[162:163]
  v_mov_b64 v[22:23], v[164:165]
  v_mov_b64 v[24:25], v[166:167]
  v_mov_b64 v[28:29], v[192:193]
  v_mov_b64 v[30:31], v[194:195]
  v_mov_b64 v[32:33], v[196:197]
  v_mov_b64 v[34:35], v[198:199]
  v_mov_b64 v[36:37], v[224:225]
  v_mov_b64 v[38:39], v[226:227]
  v_mov_b64 v[40:41], v[228:229]
  v_mov_b64 v[42:43], v[230:231]
  v_perm_b32 v128, v14, v10, v69
  v_perm_b32 v129, v14, v10, v70
  v_perm_b32 v130, v22, v18, v69
  v_perm_b32 v131, v22, v18, v70
  v_perm_b32 v132, v32, v28, v69
  v_perm_b32 v133, v32, v28, v70
  v_perm_b32 v134, v40, v36, v69
  v_perm_b32 v135, v40, v36, v70
  v_perm_b32 v160, v15, v11, v69
  v_perm_b32 v161, v15, v11, v70
  v_perm_b32 v162, v23, v19, v69
  v_perm_b32 v163, v23, v19, v70
  v_perm_b32 v164, v33, v29, v69
  v_perm_b32 v165, v33, v29, v70
  v_perm_b32 v166, v41, v37, v69
  v_perm_b32 v167, v41, v37, v70
  v_perm_b32 v192, v16, v12, v69
  v_perm_b32 v193, v16, v12, v70
  v_perm_b32 v194, v24, v20, v69
  v_perm_b32 v195, v24, v20, v70
  v_perm_b32 v196, v34, v30, v69
  v_perm_b32 v197, v34, v30, v70
  v_perm_b32 v198, v42, v38, v69
  v_perm_b32 v199, v42, v38, v70
  v_perm_b32 v224, v17, v13, v69
  v_perm_b32 v225, v17, v13, v70
  v_perm_b32 v226, v25, v21, v69
  v_perm_b32 v227, v25, v21, v70
  v_perm_b32 v228, v35, v31, v69
  v_perm_b32 v229, v35, v31, v70
  v_perm_b32 v230, v43, v39, v69
  v_perm_b32 v231, v43, v39, v70
  s_xor_b32 s24, s21, 0
  s_lshl_b32 s24, s24, 20
  s_add_u32 s24, s24, 0
  s_add_u32 s23, s24, 0
  buffer_load_dwordx2 a[0:1], v62, s[60:63], s23 offen
  s_add_u32 s23, s24, 8192
  buffer_load_dwordx2 a[2:3], v62, s[60:63], s23 offen
  s_add_u32 s23, s24, 131072
  buffer_load_dwordx2 a[8:9], v62, s[60:63], s23 offen
  s_add_u32 s23, s24, 139264
  buffer_load_dwordx2 a[10:11], v62, s[60:63], s23 offen
  s_add_u32 s23, s24, 16384
  buffer_load_dwordx2 a[16:17], v62, s[60:63], s23 offen
  s_add_u32 s23, s24, 24576
  buffer_load_dwordx2 a[18:19], v62, s[60:63], s23 offen
  s_add_u32 s23, s24, 147456
  buffer_load_dwordx2 a[24:25], v62, s[60:63], s23 offen
  s_add_u32 s23, s24, 155648
  buffer_load_dwordx2 a[26:27], v62, s[60:63], s23 offen
  s_waitcnt vmcnt(40)
  v_mov_b64 v[10:11], v[136:137]
  v_mov_b64 v[12:13], v[138:139]
  v_mov_b64 v[14:15], v[140:141]
  v_mov_b64 v[16:17], v[142:143]
  v_mov_b64 v[18:19], v[168:169]
  v_mov_b64 v[20:21], v[170:171]
  v_mov_b64 v[22:23], v[172:173]
  v_mov_b64 v[24:25], v[174:175]
  v_mov_b64 v[28:29], v[200:201]
  v_mov_b64 v[30:31], v[202:203]
  v_mov_b64 v[32:33], v[204:205]
  v_mov_b64 v[34:35], v[206:207]
  v_mov_b64 v[36:37], v[232:233]
  v_mov_b64 v[38:39], v[234:235]
  v_mov_b64 v[40:41], v[236:237]
  v_mov_b64 v[42:43], v[238:239]
  v_perm_b32 v136, v14, v10, v69
  v_perm_b32 v137, v14, v10, v70
  v_perm_b32 v138, v22, v18, v69
  v_perm_b32 v139, v22, v18, v70
  v_perm_b32 v140, v32, v28, v69
  v_perm_b32 v141, v32, v28, v70
  v_perm_b32 v142, v40, v36, v69
  v_perm_b32 v143, v40, v36, v70
  v_perm_b32 v168, v15, v11, v69
  v_perm_b32 v169, v15, v11, v70
  v_perm_b32 v170, v23, v19, v69
  v_perm_b32 v171, v23, v19, v70
  v_perm_b32 v172, v33, v29, v69
  v_perm_b32 v173, v33, v29, v70
  v_perm_b32 v174, v41, v37, v69
  v_perm_b32 v175, v41, v37, v70
  v_perm_b32 v200, v16, v12, v69
  v_perm_b32 v201, v16, v12, v70
  v_perm_b32 v202, v24, v20, v69
  v_perm_b32 v203, v24, v20, v70
  v_perm_b32 v204, v34, v30, v69
  v_perm_b32 v205, v34, v30, v70
  v_perm_b32 v206, v42, v38, v69
  v_perm_b32 v207, v42, v38, v70
  v_perm_b32 v232, v17, v13, v69
  v_perm_b32 v233, v17, v13, v70
  v_perm_b32 v234, v25, v21, v69
  v_perm_b32 v235, v25, v21, v70
  v_perm_b32 v236, v35, v31, v69
  v_perm_b32 v237, v35, v31, v70
  v_perm_b32 v238, v43, v39, v69
  v_perm_b32 v239, v43, v39, v70
  s_cmp_lg_u32 s21, 3
  s_cbranch_scc1 L_reg_c2
  v_and_b32 v65, s93, v65
  v_mov_b32 v14, 163836
  s_mov_b64 exec, 1
  ds_write_b32 v14, v65
  s_mov_b64 exec, -1
  s_waitcnt lgkmcnt(0)
    L_reg_c2:
  s_barrier
  v_mov_b32 v14, 163836
  ds_read_b32 v65, v14
  s_waitcnt lgkmcnt(0)
  v_readfirstlane_b32 s23, v65
  s_nop 0
  s_cmp_lg_u32 s23, 0
  s_cbranch_scc1 L_conflict
  v_mov_b32 v10, 0
  v_mov_b32 v11, 0
  v_mov_b32 v12, 0
  v_mov_b32 v13, 0
  v_mov_b32 v14, -1
  s_cmp_eq_u32 s29, 0
  s_cbranch_scc1 L_noarm
  buffer_store_dwordx4 v[10:13], v1, s[8:11], s38 offen offset:0 sc1
  buffer_store_dwordx4 v[10:13], v1, s[8:11], s38 offen offset:1024 sc1
  buffer_store_dwordx4 v[10:13], v1, s[8:11], s38 offen offset:2048 sc1
  buffer_store_dwordx4 v[10:13], v1, s[8:11], s38 offen offset:3072 sc1
  buffer_store_dword v10, v8, s[8:11], s43 offen sc1
    L_noarm:
  buffer_store_dword v10, off, s[8:11], s37 sc1
  buffer_store_dword v14, off, s[8:11], s6 sc1
  s_nop 1
  s_xor_b32 s24, s21, 0
  s_lshl_b32 s24, s24, 20
  s_add_u32 s24, s24, 0
  s_add_u32 s23, s24, 524288
  buffer_load_dwordx2 a[4:5], v62, s[60:63], s23 offen
  s_add_u32 s23, s24, 532480
  buffer_load_dwordx2 a[6:7], v62, s[60:63], s23 offen
  s_add_u32 s23, s24, 655360
  buffer_load_dwordx2 a[12:13], v62, s[60:63], s23 offen
  s_add_u32 s23, s24, 663552
  buffer_load_dwordx2 a[14:15], v62, s[60:63], s23 offen
  s_add_u32 s23, s24, 540672
  buffer_load_dwordx2 a[20:21], v62, s[60:63], s23 offen
  s_add_u32 s23, s24, 548864
  buffer_load_dwordx2 a[22:23], v62, s[60:63], s23 offen
  s_add_u32 s23, s24, 671744
  buffer_load_dwordx2 a[28:29], v62, s[60:63], s23 offen
  s_add_u32 s23, s24, 679936
  buffer_load_dwordx2 a[30:31], v62, s[60:63], s23 offen
  s_waitcnt vmcnt(32)
  s_waitcnt lgkmcnt(0)
  v_mov_b64 v[10:11], v[240:241]
  v_mov_b64 v[12:13], v[242:243]
  v_mov_b64 v[14:15], v[244:245]
  v_mov_b64 v[16:17], v[246:247]
  v_mov_b64 v[18:19], v[44:45]
  v_mov_b64 v[20:21], v[46:47]
  v_mov_b64 v[22:23], v[48:49]
  v_mov_b64 v[24:25], v[50:51]
  v_perm_b32 v240, v11, v10, v69
  v_perm_b32 v241, v13, v12, v69
  v_perm_b32 v242, v15, v14, v69
  v_perm_b32 v243, v17, v16, v69
  v_perm_b32 v244, v19, v18, v69
  v_perm_b32 v245, v21, v20, v69
  v_perm_b32 v246, v23, v22, v69
  v_perm_b32 v247, v25, v24, v69
  s_xor_b32 s24, s21, 0
  s_lshl_b32 s24, s24, 20
  s_add_u32 s24, s24, 32768
  s_add_u32 s23, s24, 0
  buffer_load_dwordx2 a[168:169], v62, s[60:63], s23 offen
  s_add_u32 s23, s24, 8192
  buffer_load_dwordx2 a[170:171], v62, s[60:63], s23 offen
  s_add_u32 s23, s24, 131072
  buffer_load_dwordx2 a[176:177], v62, s[60:63], s23 offen
  s_add_u32 s23, s24, 139264
  buffer_load_dwordx2 a[178:179], v62, s[60:63], s23 offen
  s_add_u32 s23, s24, 16384
  buffer_load_dwordx2 v[28:29], v62, s[60:63], s23 offen
  s_add_u32 s23, s24, 24576
  buffer_load_dwordx2 v[30:31], v62, s[60:63], s23 offen
  s_add_u32 s23, s24, 147456
  buffer_load_dwordx2 a[184:185], v62, s[60:63], s23 offen
  s_add_u32 s23, s24, 155648
  buffer_load_dwordx2 a[186:187], v62, s[60:63], s23 offen
  s_xor_b32 s24, s21, 0
  s_lshl_b32 s24, s24, 20
  s_add_u32 s24, s24, 32768
  s_add_u32 s23, s24, 524288
  buffer_load_dwordx2 a[172:173], v62, s[60:63], s23 offen
  s_add_u32 s23, s24, 532480
  buffer_load_dwordx2 a[174:175], v62, s[60:63], s23 offen
  s_add_u32 s23, s24, 655360
  buffer_load_dwordx2 a[180:181], v62, s[60:63], s23 offen
  s_add_u32 s23, s24, 663552
  buffer_load_dwordx2 a[182:183], v62, s[60:63], s23 offen
  s_add_u32 s23, s24, 540672
  buffer_load_dwordx2 v[32:33], v62, s[60:63], s23 offen
  s_add_u32 s23, s24, 548864
  buffer_load_dwordx2 v[34:35], v62, s[60:63], s23 offen
  s_add_u32 s23, s24, 671744
  buffer_load_dwordx2 a[188:189], v62, s[60:63], s23 offen
  s_add_u32 s23, s24, 679936
  buffer_load_dwordx2 a[190:191], v62, s[60:63], s23 offen
  s_waitcnt vmcnt(32)
  s_waitcnt lgkmcnt(0)
  v_mov_b64 v[10:11], v[248:249]
  v_mov_b64 v[12:13], v[250:251]
  v_mov_b64 v[14:15], v[252:253]
  v_mov_b64 v[16:17], v[254:255]
  v_mov_b64 v[18:19], v[52:53]
  v_mov_b64 v[20:21], v[54:55]
  v_mov_b64 v[22:23], v[56:57]
  v_mov_b64 v[24:25], v[58:59]
  v_perm_b32 v248, v11, v10, v69
  v_perm_b32 v249, v13, v12, v69
  v_perm_b32 v250, v15, v14, v69
  v_perm_b32 v251, v17, v16, v69
  v_perm_b32 v252, v19, v18, v69
  v_perm_b32 v253, v21, v20, v69
  v_perm_b32 v254, v23, v22, v69
  v_perm_b32 v255, v25, v24, v69
  v_lshlrev_b32 v17, 4, v71
  ds_write_b128 v17, a[136:139]
  ds_write_b128 v17, a[140:143] offset:4096
  s_cmp_lg_u32 s21, 0
  s_cbranch_scc1 L_m0skip
  ds_write_b128 v17, a[144:147] offset:8192
            L_m0skip:
  s_waitcnt lgkmcnt(0)
  s_xor_b32 s24, s21, 1
  s_lshl_b32 s24, s24, 20
  s_add_u32 s24, s24, 0
  s_add_u32 s23, s24, 0
  buffer_load_dwordx2 a[40:41], v62, s[60:63], s23 offen
  s_add_u32 s23, s24, 8192
  buffer_load_dwordx2 a[42:43], v62, s[60:63], s23 offen
  s_add_u32 s23, s24, 131072
  buffer_load_dwordx2 a[48:49], v62, s[60:63], s23 offen
  s_add_u32 s23, s24, 139264
  buffer_load_dwordx2 a[50:51], v62, s[60:63], s23 offen
  s_add_u32 s23, s24, 16384
  buffer_load_dwordx2 v[36:37], v62, s[60:63], s23 offen
  s_add_u32 s23, s24, 24576
  buffer_load_dwordx2 v[38:39], v62, s[60:63], s23 offen
  s_add_u32 s23, s24, 147456
  buffer_load_dwordx2 a[56:57], v62, s[60:63], s23 offen
  s_add_u32 s23, s24, 155648
  buffer_load_dwordx2 a[58:59], v62, s[60:63], s23 offen
  s_xor_b32 s24, s21, 1
  s_lshl_b32 s24, s24, 20
  s_add_u32 s24, s24, 0
  s_add_u32 s23, s24, 524288
  buffer_load_dwordx2 a[44:45], v62, s[60:63], s23 offen
  s_add_u32 s23, s24, 532480
  buffer_load_dwordx2 a[46:47], v62, s[60:63], s23 offen
  s_add_u32 s23, s24, 655360
  buffer_load_dwordx2 a[52:53], v62, s[60:63], s23 offen
  s_add_u32 s23, s24, 663552
  buffer_load_dwordx2 a[54:55], v62, s[60:63], s23 offen
  s_add_u32 s23, s24, 540672
  buffer_load_dwordx2 v[40:41], v62, s[60:63], s23 offen
  s_add_u32 s23, s24, 548864
  buffer_load_dwordx2 v[42:43], v62, s[60:63], s23 offen
  s_add_u32 s23, s24, 671744
  buffer_load_dwordx2 a[60:61], v62, s[60:63], s23 offen
  s_add_u32 s23, s24, 679936
  buffer_load_dwordx2 a[62:63], v62, s[60:63], s23 offen
  s_waitcnt vmcnt(40)
  s_waitcnt lgkmcnt(0)
  v_accvgpr_read_b32 v10, a0
  v_accvgpr_read_b32 v11, a1
  v_accvgpr_read_b32 v12, a2
  v_accvgpr_read_b32 v13, a3
  v_accvgpr_read_b32 v14, a8
  v_accvgpr_read_b32 v15, a9
  v_accvgpr_read_b32 v16, a10
  v_accvgpr_read_b32 v17, a11
  v_accvgpr_read_b32 v18, a16
  v_accvgpr_read_b32 v19, a17
  v_accvgpr_read_b32 v20, a18
  v_accvgpr_read_b32 v21, a19
  v_accvgpr_read_b32 v22, a24
  v_accvgpr_read_b32 v23, a25
  v_accvgpr_read_b32 v24, a26
  v_accvgpr_read_b32 v25, a27
  v_perm_b32 v60, v12, v10, v69
  v_accvgpr_write_b32 a0, v60
  v_perm_b32 v61, v16, v14, v69
  v_accvgpr_write_b32 a1, v61
  v_perm_b32 v60, v20, v18, v69
  v_accvgpr_write_b32 a2, v60
  v_perm_b32 v61, v24, v22, v69
  v_accvgpr_write_b32 a3, v61
  v_perm_b32 v60, v12, v10, v70
  v_accvgpr_write_b32 a8, v60
  v_perm_b32 v61, v16, v14, v70
  v_accvgpr_write_b32 a9, v61
  v_perm_b32 v60, v20, v18, v70
  v_accvgpr_write_b32 a10, v60
  v_perm_b32 v61, v24, v22, v70
  v_accvgpr_write_b32 a11, v61
  v_perm_b32 v60, v13, v11, v69
  v_accvgpr_write_b32 a16, v60
  v_perm_b32 v61, v17, v15, v69
  v_accvgpr_write_b32 a17, v61
  v_perm_b32 v60, v21, v19, v69
  v_accvgpr_write_b32 a18, v60
  v_perm_b32 v61, v25, v23, v69
  v_accvgpr_write_b32 a19, v61
  v_perm_b32 v60, v13, v11, v70
  v_accvgpr_write_b32 a24, v60
  v_perm_b32 v61, v17, v15, v70
  v_accvgpr_write_b32 a25, v61
  v_perm_b32 v60, v21, v19, v70
  v_accvgpr_write_b32 a26, v60
  v_perm_b32 v61, v25, v23, v70
  v_accvgpr_write_b32 a27, v61
  s_xor_b32 s24, s21, 1
  s_lshl_b32 s24, s24, 20
  s_add_u32 s24, s24, 32768
  s_add_u32 s23, s24, 0
  buffer_load_dwordx2 a[200:201], v62, s[60:63], s23 offen
  s_add_u32 s23, s24, 8192
  buffer_load_dwordx2 a[202:203], v62, s[60:63], s23 offen
  s_add_u32 s23, s24, 131072
  buffer_load_dwordx2 a[208:209], v62, s[60:63], s23 offen
  s_add_u32 s23, s24, 139264
  buffer_load_dwordx2 a[210:211], v62, s[60:63], s23 offen
  s_add_u32 s23, s24, 16384
  buffer_load_dwordx2 v[44:45], v62, s[60:63], s23 offen
  s_add_u32 s23, s24, 24576
  buffer_load_dwordx2 v[46:47], v62, s[60:63], s23 offen
  s_add_u32 s23, s24, 147456
  buffer_load_dwordx2 a[216:217], v62, s[60:63], s23 offen
  s_add_u32 s23, s24, 155648
  buffer_load_dwordx2 a[218:219], v62, s[60:63], s23 offen
  s_waitcnt vmcnt(40)
  s_waitcnt lgkmcnt(0)
  v_accvgpr_read_b32 v10, a4
  v_accvgpr_read_b32 v11, a5
  v_accvgpr_read_b32 v12, a6
  v_accvgpr_read_b32 v13, a7
  v_accvgpr_read_b32 v14, a12
  v_accvgpr_read_b32 v15, a13
  v_accvgpr_read_b32 v16, a14
  v_accvgpr_read_b32 v17, a15
  v_accvgpr_read_b32 v18, a20
  v_accvgpr_read_b32 v19, a21
  v_accvgpr_read_b32 v20, a22
  v_accvgpr_read_b32 v21, a23
  v_accvgpr_read_b32 v22, a28
  v_accvgpr_read_b32 v23, a29
  v_accvgpr_read_b32 v24, a30
  v_accvgpr_read_b32 v25, a31
  v_perm_b32 v60, v12, v10, v69
  v_accvgpr_write_b32 a4, v60
  v_perm_b32 v61, v16, v14, v69
  v_accvgpr_write_b32 a5, v61
  v_perm_b32 v60, v20, v18, v69
  v_accvgpr_write_b32 a6, v60
  v_perm_b32 v61, v24, v22, v69
  v_accvgpr_write_b32 a7, v61
  v_perm_b32 v60, v12, v10, v70
  v_accvgpr_write_b32 a12, v60
  v_perm_b32 v61, v16, v14, v70
  v_accvgpr_write_b32 a13, v61
  v_perm_b32 v60, v20, v18, v70
  v_accvgpr_write_b32 a14, v60
  v_perm_b32 v61, v24, v22, v70
  v_accvgpr_write_b32 a15, v61
  v_perm_b32 v60, v13, v11, v69
  v_accvgpr_write_b32 a20, v60
  v_perm_b32 v61, v17, v15, v69
  v_accvgpr_write_b32 a21, v61
  v_perm_b32 v60, v21, v19, v69
  v_accvgpr_write_b32 a22, v60
  v_perm_b32 v61, v25, v23, v69
  v_accvgpr_write_b32 a23, v61
  v_perm_b32 v60, v13, v11, v70
  v_accvgpr_write_b32 a28, v60
  v_perm_b32 v61, v17, v15, v70
  v_accvgpr_write_b32 a29, v61
  v_perm_b32 v60, v21, v19, v70
  v_accvgpr_write_b32 a30, v60
  v_perm_b32 v61, v25, v23, v70
  v_accvgpr_write_b32 a31, v61
  s_xor_b32 s24, s21, 1
  s_lshl_b32 s24, s24, 20
  s_add_u32 s24, s24, 32768
  s_add_u32 s23, s24, 524288
  buffer_load_dwordx2 a[204:205], v62, s[60:63], s23 offen
  s_add_u32 s23, s24, 532480
  buffer_load_dwordx2 a[206:207], v62, s[60:63], s23 offen
  s_add_u32 s23, s24, 655360
  buffer_load_dwordx2 a[212:213], v62, s[60:63], s23 offen
  s_add_u32 s23, s24, 663552
  buffer_load_dwordx2 a[214:215], v62, s[60:63], s23 offen
  s_add_u32 s23, s24, 540672
  buffer_load_dwordx2 v[48:49], v62, s[60:63], s23 offen
  s_add_u32 s23, s24, 548864
  buffer_load_dwordx2 v[50:51], v62, s[60:63], s23 offen
  s_add_u32 s23, s24, 671744
  buffer_load_dwordx2 a[220:221], v62, s[60:63], s23 offen
  s_add_u32 s23, s24, 679936
  buffer_load_dwordx2 a[222:223], v62, s[60:63], s23 offen
  s_waitcnt vmcnt(40)
  s_waitcnt lgkmcnt(0)
  v_accvgpr_read_b32 v10, a168
  v_accvgpr_read_b32 v11, a169
  v_accvgpr_read_b32 v12, a170
  v_accvgpr_read_b32 v13, a171
  v_accvgpr_read_b32 v14, a176
  v_accvgpr_read_b32 v15, a177
  v_accvgpr_read_b32 v16, a178
  v_accvgpr_read_b32 v17, a179
  v_mov_b64 v[18:19], v[28:29]
  v_mov_b64 v[20:21], v[30:31]
  v_accvgpr_read_b32 v22, a184
  v_accvgpr_read_b32 v23, a185
  v_accvgpr_read_b32 v24, a186
  v_accvgpr_read_b32 v25, a187
  v_perm_b32 v60, v12, v10, v69
  v_accvgpr_write_b32 a168, v60
  v_perm_b32 v61, v16, v14, v69
  v_accvgpr_write_b32 a169, v61
  v_perm_b32 v60, v20, v18, v69
  v_accvgpr_write_b32 a170, v60
  v_perm_b32 v61, v24, v22, v69
  v_accvgpr_write_b32 a171, v61
  v_perm_b32 v60, v12, v10, v70
  v_accvgpr_write_b32 a176, v60
  v_perm_b32 v61, v16, v14, v70
  v_accvgpr_write_b32 a177, v61
  v_perm_b32 v60, v20, v18, v70
  v_accvgpr_write_b32 a178, v60
  v_perm_b32 v61, v24, v22, v70
  v_accvgpr_write_b32 a179, v61
  v_perm_b32 v28, v13, v11, v69
  v_perm_b32 v29, v17, v15, v69
  v_perm_b32 v30, v21, v19, v69
  v_perm_b32 v31, v25, v23, v69
  ds_write_b128 v26, v[28:31] offset:32768
  v_perm_b32 v60, v13, v11, v70
  v_accvgpr_write_b32 a184, v60
  v_perm_b32 v61, v17, v15, v70
  v_accvgpr_write_b32 a185, v61
  v_perm_b32 v60, v21, v19, v70
  v_accvgpr_write_b32 a186, v60
  v_perm_b32 v61, v25, v23, v70
  v_accvgpr_write_b32 a187, v61
  s_xor_b32 s24, s21, 2
  s_lshl_b32 s24, s24, 20
  s_add_u32 s24, s24, 0
  s_add_u32 s23, s24, 0
  buffer_load_dwordx2 a[72:73], v62, s[60:63], s23 offen
  s_add_u32 s23, s24, 8192
  buffer_load_dwordx2 a[74:75], v62, s[60:63], s23 offen
  s_add_u32 s23, s24, 131072
  buffer_load_dwordx2 a[80:81], v62, s[60:63], s23 offen
  s_add_u32 s23, s24, 139264
  buffer_load_dwordx2 a[82:83], v62, s[60:63], s23 offen
  s_add_u32 s23, s24, 16384
  buffer_load_dwordx2 v[52:53], v62, s[60:63], s23 offen
  s_add_u32 s23, s24, 24576
  buffer_load_dwordx2 v[54:55], v62, s[60:63], s23 offen
  s_add_u32 s23, s24, 147456
  buffer_load_dwordx2 a[88:89], v62, s[60:63], s23 offen
  s_add_u32 s23, s24, 155648
  buffer_load_dwordx2 a[90:91], v62, s[60:63], s23 offen
  s_waitcnt vmcnt(40)
  s_waitcnt lgkmcnt(0)
  v_accvgpr_read_b32 v10, a172
  v_accvgpr_read_b32 v11, a173
  v_accvgpr_read_b32 v12, a174
  v_accvgpr_read_b32 v13, a175
  v_accvgpr_read_b32 v14, a180
  v_accvgpr_read_b32 v15, a181
  v_accvgpr_read_b32 v16, a182
  v_accvgpr_read_b32 v17, a183
  v_mov_b64 v[18:19], v[32:33]
  v_mov_b64 v[20:21], v[34:35]
  v_accvgpr_read_b32 v22, a188
  v_accvgpr_read_b32 v23, a189
  v_accvgpr_read_b32 v24, a190
  v_accvgpr_read_b32 v25, a191
  v_perm_b32 v60, v12, v10, v69
  v_accvgpr_write_b32 a172, v60
  v_perm_b32 v61, v16, v14, v69
  v_accvgpr_write_b32 a173, v61
  v_perm_b32 v60, v20, v18, v69
  v_accvgpr_write_b32 a174, v60
  v_perm_b32 v61, v24, v22, v69
  v_accvgpr_write_b32 a175, v61
  v_perm_b32 v60, v12, v10, v70
  v_accvgpr_write_b32 a180, v60
  v_perm_b32 v61, v16, v14, v70
  v_accvgpr_write_b32 a181, v61
  v_perm_b32 v60, v20, v18, v70
  v_accvgpr_write_b32 a182, v60
  v_perm_b32 v61, v24, v22, v70
  v_accvgpr_write_b32 a183, v61
  v_perm_b32 v32, v13, v11, v69
  v_perm_b32 v33, v17, v15, v69
  v_perm_b32 v34, v21, v19, v69
  v_perm_b32 v35, v25, v23, v69
  ds_write_b128 v26, v[32:35] offset:33792
  v_perm_b32 v60, v13, v11, v70
  v_accvgpr_write_b32 a188, v60
  v_perm_b32 v61, v17, v15, v70
  v_accvgpr_write_b32 a189, v61
  v_perm_b32 v60, v21, v19, v70
  v_accvgpr_write_b32 a190, v60
  v_perm_b32 v61, v25, v23, v70
  v_accvgpr_write_b32 a191, v61
  s_xor_b32 s24, s21, 2
  s_lshl_b32 s24, s24, 20
  s_add_u32 s24, s24, 0
  s_add_u32 s23, s24, 524288
  buffer_load_dwordx2 a[76:77], v62, s[60:63], s23 offen
  s_add_u32 s23, s24, 532480
  buffer_load_dwordx2 a[78:79], v62, s[60:63], s23 offen
  s_add_u32 s23, s24, 655360
  buffer_load_dwordx2 a[84:85], v62, s[60:63], s23 offen
  s_add_u32 s23, s24, 663552
  buffer_load_dwordx2 a[86:87], v62, s[60:63], s23 offen
  s_add_u32 s23, s24, 540672
  buffer_load_dwordx2 v[56:57], v62, s[60:63], s23 offen
  s_add_u32 s23, s24, 548864
  buffer_load_dwordx2 v[58:59], v62, s[60:63], s23 offen
  s_add_u32 s23, s24, 671744
  buffer_load_dwordx2 a[92:93], v62, s[60:63], s23 offen
  s_add_u32 s23, s24, 679936
  buffer_load_dwordx2 a[94:95], v62, s[60:63], s23 offen
  s_waitcnt vmcnt(40)
  s_waitcnt lgkmcnt(0)
  v_accvgpr_read_b32 v10, a40
  v_accvgpr_read_b32 v11, a41
  v_accvgpr_read_b32 v12, a42
  v_accvgpr_read_b32 v13, a43
  v_accvgpr_read_b32 v14, a48
  v_accvgpr_read_b32 v15, a49
  v_accvgpr_read_b32 v16, a50
  v_accvgpr_read_b32 v17, a51
  v_mov_b64 v[18:19], v[36:37]
  v_mov_b64 v[20:21], v[38:39]
  v_accvgpr_read_b32 v22, a56
  v_accvgpr_read_b32 v23, a57
  v_accvgpr_read_b32 v24, a58
  v_accvgpr_read_b32 v25, a59
  v_perm_b32 v60, v12, v10, v69
  v_accvgpr_write_b32 a40, v60
  v_perm_b32 v61, v16, v14, v69
  v_accvgpr_write_b32 a41, v61
  v_perm_b32 v60, v20, v18, v69
  v_accvgpr_write_b32 a42, v60
  v_perm_b32 v61, v24, v22, v69
  v_accvgpr_write_b32 a43, v61
  v_perm_b32 v60, v12, v10, v70
  v_accvgpr_write_b32 a48, v60
  v_perm_b32 v61, v16, v14, v70
  v_accvgpr_write_b32 a49, v61
  v_perm_b32 v60, v20, v18, v70
  v_accvgpr_write_b32 a50, v60
  v_perm_b32 v61, v24, v22, v70
  v_accvgpr_write_b32 a51, v61
  v_perm_b32 v36, v13, v11, v69
  v_perm_b32 v37, v17, v15, v69
  v_perm_b32 v38, v21, v19, v69
  v_perm_b32 v39, v25, v23, v69
  ds_write_b128 v1, v[36:39] offset:32768
  v_perm_b32 v60, v13, v11, v70
  v_accvgpr_write_b32 a56, v60
  v_perm_b32 v61, v17, v15, v70
  v_accvgpr_write_b32 a57, v61
  v_perm_b32 v60, v21, v19, v70
  v_accvgpr_write_b32 a58, v60
  v_perm_b32 v61, v25, v23, v70
  v_accvgpr_write_b32 a59, v61
  s_barrier
  s_cmp_lg_u32 s21, 0
  s_cbranch_scc1 L_noarr
  s_lshl_b32 s23, s35, 16
  s_add_u32 s23, s23, 1
  v_mov_b32 v14, s23
  s_mov_b64 exec, 1
  buffer_atomic_add v14, off, s[16:19], 0 offset:60
  s_mov_b64 exec, -1
    L_noarr:
  s_xor_b32 s24, s21, 2
  s_lshl_b32 s24, s24, 20
  s_add_u32 s24, s24, 32768
  s_add_u32 s23, s24, 0
  buffer_load_dwordx2 a[224:225], v62, s[60:63], s23 offen
  s_add_u32 s23, s24, 8192
  buffer_load_dwordx2 a[226:227], v62, s[60:63], s23 offen
  s_add_u32 s23, s24, 131072
  buffer_load_dwordx2 v[28:29], v62, s[60:63], s23 offen
  s_add_u32 s23, s24, 139264
  buffer_load_dwordx2 v[30:31], v62, s[60:63], s23 offen
  s_add_u32 s23, s24, 16384
  buffer_load_dwordx2 a[232:233], v62, s[60:63], s23 offen
  s_add_u32 s23, s24, 24576
  buffer_load_dwordx2 a[234:235], v62, s[60:63], s23 offen
  s_add_u32 s23, s24, 147456
  buffer_load_dwordx2 a[240:241], v62, s[60:63], s23 offen
  s_add_u32 s23, s24, 155648
  buffer_load_dwordx2 a[242:243], v62, s[60:63], s23 offen
  s_waitcnt vmcnt(40)
  s_waitcnt lgkmcnt(0)
  v_accvgpr_read_b32 v10, a44
  v_accvgpr_read_b32 v11, a45
  v_accvgpr_read_b32 v12, a46
  v_accvgpr_read_b32 v13, a47
  v_accvgpr_read_b32 v14, a52
  v_accvgpr_read_b32 v15, a53
  v_accvgpr_read_b32 v16, a54
  v_accvgpr_read_b32 v17, a55
  v_mov_b64 v[18:19], v[40:41]
  v_mov_b64 v[20:21], v[42:43]
  v_accvgpr_read_b32 v22, a60
  v_accvgpr_read_b32 v23, a61
  v_accvgpr_read_b32 v24, a62
  v_accvgpr_read_b32 v25, a63
  v_perm_b32 v60, v12, v10, v69
  v_accvgpr_write_b32 a44, v60
  v_perm_b32 v61, v16, v14, v69
  v_accvgpr_write_b32 a45, v61
  v_perm_b32 v60, v20, v18, v69
  v_accvgpr_write_b32 a46, v60
  v_perm_b32 v61, v24, v22, v69
  v_accvgpr_write_b32 a47, v61
  v_perm_b32 v60, v12, v10, v70
  v_accvgpr_write_b32 a52, v60
  v_perm_b32 v61, v16, v14, v70
  v_accvgpr_write_b32 a53, v61
  v_perm_b32 v60, v20, v18, v70
  v_accvgpr_write_b32 a54, v60
  v_perm_b32 v61, v24, v22, v70
  v_accvgpr_write_b32 a55, v61
  v_perm_b32 v40, v13, v11, v69
  v_perm_b32 v41, v17, v15, v69
  v_perm_b32 v42, v21, v19, v69
  v_perm_b32 v43, v25, v23, v69
  ds_write_b128 v1, v[40:43] offset:33792
  v_perm_b32 v60, v13, v11, v70
  v_accvgpr_write_b32 a60, v60
  v_perm_b32 v61, v17, v15, v70
  v_accvgpr_write_b32 a61, v61
  v_perm_b32 v60, v21, v19, v70
  v_accvgpr_write_b32 a62, v60
  v_perm_b32 v61, v25, v23, v70
  v_accvgpr_write_b32 a63, v61
  ds_read_b128 v[10:13], v1 offset:1024
  s_lshl_b32 s43, s20, 13
  s_add_u32 s43, s43, 1703936
  s_waitcnt lgkmcnt(0)
  buffer_store_dwordx4 v[10:13], v1, s[8:11], s43 offen offset:1024
  s_nop 1
  s_xor_b32 s24, s21, 2
  s_lshl_b32 s24, s24, 20
  s_add_u32 s24, s24, 32768
  s_add_u32 s23, s24, 524288
  buffer_load_dwordx2 a[228:229], v62, s[60:63], s23 offen
  s_add_u32 s23, s24, 532480
  buffer_load_dwordx2 a[230:231], v62, s[60:63], s23 offen
  s_add_u32 s23, s24, 655360
  buffer_load_dwordx2 v[32:33], v62, s[60:63], s23 offen
  s_add_u32 s23, s24, 663552
  buffer_load_dwordx2 v[34:35], v62, s[60:63], s23 offen
  s_add_u32 s23, s24, 540672
  buffer_load_dwordx2 a[236:237], v62, s[60:63], s23 offen
  s_add_u32 s23, s24, 548864
  buffer_load_dwordx2 a[238:239], v62, s[60:63], s23 offen
  s_add_u32 s23, s24, 671744
  buffer_load_dwordx2 a[244:245], v62, s[60:63], s23 offen
  s_add_u32 s23, s24, 679936
  buffer_load_dwordx2 a[246:247], v62, s[60:63], s23 offen
  s_waitcnt vmcnt(40)
  s_waitcnt lgkmcnt(0)
  v_accvgpr_read_b32 v10, a200
  v_accvgpr_read_b32 v11, a201
  v_accvgpr_read_b32 v12, a202
  v_accvgpr_read_b32 v13, a203
  v_accvgpr_read_b32 v14, a208
  v_accvgpr_read_b32 v15, a209
  v_accvgpr_read_b32 v16, a210
  v_accvgpr_read_b32 v17, a211
  v_mov_b64 v[18:19], v[44:45]
  v_mov_b64 v[20:21], v[46:47]
  v_accvgpr_read_b32 v22, a216
  v_accvgpr_read_b32 v23, a217
  v_accvgpr_read_b32 v24, a218
  v_accvgpr_read_b32 v25, a219
  v_perm_b32 v60, v12, v10, v69
  v_accvgpr_write_b32 a200, v60
  v_perm_b32 v61, v16, v14, v69
  v_accvgpr_write_b32 a201, v61
  v_perm_b32 v60, v20, v18, v69
  v_accvgpr_write_b32 a202, v60
  v_perm_b32 v61, v24, v22, v69
  v_accvgpr_write_b32 a203, v61
  v_perm_b32 v60, v12, v10, v70
  v_accvgpr_write_b32 a208, v60
  v_perm_b32 v61, v16, v14, v70
  v_accvgpr_write_b32 a209, v61
  v_perm_b32 v60, v20, v18, v70
  v_accvgpr_write_b32 a210, v60
  v_perm_b32 v61, v24, v22, v70
  v_accvgpr_write_b32 a211, v61
  v_perm_b32 v44, v13, v11, v69
  v_perm_b32 v45, v17, v15, v69
  v_perm_b32 v46, v21, v19, v69
  v_perm_b32 v47, v25, v23, v69
  ds_write_b128 v26, v[44:47] offset:49152
  v_perm_b32 v60, v13, v11, v70
  v_accvgpr_write_b32 a216, v60
  v_perm_b32 v61, v17, v15, v70
  v_accvgpr_write_b32 a217, v61
  v_perm_b32 v60, v21, v19, v70
  v_accvgpr_write_b32 a218, v60
  v_perm_b32 v61, v25, v23, v70
  v_accvgpr_write_b32 a219, v61
  s_xor_b32 s24, s21, 3
  s_lshl_b32 s24, s24, 20
  s_add_u32 s24, s24, 0
  s_add_u32 s23, s24, 0
  buffer_load_dwordx2 a[104:105], v62, s[60:63], s23 offen
  s_add_u32 s23, s24, 8192
  buffer_load_dwordx2 a[106:107], v62, s[60:63], s23 offen
  s_add_u32 s23, s24, 131072
  buffer_load_dwordx2 a[112:113], v62, s[60:63], s23 offen
  s_add_u32 s23, s24, 139264
  buffer_load_dwordx2 a[114:115], v62, s[60:63], s23 offen
  s_add_u32 s23, s24, 16384
  buffer_load_dwordx2 v[36:37], v62, s[60:63], s23 offen
  s_add_u32 s23, s24, 24576
  buffer_load_dwordx2 v[38:39], v62, s[60:63], s23 offen
  s_add_u32 s23, s24, 147456
  buffer_load_dwordx2 a[120:121], v62, s[60:63], s23 offen
  s_add_u32 s23, s24, 155648
  buffer_load_dwordx2 a[122:123], v62, s[60:63], s23 offen
  s_waitcnt vmcnt(40)
  s_waitcnt lgkmcnt(0)
  v_accvgpr_read_b32 v10, a204
  v_accvgpr_read_b32 v11, a205
  v_accvgpr_read_b32 v12, a206
  v_accvgpr_read_b32 v13, a207
  v_accvgpr_read_b32 v14, a212
  v_accvgpr_read_b32 v15, a213
  v_accvgpr_read_b32 v16, a214
  v_accvgpr_read_b32 v17, a215
  v_mov_b64 v[18:19], v[48:49]
  v_mov_b64 v[20:21], v[50:51]
  v_accvgpr_read_b32 v22, a220
  v_accvgpr_read_b32 v23, a221
  v_accvgpr_read_b32 v24, a222
  v_accvgpr_read_b32 v25, a223
  v_perm_b32 v60, v12, v10, v69
  v_accvgpr_write_b32 a204, v60
  v_perm_b32 v61, v16, v14, v69
  v_accvgpr_write_b32 a205, v61
  v_perm_b32 v60, v20, v18, v69
  v_accvgpr_write_b32 a206, v60
  v_perm_b32 v61, v24, v22, v69
  v_accvgpr_write_b32 a207, v61
  v_perm_b32 v60, v12, v10, v70
  v_accvgpr_write_b32 a212, v60
  v_perm_b32 v61, v16, v14, v70
  v_accvgpr_write_b32 a213, v61
  v_perm_b32 v60, v20, v18, v70
  v_accvgpr_write_b32 a214, v60
  v_perm_b32 v61, v24, v22, v70
  v_accvgpr_write_b32 a215, v61
  v_perm_b32 v48, v13, v11, v69
  v_perm_b32 v49, v17, v15, v69
  v_perm_b32 v50, v21, v19, v69
  v_perm_b32 v51, v25, v23, v69
  ds_write_b128 v26, v[48:51] offset:50176
  v_perm_b32 v60, v13, v11, v70
  v_accvgpr_write_b32 a220, v60
  v_perm_b32 v61, v17, v15, v70
  v_accvgpr_write_b32 a221, v61
  v_perm_b32 v60, v21, v19, v70
  v_accvgpr_write_b32 a222, v60
  v_perm_b32 v61, v25, v23, v70
  v_accvgpr_write_b32 a223, v61
  s_xor_b32 s24, s21, 3
  s_lshl_b32 s24, s24, 20
  s_add_u32 s24, s24, 0
  s_add_u32 s23, s24, 524288
  buffer_load_dwordx2 a[108:109], v62, s[60:63], s23 offen
  s_add_u32 s23, s24, 532480
  buffer_load_dwordx2 a[110:111], v62, s[60:63], s23 offen
  s_add_u32 s23, s24, 655360
  buffer_load_dwordx2 a[116:117], v62, s[60:63], s23 offen
  s_add_u32 s23, s24, 663552
  buffer_load_dwordx2 a[118:119], v62, s[60:63], s23 offen
  s_add_u32 s23, s24, 540672
  buffer_load_dwordx2 v[40:41], v62, s[60:63], s23 offen
  s_add_u32 s23, s24, 548864
  buffer_load_dwordx2 v[42:43], v62, s[60:63], s23 offen
  s_add_u32 s23, s24, 671744
  buffer_load_dwordx2 a[124:125], v62, s[60:63], s23 offen
  s_add_u32 s23, s24, 679936
  buffer_load_dwordx2 a[126:127], v62, s[60:63], s23 offen
  s_waitcnt vmcnt(40)
  s_waitcnt lgkmcnt(0)
  v_accvgpr_read_b32 v10, a72
  v_accvgpr_read_b32 v11, a73
  v_accvgpr_read_b32 v12, a74
  v_accvgpr_read_b32 v13, a75
  v_accvgpr_read_b32 v14, a80
  v_accvgpr_read_b32 v15, a81
  v_accvgpr_read_b32 v16, a82
  v_accvgpr_read_b32 v17, a83
  v_mov_b64 v[18:19], v[52:53]
  v_mov_b64 v[20:21], v[54:55]
  v_accvgpr_read_b32 v22, a88
  v_accvgpr_read_b32 v23, a89
  v_accvgpr_read_b32 v24, a90
  v_accvgpr_read_b32 v25, a91
  v_perm_b32 v60, v12, v10, v69
  v_accvgpr_write_b32 a72, v60
  v_perm_b32 v61, v16, v14, v69
  v_accvgpr_write_b32 a73, v61
  v_perm_b32 v60, v20, v18, v69
  v_accvgpr_write_b32 a74, v60
  v_perm_b32 v61, v24, v22, v69
  v_accvgpr_write_b32 a75, v61
  v_perm_b32 v60, v12, v10, v70
  v_accvgpr_write_b32 a80, v60
  v_perm_b32 v61, v16, v14, v70
  v_accvgpr_write_b32 a81, v61
  v_perm_b32 v60, v20, v18, v70
  v_accvgpr_write_b32 a82, v60
  v_perm_b32 v61, v24, v22, v70
  v_accvgpr_write_b32 a83, v61
  v_perm_b32 v52, v13, v11, v69
  v_perm_b32 v53, v17, v15, v69
  v_perm_b32 v54, v21, v19, v69
  v_perm_b32 v55, v25, v23, v69
  ds_write_b128 v1, v[52:55] offset:49152
  v_perm_b32 v60, v13, v11, v70
  v_accvgpr_write_b32 a88, v60
  v_perm_b32 v61, v17, v15, v70
  v_accvgpr_write_b32 a89, v61
  v_perm_b32 v60, v21, v19, v70
  v_accvgpr_write_b32 a90, v60
  v_perm_b32 v61, v25, v23, v70
  v_accvgpr_write_b32 a91, v61
  s_xor_b32 s24, s21, 3
  s_lshl_b32 s24, s24, 20
  s_add_u32 s24, s24, 32768
  s_add_u32 s23, s24, 0
  buffer_load_dwordx2 v[44:45], v62, s[60:63], s23 offen
  s_add_u32 s23, s24, 8192
  buffer_load_dwordx2 v[46:47], v62, s[60:63], s23 offen
  s_add_u32 s23, s24, 131072
  buffer_load_dwordx2 a[248:249], v62, s[60:63], s23 offen
  s_add_u32 s23, s24, 139264
  buffer_load_dwordx2 a[250:251], v62, s[60:63], s23 offen
  s_add_u32 s23, s24, 16384
  buffer_load_dwordx2 v[72:73], v62, s[60:63], s23 offen
  s_add_u32 s23, s24, 24576
  buffer_load_dwordx2 v[74:75], v62, s[60:63], s23 offen
  s_add_u32 s23, s24, 147456
  buffer_load_dwordx2 v[48:49], v62, s[60:63], s23 offen
  s_add_u32 s23, s24, 155648
  buffer_load_dwordx2 v[50:51], v62, s[60:63], s23 offen
  s_waitcnt vmcnt(40)
  s_waitcnt lgkmcnt(0)
  v_accvgpr_read_b32 v10, a76
  v_accvgpr_read_b32 v11, a77
  v_accvgpr_read_b32 v12, a78
  v_accvgpr_read_b32 v13, a79
  v_accvgpr_read_b32 v14, a84
  v_accvgpr_read_b32 v15, a85
  v_accvgpr_read_b32 v16, a86
  v_accvgpr_read_b32 v17, a87
  v_mov_b64 v[18:19], v[56:57]
  v_mov_b64 v[20:21], v[58:59]
  v_accvgpr_read_b32 v22, a92
  v_accvgpr_read_b32 v23, a93
  v_accvgpr_read_b32 v24, a94
  v_accvgpr_read_b32 v25, a95
  v_perm_b32 v60, v12, v10, v69
  v_accvgpr_write_b32 a76, v60
  v_perm_b32 v61, v16, v14, v69
  v_accvgpr_write_b32 a77, v61
  v_perm_b32 v60, v20, v18, v69
  v_accvgpr_write_b32 a78, v60
  v_perm_b32 v61, v24, v22, v69
  v_accvgpr_write_b32 a79, v61
  v_perm_b32 v60, v12, v10, v70
  v_accvgpr_write_b32 a84, v60
  v_perm_b32 v61, v16, v14, v70
  v_accvgpr_write_b32 a85, v61
  v_perm_b32 v60, v20, v18, v70
  v_accvgpr_write_b32 a86, v60
  v_perm_b32 v61, v24, v22, v70
  v_accvgpr_write_b32 a87, v61
  v_perm_b32 v56, v13, v11, v69
  v_perm_b32 v57, v17, v15, v69
  v_perm_b32 v58, v21, v19, v69
  v_perm_b32 v59, v25, v23, v69
  ds_write_b128 v1, v[56:59] offset:50176
  v_perm_b32 v60, v13, v11, v70
  v_accvgpr_write_b32 a92, v60
  v_perm_b32 v61, v17, v15, v70
  v_accvgpr_write_b32 a93, v61
  v_perm_b32 v60, v21, v19, v70
  v_accvgpr_write_b32 a94, v60
  v_perm_b32 v61, v25, v23, v70
  v_accvgpr_write_b32 a95, v61
  s_xor_b32 s24, s21, 3
  s_lshl_b32 s24, s24, 20
  s_add_u32 s24, s24, 32768
  s_add_u32 s23, s24, 524288
  buffer_load_dwordx2 v[52:53], v62, s[60:63], s23 offen
  s_add_u32 s23, s24, 532480
  buffer_load_dwordx2 v[54:55], v62, s[60:63], s23 offen
  s_add_u32 s23, s24, 655360
  buffer_load_dwordx2 a[252:253], v62, s[60:63], s23 offen
  s_add_u32 s23, s24, 663552
  buffer_load_dwordx2 a[254:255], v62, s[60:63], s23 offen
  s_add_u32 s23, s24, 540672
  buffer_load_dwordx2 v[76:77], v62, s[60:63], s23 offen
  s_add_u32 s23, s24, 548864
  buffer_load_dwordx2 v[78:79], v62, s[60:63], s23 offen
  s_add_u32 s23, s24, 671744
  buffer_load_dwordx2 v[56:57], v62, s[60:63], s23 offen
  s_add_u32 s23, s24, 679936
  buffer_load_dwordx2 v[58:59], v62, s[60:63], s23 offen
  s_waitcnt vmcnt(40)
  s_waitcnt lgkmcnt(0)
  v_accvgpr_read_b32 v10, a224
  v_accvgpr_read_b32 v11, a225
  v_accvgpr_read_b32 v12, a226
  v_accvgpr_read_b32 v13, a227
  v_mov_b64 v[14:15], v[28:29]
  v_mov_b64 v[16:17], v[30:31]
  v_accvgpr_read_b32 v18, a232
  v_accvgpr_read_b32 v19, a233
  v_accvgpr_read_b32 v20, a234
  v_accvgpr_read_b32 v21, a235
  v_accvgpr_read_b32 v22, a240
  v_accvgpr_read_b32 v23, a241
  v_accvgpr_read_b32 v24, a242
  v_accvgpr_read_b32 v25, a243
  v_perm_b32 v60, v12, v10, v69
  v_accvgpr_write_b32 a224, v60
  v_perm_b32 v61, v16, v14, v69
  v_accvgpr_write_b32 a225, v61
  v_perm_b32 v60, v20, v18, v69
  v_accvgpr_write_b32 a226, v60
  v_perm_b32 v61, v24, v22, v69
  v_accvgpr_write_b32 a227, v61
  v_perm_b32 v28, v12, v10, v70
  v_perm_b32 v29, v16, v14, v70
  v_perm_b32 v30, v20, v18, v70
  v_perm_b32 v31, v24, v22, v70
  ds_write_b128 v26, v[28:31] offset:57344
  v_perm_b32 v60, v13, v11, v69
  v_accvgpr_write_b32 a232, v60
  v_perm_b32 v61, v17, v15, v69
  v_accvgpr_write_b32 a233, v61
  v_perm_b32 v60, v21, v19, v69
  v_accvgpr_write_b32 a234, v60
  v_perm_b32 v61, v25, v23, v69
  v_accvgpr_write_b32 a235, v61
  v_perm_b32 v60, v13, v11, v70
  v_accvgpr_write_b32 a240, v60
  v_perm_b32 v61, v17, v15, v70
  v_accvgpr_write_b32 a241, v61
  v_perm_b32 v60, v21, v19, v70
  v_accvgpr_write_b32 a242, v60
  v_perm_b32 v61, v25, v23, v70
  v_accvgpr_write_b32 a243, v61
  s_mov_b32 s24, 4194304
  s_add_u32 s23, s24, 0
  buffer_load_dwordx2 a[136:137], v63, s[60:63], s23 offen
  s_add_u32 s23, s24, 8192
  buffer_load_dwordx2 a[138:139], v63, s[60:63], s23 offen
  s_add_u32 s23, s24, 65536
  buffer_load_dwordx2 a[144:145], v63, s[60:63], s23 offen
  s_add_u32 s23, s24, 73728
  buffer_load_dwordx2 a[146:147], v63, s[60:63], s23 offen
  s_add_u32 s23, s24, 16384
  buffer_load_dwordx2 v[28:29], v63, s[60:63], s23 offen
  s_add_u32 s23, s24, 24576
  buffer_load_dwordx2 v[30:31], v63, s[60:63], s23 offen
  s_add_u32 s23, s24, 81920
  buffer_load_dwordx2 a[152:153], v63, s[60:63], s23 offen
  s_add_u32 s23, s24, 90112
  buffer_load_dwordx2 a[154:155], v63, s[60:63], s23 offen
  s_waitcnt vmcnt(40)
  s_waitcnt lgkmcnt(0)
  v_accvgpr_read_b32 v10, a228
  v_accvgpr_read_b32 v11, a229
  v_accvgpr_read_b32 v12, a230
  v_accvgpr_read_b32 v13, a231
  v_mov_b64 v[14:15], v[32:33]
  v_mov_b64 v[16:17], v[34:35]
  v_accvgpr_read_b32 v18, a236
  v_accvgpr_read_b32 v19, a237
  v_accvgpr_read_b32 v20, a238
  v_accvgpr_read_b32 v21, a239
  v_accvgpr_read_b32 v22, a244
  v_accvgpr_read_b32 v23, a245
  v_accvgpr_read_b32 v24, a246
  v_accvgpr_read_b32 v25, a247
  v_perm_b32 v60, v12, v10, v69
  v_accvgpr_write_b32 a228, v60
  v_perm_b32 v61, v16, v14, v69
  v_accvgpr_write_b32 a229, v61
  v_perm_b32 v60, v20, v18, v69
  v_accvgpr_write_b32 a230, v60
  v_perm_b32 v61, v24, v22, v69
  v_accvgpr_write_b32 a231, v61
  v_perm_b32 v32, v12, v10, v70
  v_perm_b32 v33, v16, v14, v70
  v_perm_b32 v34, v20, v18, v70
  v_perm_b32 v35, v24, v22, v70
  ds_write_b128 v26, v[32:35] offset:58368
  v_perm_b32 v60, v13, v11, v69
  v_accvgpr_write_b32 a236, v60
  v_perm_b32 v61, v17, v15, v69
  v_accvgpr_write_b32 a237, v61
  v_perm_b32 v60, v21, v19, v69
  v_accvgpr_write_b32 a238, v60
  v_perm_b32 v61, v25, v23, v69
  v_accvgpr_write_b32 a239, v61
  v_perm_b32 v60, v13, v11, v70
  v_accvgpr_write_b32 a244, v60
  v_perm_b32 v61, v17, v15, v70
  v_accvgpr_write_b32 a245, v61
  v_perm_b32 v60, v21, v19, v70
  v_accvgpr_write_b32 a246, v60
  v_perm_b32 v61, v25, v23, v70
  v_accvgpr_write_b32 a247, v61
  s_mov_b32 s24, 4194304
  s_add_u32 s23, s24, 262144
  buffer_load_dwordx2 a[140:141], v63, s[60:63], s23 offen
  s_add_u32 s23, s24, 270336
  buffer_load_dwordx2 a[142:143], v63, s[60:63], s23 offen
  s_add_u32 s23, s24, 327680
  buffer_load_dwordx2 a[148:149], v63, s[60:63], s23 offen
  s_add_u32 s23, s24, 335872
  buffer_load_dwordx2 a[150:151], v63, s[60:63], s23 offen
  s_add_u32 s23, s24, 278528
  buffer_load_dwordx2 v[32:33], v63, s[60:63], s23 offen
  s_add_u32 s23, s24, 286720
  buffer_load_dwordx2 v[34:35], v63, s[60:63], s23 offen
  s_add_u32 s23, s24, 344064
  buffer_load_dwordx2 a[156:157], v63, s[60:63], s23 offen
  s_add_u32 s23, s24, 352256
  buffer_load_dwordx2 a[158:159], v63, s[60:63], s23 offen
  s_waitcnt vmcnt(40)
  s_waitcnt lgkmcnt(0)
  v_accvgpr_read_b32 v10, a104
  v_accvgpr_read_b32 v11, a105
  v_accvgpr_read_b32 v12, a106
  v_accvgpr_read_b32 v13, a107
  v_accvgpr_read_b32 v14, a112
  v_accvgpr_read_b32 v15, a113
  v_accvgpr_read_b32 v16, a114
  v_accvgpr_read_b32 v17, a115
  v_mov_b64 v[18:19], v[36:37]
  v_mov_b64 v[20:21], v[38:39]
  v_accvgpr_read_b32 v22, a120
  v_accvgpr_read_b32 v23, a121
  v_accvgpr_read_b32 v24, a122
  v_accvgpr_read_b32 v25, a123
  v_perm_b32 v60, v12, v10, v69
  v_accvgpr_write_b32 a104, v60
  v_perm_b32 v61, v16, v14, v69
  v_accvgpr_write_b32 a105, v61
  v_perm_b32 v60, v20, v18, v69
  v_accvgpr_write_b32 a106, v60
  v_perm_b32 v61, v24, v22, v69
  v_accvgpr_write_b32 a107, v61
  v_perm_b32 v60, v12, v10, v70
  v_accvgpr_write_b32 a112, v60
  v_perm_b32 v61, v16, v14, v70
  v_accvgpr_write_b32 a113, v61
  v_perm_b32 v60, v20, v18, v70
  v_accvgpr_write_b32 a114, v60
  v_perm_b32 v61, v24, v22, v70
  v_accvgpr_write_b32 a115, v61
  v_perm_b32 v36, v13, v11, v69
  v_perm_b32 v37, v17, v15, v69
  v_perm_b32 v38, v21, v19, v69
  v_perm_b32 v39, v25, v23, v69
  ds_write_b128 v26, v[36:39] offset:0
  v_perm_b32 v60, v13, v11, v70
  v_accvgpr_write_b32 a120, v60
  v_perm_b32 v61, v17, v15, v70
  v_accvgpr_write_b32 a121, v61
  v_perm_b32 v60, v21, v19, v70
  v_accvgpr_write_b32 a122, v60
  v_perm_b32 v61, v25, v23, v70
  v_accvgpr_write_b32 a123, v61
  s_waitcnt vmcnt(32)
  s_waitcnt lgkmcnt(0)
  v_accvgpr_read_b32 v10, a108
  v_accvgpr_read_b32 v11, a109
  v_accvgpr_read_b32 v12, a110
  v_accvgpr_read_b32 v13, a111
  v_accvgpr_read_b32 v14, a116
  v_accvgpr_read_b32 v15, a117
  v_accvgpr_read_b32 v16, a118
  v_accvgpr_read_b32 v17, a119
  v_mov_b64 v[18:19], v[40:41]
  v_mov_b64 v[20:21], v[42:43]
  v_accvgpr_read_b32 v22, a124
  v_accvgpr_read_b32 v23, a125
  v_accvgpr_read_b32 v24, a126
  v_accvgpr_read_b32 v25, a127
  v_perm_b32 v60, v12, v10, v69
  v_accvgpr_write_b32 a108, v60
  v_perm_b32 v61, v16, v14, v69
  v_accvgpr_write_b32 a109, v61
  v_perm_b32 v60, v20, v18, v69
  v_accvgpr_write_b32 a110, v60
  v_perm_b32 v61, v24, v22, v69
  v_accvgpr_write_b32 a111, v61
  v_perm_b32 v60, v12, v10, v70
  v_accvgpr_write_b32 a116, v60
  v_perm_b32 v61, v16, v14, v70
  v_accvgpr_write_b32 a117, v61
  v_perm_b32 v60, v20, v18, v70
  v_accvgpr_write_b32 a118, v60
  v_perm_b32 v61, v24, v22, v70
  v_accvgpr_write_b32 a119, v61
  v_perm_b32 v40, v13, v11, v69
  v_perm_b32 v41, v17, v15, v69
  v_perm_b32 v42, v21, v19, v69
  v_perm_b32 v43, v25, v23, v69
  ds_write_b128 v26, v[40:43] offset:1024
  v_perm_b32 v60, v13, v11, v70
  v_accvgpr_write_b32 a124, v60
  v_perm_b32 v61, v17, v15, v70
  v_accvgpr_write_b32 a125, v61
  v_perm_b32 v60, v21, v19, v70
  v_accvgpr_write_b32 a126, v60
  v_perm_b32 v61, v25, v23, v70
  v_accvgpr_write_b32 a127, v61
  s_xor_b32 s24, s21, 0
  s_lshl_b32 s24, s24, 20
  s_add_u32 s24, s24, 0
  s_add_u32 s23, s24, 0
  buffer_load_dword a32, v64, s[64:67], s23 offen
  s_add_u32 s23, s24, 8192
  buffer_load_dword a33, v64, s[64:67], s23 offen
  s_add_u32 s23, s24, 131072
  buffer_load_dword a34, v64, s[64:67], s23 offen
  s_add_u32 s23, s24, 139264
  buffer_load_dword a35, v64, s[64:67], s23 offen
  s_add_u32 s23, s24, 16384
  buffer_load_dword a36, v64, s[64:67], s23 offen
  s_add_u32 s23, s24, 24576
  buffer_load_dword a37, v64, s[64:67], s23 offen
  s_add_u32 s23, s24, 147456
  buffer_load_dword a38, v64, s[64:67], s23 offen
  s_add_u32 s23, s24, 155648
  buffer_load_dword a39, v64, s[64:67], s23 offen
  s_add_u32 s23, s24, 524288
  buffer_load_dword v36, v64, s[64:67], s23 offen
  s_add_u32 s23, s24, 532480
  buffer_load_dword v37, v64, s[64:67], s23 offen
  s_add_u32 s23, s24, 655360
  buffer_load_dword v38, v64, s[64:67], s23 offen
  s_add_u32 s23, s24, 663552
  buffer_load_dword v39, v64, s[64:67], s23 offen
  s_add_u32 s23, s24, 540672
  buffer_load_dword v40, v64, s[64:67], s23 offen
  s_add_u32 s23, s24, 548864
  buffer_load_dword v41, v64, s[64:67], s23 offen
  s_add_u32 s23, s24, 671744
  buffer_load_dword v42, v64, s[64:67], s23 offen
  s_add_u32 s23, s24, 679936
  buffer_load_dword v43, v64, s[64:67], s23 offen
  s_waitcnt vmcnt(40)
  s_waitcnt lgkmcnt(0)
  v_mov_b64 v[10:11], v[44:45]
  v_mov_b64 v[12:13], v[46:47]
  v_accvgpr_read_b32 v14, a248
  v_accvgpr_read_b32 v15, a249
  v_accvgpr_read_b32 v16, a250
  v_accvgpr_read_b32 v17, a251
  v_mov_b64 v[18:19], v[72:73]
  v_mov_b64 v[20:21], v[74:75]
  v_mov_b64 v[22:23], v[48:49]
  v_mov_b64 v[24:25], v[50:51]
  v_perm_b32 v44, v12, v10, v69
  v_perm_b32 v45, v16, v14, v69
  v_perm_b32 v46, v20, v18, v69
  v_perm_b32 v47, v24, v22, v69
  ds_write_b128 v27, v[44:47] offset:0
  v_perm_b32 v60, v12, v10, v70
  v_accvgpr_write_b32 a248, v60
  v_perm_b32 v61, v16, v14, v70
  v_accvgpr_write_b32 a249, v61
  v_perm_b32 v60, v20, v18, v70
  v_accvgpr_write_b32 a250, v60
  v_perm_b32 v61, v24, v22, v70
  v_accvgpr_write_b32 a251, v61
  v_perm_b32 v72, v13, v11, v69
  v_perm_b32 v73, v17, v15, v69
  v_perm_b32 v74, v21, v19, v69
  v_perm_b32 v75, v25, v23, v69
  v_perm_b32 v48, v13, v11, v70
  v_perm_b32 v49, v17, v15, v70
  v_perm_b32 v50, v21, v19, v70
  v_perm_b32 v51, v25, v23, v70
  ds_write_b128 v27, v[48:51] offset:8192
  s_waitcnt vmcnt(32)
  s_waitcnt lgkmcnt(0)
  v_mov_b64 v[10:11], v[52:53]
  v_mov_b64 v[12:13], v[54:55]
  v_accvgpr_read_b32 v14, a252
  v_accvgpr_read_b32 v15, a253
  v_accvgpr_read_b32 v16, a254
  v_accvgpr_read_b32 v17, a255
  v_mov_b64 v[18:19], v[76:77]
  v_mov_b64 v[20:21], v[78:79]
  v_mov_b64 v[22:23], v[56:57]
  v_mov_b64 v[24:25], v[58:59]
  v_perm_b32 v52, v12, v10, v69
  v_perm_b32 v53, v16, v14, v69
  v_perm_b32 v54, v20, v18, v69
  v_perm_b32 v55, v24, v22, v69
  ds_write_b128 v27, v[52:55] offset:1024
  v_perm_b32 v60, v12, v10, v70
  v_accvgpr_write_b32 a252, v60
  v_perm_b32 v61, v16, v14, v70
  v_accvgpr_write_b32 a253, v61
  v_perm_b32 v60, v20, v18, v70
  v_accvgpr_write_b32 a254, v60
  v_perm_b32 v61, v24, v22, v70
  v_accvgpr_write_b32 a255, v61
  v_perm_b32 v76, v13, v11, v69
  v_perm_b32 v77, v17, v15, v69
  v_perm_b32 v78, v21, v19, v69
  v_perm_b32 v79, v25, v23, v69
  v_perm_b32 v56, v13, v11, v70
  v_perm_b32 v57, v17, v15, v70
  v_perm_b32 v58, v21, v19, v70
  v_perm_b32 v59, v25, v23, v70
  ds_write_b128 v27, v[56:59] offset:9216
  s_xor_b32 s24, s21, 0
  s_lshl_b32 s24, s24, 20
  s_add_u32 s24, s24, 32768
  s_add_u32 s23, s24, 0
  buffer_load_dword a192, v64, s[64:67], s23 offen
  s_add_u32 s23, s24, 8192
  buffer_load_dword a193, v64, s[64:67], s23 offen
  s_add_u32 s23, s24, 131072
  buffer_load_dword a194, v64, s[64:67], s23 offen
  s_add_u32 s23, s24, 139264
  buffer_load_dword a195, v64, s[64:67], s23 offen
  s_add_u32 s23, s24, 16384
  buffer_load_dword a196, v64, s[64:67], s23 offen
  s_add_u32 s23, s24, 24576
  buffer_load_dword a197, v64, s[64:67], s23 offen
  s_add_u32 s23, s24, 147456
  buffer_load_dword a198, v64, s[64:67], s23 offen
  s_add_u32 s23, s24, 155648
  buffer_load_dword a199, v64, s[64:67], s23 offen
  s_add_u32 s23, s24, 524288
  buffer_load_dword v44, v64, s[64:67], s23 offen
  s_add_u32 s23, s24, 532480
  buffer_load_dword v45, v64, s[64:67], s23 offen
  s_add_u32 s23, s24, 655360
  buffer_load_dword v46, v64, s[64:67], s23 offen
  s_add_u32 s23, s24, 663552
  buffer_load_dword v47, v64, s[64:67], s23 offen
  s_add_u32 s23, s24, 540672
  buffer_load_dword v48, v64, s[64:67], s23 offen
  s_add_u32 s23, s24, 548864
  buffer_load_dword v49, v64, s[64:67], s23 offen
  s_add_u32 s23, s24, 671744
  buffer_load_dword v50, v64, s[64:67], s23 offen
  s_add_u32 s23, s24, 679936
  buffer_load_dword v51, v64, s[64:67], s23 offen
  s_waitcnt vmcnt(40)
  s_waitcnt lgkmcnt(0)
  v_accvgpr_read_b32 v10, a136
  v_accvgpr_read_b32 v11, a137
  v_accvgpr_read_b32 v12, a138
  v_accvgpr_read_b32 v13, a139
  v_accvgpr_read_b32 v14, a144
  v_accvgpr_read_b32 v15, a145
  v_accvgpr_read_b32 v16, a146
  v_accvgpr_read_b32 v17, a147
  v_mov_b64 v[18:19], v[28:29]
  v_mov_b64 v[20:21], v[30:31]
  v_accvgpr_read_b32 v22, a152
  v_accvgpr_read_b32 v23, a153
  v_accvgpr_read_b32 v24, a154
  v_accvgpr_read_b32 v25, a155
  v_perm_b32 v60, v12, v10, v69
  v_accvgpr_write_b32 a136, v60
  v_perm_b32 v61, v16, v14, v69
  v_accvgpr_write_b32 a137, v61
  v_perm_b32 v60, v20, v18, v69
  v_accvgpr_write_b32 a138, v60
  v_perm_b32 v61, v24, v22, v69
  v_accvgpr_write_b32 a139, v61
  v_perm_b32 v60, v12, v10, v70
  v_accvgpr_write_b32 a144, v60
  v_perm_b32 v61, v16, v14, v70
  v_accvgpr_write_b32 a145, v61
  v_perm_b32 v60, v20, v18, v70
  v_accvgpr_write_b32 a146, v60
  v_perm_b32 v61, v24, v22, v70
  v_accvgpr_write_b32 a147, v61
  v_perm_b32 v28, v13, v11, v69
  v_perm_b32 v29, v17, v15, v69
  v_perm_b32 v30, v21, v19, v69
  v_perm_b32 v31, v25, v23, v69
  ds_write_b128 v26, v[28:31] offset:16384
  v_perm_b32 v60, v13, v11, v70
  v_accvgpr_write_b32 a152, v60
  v_perm_b32 v61, v17, v15, v70
  v_accvgpr_write_b32 a153, v61
  v_perm_b32 v60, v21, v19, v70
  v_accvgpr_write_b32 a154, v60
  v_perm_b32 v61, v25, v23, v70
  v_accvgpr_write_b32 a155, v61
  s_waitcnt vmcnt(32)
  s_waitcnt lgkmcnt(0)
  v_accvgpr_read_b32 v10, a140
  v_accvgpr_read_b32 v11, a141
  v_accvgpr_read_b32 v12, a142
  v_accvgpr_read_b32 v13, a143
  v_accvgpr_read_b32 v14, a148
  v_accvgpr_read_b32 v15, a149
  v_accvgpr_read_b32 v16, a150
  v_accvgpr_read_b32 v17, a151
  v_mov_b64 v[18:19], v[32:33]
  v_mov_b64 v[20:21], v[34:35]
  v_accvgpr_read_b32 v22, a156
  v_accvgpr_read_b32 v23, a157
  v_accvgpr_read_b32 v24, a158
  v_accvgpr_read_b32 v25, a159
  v_perm_b32 v60, v12, v10, v69
  v_accvgpr_write_b32 a140, v60
  v_perm_b32 v61, v16, v14, v69
  v_accvgpr_write_b32 a141, v61
  v_perm_b32 v60, v20, v18, v69
  v_accvgpr_write_b32 a142, v60
  v_perm_b32 v61, v24, v22, v69
  v_accvgpr_write_b32 a143, v61
  v_perm_b32 v60, v12, v10, v70
  v_accvgpr_write_b32 a148, v60
  v_perm_b32 v61, v16, v14, v70
  v_accvgpr_write_b32 a149, v61
  v_perm_b32 v60, v20, v18, v70
  v_accvgpr_write_b32 a150, v60
  v_perm_b32 v61, v24, v22, v70
  v_accvgpr_write_b32 a151, v61
  v_perm_b32 v32, v13, v11, v69
  v_perm_b32 v33, v17, v15, v69
  v_perm_b32 v34, v21, v19, v69
  v_perm_b32 v35, v25, v23, v69
  ds_write_b128 v26, v[32:35] offset:17408
  v_perm_b32 v60, v13, v11, v70
  v_accvgpr_write_b32 a156, v60
  v_perm_b32 v61, v17, v15, v70
  v_accvgpr_write_b32 a157, v61
  v_perm_b32 v60, v21, v19, v70
  v_accvgpr_write_b32 a158, v60
  v_perm_b32 v61, v25, v23, v70
  v_accvgpr_write_b32 a159, v61
  s_xor_b32 s24, s21, 1
  s_lshl_b32 s24, s24, 20
  s_add_u32 s24, s24, 0
  s_add_u32 s23, s24, 0
  buffer_load_dword a64, v64, s[64:67], s23 offen
  s_add_u32 s23, s24, 8192
  buffer_load_dword a65, v64, s[64:67], s23 offen
  s_add_u32 s23, s24, 131072
  buffer_load_dword a66, v64, s[64:67], s23 offen
  s_add_u32 s23, s24, 139264
  buffer_load_dword a67, v64, s[64:67], s23 offen
  s_add_u32 s23, s24, 16384
  buffer_load_dword a68, v64, s[64:67], s23 offen
  s_add_u32 s23, s24, 24576
  buffer_load_dword a69, v64, s[64:67], s23 offen
  s_add_u32 s23, s24, 147456
  buffer_load_dword a70, v64, s[64:67], s23 offen
  s_add_u32 s23, s24, 155648
  buffer_load_dword a71, v64, s[64:67], s23 offen
  s_add_u32 s23, s24, 524288
  buffer_load_dword v52, v64, s[64:67], s23 offen
  s_add_u32 s23, s24, 532480
  buffer_load_dword v53, v64, s[64:67], s23 offen
  s_add_u32 s23, s24, 655360
  buffer_load_dword v54, v64, s[64:67], s23 offen
  s_add_u32 s23, s24, 663552
  buffer_load_dword v55, v64, s[64:67], s23 offen
  s_add_u32 s23, s24, 540672
  buffer_load_dword v56, v64, s[64:67], s23 offen
  s_add_u32 s23, s24, 548864
  buffer_load_dword v57, v64, s[64:67], s23 offen
  s_add_u32 s23, s24, 671744
  buffer_load_dword v58, v64, s[64:67], s23 offen
  s_add_u32 s23, s24, 679936
  buffer_load_dword v59, v64, s[64:67], s23 offen
  s_waitcnt vmcnt(32)
  s_waitcnt lgkmcnt(0)
  v_accvgpr_read_b32 v10, a32
  v_accvgpr_read_b32 v11, a33
  v_accvgpr_read_b32 v12, a34
  v_accvgpr_read_b32 v13, a35
  v_accvgpr_read_b32 v14, a36
  v_accvgpr_read_b32 v15, a37
  v_accvgpr_read_b32 v16, a38
  v_accvgpr_read_b32 v17, a39
  v_mov_b64 v[18:19], v[36:37]
  v_mov_b64 v[20:21], v[38:39]
  v_mov_b64 v[22:23], v[40:41]
  v_mov_b64 v[24:25], v[42:43]
  v_perm_b32 v60, v11, v10, v69
  v_accvgpr_write_b32 a32, v60
  v_perm_b32 v61, v13, v12, v69
  v_accvgpr_write_b32 a33, v61
  v_perm_b32 v60, v15, v14, v69
  v_accvgpr_write_b32 a34, v60
  v_perm_b32 v61, v17, v16, v69
  v_accvgpr_write_b32 a35, v61
  v_perm_b32 v60, v19, v18, v69
  v_accvgpr_write_b32 a36, v60
  v_perm_b32 v61, v21, v20, v69
  v_accvgpr_write_b32 a37, v61
  v_perm_b32 v60, v23, v22, v69
  v_accvgpr_write_b32 a38, v60
  v_perm_b32 v61, v25, v24, v69
  v_accvgpr_write_b32 a39, v61
  v_perm_b32 v36, v11, v10, v70
  v_perm_b32 v37, v13, v12, v70
  v_perm_b32 v38, v15, v14, v70
  v_perm_b32 v39, v17, v16, v70
  ds_write_b128 v1, v[36:39] offset:24576
  v_perm_b32 v40, v19, v18, v70
  v_perm_b32 v41, v21, v20, v70
  v_perm_b32 v42, v23, v22, v70
  v_perm_b32 v43, v25, v24, v70
  ds_write_b128 v1, v[40:43] offset:25600
  s_xor_b32 s24, s21, 1
  s_lshl_b32 s24, s24, 20
  s_add_u32 s24, s24, 32768
  s_add_u32 s23, s24, 0
  buffer_load_dword v80, v64, s[64:67], s23 offen
  s_add_u32 s23, s24, 8192
  buffer_load_dword v81, v64, s[64:67], s23 offen
  s_add_u32 s23, s24, 131072
  buffer_load_dword v82, v64, s[64:67], s23 offen
  s_add_u32 s23, s24, 139264
  buffer_load_dword v83, v64, s[64:67], s23 offen
  s_add_u32 s23, s24, 16384
  buffer_load_dword v84, v64, s[64:67], s23 offen
  s_add_u32 s23, s24, 24576
  buffer_load_dword v85, v64, s[64:67], s23 offen
  s_add_u32 s23, s24, 147456
  buffer_load_dword v86, v64, s[64:67], s23 offen
  s_add_u32 s23, s24, 155648
  buffer_load_dword v87, v64, s[64:67], s23 offen
  s_add_u32 s23, s24, 524288
  buffer_load_dword v88, v64, s[64:67], s23 offen
  s_add_u32 s23, s24, 532480
  buffer_load_dword v89, v64, s[64:67], s23 offen
  s_add_u32 s23, s24, 655360
  buffer_load_dword v90, v64, s[64:67], s23 offen
  s_add_u32 s23, s24, 663552
  buffer_load_dword v91, v64, s[64:67], s23 offen
  s_add_u32 s23, s24, 540672
  buffer_load_dword v92, v64, s[64:67], s23 offen
  s_add_u32 s23, s24, 548864
  buffer_load_dword v93, v64, s[64:67], s23 offen
  s_add_u32 s23, s24, 671744
  buffer_load_dword v94, v64, s[64:67], s23 offen
  s_add_u32 s23, s24, 679936
  buffer_load_dword v95, v64, s[64:67], s23 offen
  s_waitcnt vmcnt(32)
  s_waitcnt lgkmcnt(0)
  v_accvgpr_read_b32 v10, a192
  v_accvgpr_read_b32 v11, a193
  v_accvgpr_read_b32 v12, a194
  v_accvgpr_read_b32 v13, a195
  v_accvgpr_read_b32 v14, a196
  v_accvgpr_read_b32 v15, a197
  v_accvgpr_read_b32 v16, a198
  v_accvgpr_read_b32 v17, a199
  v_mov_b64 v[18:19], v[44:45]
  v_mov_b64 v[20:21], v[46:47]
  v_mov_b64 v[22:23], v[48:49]
  v_mov_b64 v[24:25], v[50:51]
  v_perm_b32 v60, v11, v10, v69
  v_accvgpr_write_b32 a192, v60
  v_perm_b32 v61, v13, v12, v69
  v_accvgpr_write_b32 a193, v61
  v_perm_b32 v60, v15, v14, v69
  v_accvgpr_write_b32 a194, v60
  v_perm_b32 v61, v17, v16, v69
  v_accvgpr_write_b32 a195, v61
  v_perm_b32 v60, v19, v18, v69
  v_accvgpr_write_b32 a196, v60
  v_perm_b32 v61, v21, v20, v69
  v_accvgpr_write_b32 a197, v61
  v_perm_b32 v60, v23, v22, v69
  v_accvgpr_write_b32 a198, v60
  v_perm_b32 v61, v25, v24, v69
  v_accvgpr_write_b32 a199, v61
  v_perm_b32 v44, v11, v10, v70
  v_perm_b32 v45, v13, v12, v70
  v_perm_b32 v46, v15, v14, v70
  v_perm_b32 v47, v17, v16, v70
  ds_write_b128 v26, v[44:47] offset:40960
  v_perm_b32 v48, v19, v18, v70
  v_perm_b32 v49, v21, v20, v70
  v_perm_b32 v50, v23, v22, v70
  v_perm_b32 v51, v25, v24, v70
  ds_write_b128 v26, v[48:51] offset:41984
  s_xor_b32 s24, s21, 2
  s_lshl_b32 s24, s24, 20
  s_add_u32 s24, s24, 0
  s_add_u32 s23, s24, 0
  buffer_load_dword a96, v64, s[64:67], s23 offen
  s_add_u32 s23, s24, 8192
  buffer_load_dword a97, v64, s[64:67], s23 offen
  s_add_u32 s23, s24, 131072
  buffer_load_dword a98, v64, s[64:67], s23 offen
  s_add_u32 s23, s24, 139264
  buffer_load_dword a99, v64, s[64:67], s23 offen
  s_add_u32 s23, s24, 16384
  buffer_load_dword a100, v64, s[64:67], s23 offen
  s_add_u32 s23, s24, 24576
  buffer_load_dword a101, v64, s[64:67], s23 offen
  s_add_u32 s23, s24, 147456
  buffer_load_dword a102, v64, s[64:67], s23 offen
  s_add_u32 s23, s24, 155648
  buffer_load_dword a103, v64, s[64:67], s23 offen
  s_add_u32 s23, s24, 524288
  buffer_load_dword v28, v64, s[64:67], s23 offen
  s_add_u32 s23, s24, 532480
  buffer_load_dword v29, v64, s[64:67], s23 offen
  s_add_u32 s23, s24, 655360
  buffer_load_dword v30, v64, s[64:67], s23 offen
  s_add_u32 s23, s24, 663552
  buffer_load_dword v31, v64, s[64:67], s23 offen
  s_add_u32 s23, s24, 540672
  buffer_load_dword v32, v64, s[64:67], s23 offen
  s_add_u32 s23, s24, 548864
  buffer_load_dword v33, v64, s[64:67], s23 offen
  s_add_u32 s23, s24, 671744
  buffer_load_dword v34, v64, s[64:67], s23 offen
  s_add_u32 s23, s24, 679936
  buffer_load_dword v35, v64, s[64:67], s23 offen
  s_waitcnt vmcnt(32)
  s_waitcnt lgkmcnt(0)
  v_accvgpr_read_b32 v10, a64
  v_accvgpr_read_b32 v11, a65
  v_accvgpr_read_b32 v12, a66
  v_accvgpr_read_b32 v13, a67
  v_accvgpr_read_b32 v14, a68
  v_accvgpr_read_b32 v15, a69
  v_accvgpr_read_b32 v16, a70
  v_accvgpr_read_b32 v17, a71
  v_mov_b64 v[18:19], v[52:53]
  v_mov_b64 v[20:21], v[54:55]
  v_mov_b64 v[22:23], v[56:57]
  v_mov_b64 v[24:25], v[58:59]
  v_perm_b32 v60, v11, v10, v69
  v_accvgpr_write_b32 a64, v60
  v_perm_b32 v61, v13, v12, v69
  v_accvgpr_write_b32 a65, v61
  v_perm_b32 v60, v15, v14, v69
  v_accvgpr_write_b32 a66, v60
  v_perm_b32 v61, v17, v16, v69
  v_accvgpr_write_b32 a67, v61
  v_perm_b32 v60, v19, v18, v69
  v_accvgpr_write_b32 a68, v60
  v_perm_b32 v61, v21, v20, v69
  v_accvgpr_write_b32 a69, v61
  v_perm_b32 v60, v23, v22, v69
  v_accvgpr_write_b32 a70, v60
  v_perm_b32 v61, v25, v24, v69
  v_accvgpr_write_b32 a71, v61
  v_perm_b32 v52, v11, v10, v70
  v_perm_b32 v53, v13, v12, v70
  v_perm_b32 v54, v15, v14, v70
  v_perm_b32 v55, v17, v16, v70
  ds_write_b128 v1, v[52:55] offset:40960
  v_perm_b32 v56, v19, v18, v70
  v_perm_b32 v57, v21, v20, v70
  v_perm_b32 v58, v23, v22, v70
  v_perm_b32 v59, v25, v24, v70
  ds_write_b128 v1, v[56:59] offset:41984
  s_xor_b32 s24, s21, 2
  s_lshl_b32 s24, s24, 20
  s_add_u32 s24, s24, 32768
  s_add_u32 s23, s24, 0
  buffer_load_dword v36, v64, s[64:67], s23 offen
  s_add_u32 s23, s24, 8192
  buffer_load_dword v37, v64, s[64:67], s23 offen
  s_add_u32 s23, s24, 131072
  buffer_load_dword v38, v64, s[64:67], s23 offen
  s_add_u32 s23, s24, 139264
  buffer_load_dword v39, v64, s[64:67], s23 offen
  s_add_u32 s23, s24, 16384
  buffer_load_dword v40, v64, s[64:67], s23 offen
  s_add_u32 s23, s24, 24576
  buffer_load_dword v41, v64, s[64:67], s23 offen
  s_add_u32 s23, s24, 147456
  buffer_load_dword v42, v64, s[64:67], s23 offen
  s_add_u32 s23, s24, 155648
  buffer_load_dword v43, v64, s[64:67], s23 offen
  s_add_u32 s23, s24, 524288
  buffer_load_dword v96, v64, s[64:67], s23 offen
  s_add_u32 s23, s24, 532480
  buffer_load_dword v97, v64, s[64:67], s23 offen
  s_add_u32 s23, s24, 655360
  buffer_load_dword v98, v64, s[64:67], s23 offen
  s_add_u32 s23, s24, 663552
  buffer_load_dword v99, v64, s[64:67], s23 offen
  s_add_u32 s23, s24, 540672
  buffer_load_dword v100, v64, s[64:67], s23 offen
  s_add_u32 s23, s24, 548864
  buffer_load_dword v101, v64, s[64:67], s23 offen
  s_add_u32 s23, s24, 671744
  buffer_load_dword v102, v64, s[64:67], s23 offen
  s_add_u32 s23, s24, 679936
  buffer_load_dword v103, v64, s[64:67], s23 offen
  s_waitcnt vmcnt(32)
  s_waitcnt lgkmcnt(0)
  v_mov_b64 v[10:11], v[80:81]
  v_mov_b64 v[12:13], v[82:83]
  v_mov_b64 v[14:15], v[84:85]
  v_mov_b64 v[16:17], v[86:87]
  v_mov_b64 v[18:19], v[88:89]
  v_mov_b64 v[20:21], v[90:91]
  v_mov_b64 v[22:23], v[92:93]
  v_mov_b64 v[24:25], v[94:95]
  v_perm_b32 v80, v11, v10, v69
  v_perm_b32 v81, v13, v12, v69
  v_perm_b32 v82, v15, v14, v69
  v_perm_b32 v83, v17, v16, v69
  v_perm_b32 v84, v19, v18, v69
  v_perm_b32 v85, v21, v20, v69
  v_perm_b32 v86, v23, v22, v69
  v_perm_b32 v87, v25, v24, v69
  v_perm_b32 v88, v11, v10, v70
  v_perm_b32 v89, v13, v12, v70
  v_perm_b32 v90, v15, v14, v70
  v_perm_b32 v91, v17, v16, v70
  v_perm_b32 v92, v19, v18, v70
  v_perm_b32 v93, v21, v20, v70
  v_perm_b32 v94, v23, v22, v70
  v_perm_b32 v95, v25, v24, v70
  buffer_load_dwordx2 v[66:67], off, s[16:19], 0 offset:60 sc1
  s_xor_b32 s24, s21, 3
  s_lshl_b32 s24, s24, 20
  s_add_u32 s24, s24, 0
  s_add_u32 s23, s24, 0
  buffer_load_dword a128, v64, s[64:67], s23 offen
  s_add_u32 s23, s24, 8192
  buffer_load_dword a129, v64, s[64:67], s23 offen
  s_add_u32 s23, s24, 131072
  buffer_load_dword a130, v64, s[64:67], s23 offen
  s_add_u32 s23, s24, 139264
  buffer_load_dword a131, v64, s[64:67], s23 offen
  s_add_u32 s23, s24, 16384
  buffer_load_dword a132, v64, s[64:67], s23 offen
  s_add_u32 s23, s24, 24576
  buffer_load_dword a133, v64, s[64:67], s23 offen
  s_add_u32 s23, s24, 147456
  buffer_load_dword a134, v64, s[64:67], s23 offen
  s_add_u32 s23, s24, 155648
  buffer_load_dword a135, v64, s[64:67], s23 offen
  s_add_u32 s23, s24, 524288
  buffer_load_dword v44, v64, s[64:67], s23 offen
  s_add_u32 s23, s24, 532480
  buffer_load_dword v45, v64, s[64:67], s23 offen
  s_add_u32 s23, s24, 655360
  buffer_load_dword v46, v64, s[64:67], s23 offen
  s_add_u32 s23, s24, 663552
  buffer_load_dword v47, v64, s[64:67], s23 offen
  s_add_u32 s23, s24, 540672
  buffer_load_dword v48, v64, s[64:67], s23 offen
  s_add_u32 s23, s24, 548864
  buffer_load_dword v49, v64, s[64:67], s23 offen
  s_add_u32 s23, s24, 671744
  buffer_load_dword v50, v64, s[64:67], s23 offen
  s_add_u32 s23, s24, 679936
  buffer_load_dword v51, v64, s[64:67], s23 offen
  s_waitcnt vmcnt(32)
  s_waitcnt lgkmcnt(0)
  v_accvgpr_read_b32 v10, a96
  v_accvgpr_read_b32 v11, a97
  v_accvgpr_read_b32 v12, a98
  v_accvgpr_read_b32 v13, a99
  v_accvgpr_read_b32 v14, a100
  v_accvgpr_read_b32 v15, a101
  v_accvgpr_read_b32 v16, a102
  v_accvgpr_read_b32 v17, a103
  v_mov_b64 v[18:19], v[28:29]
  v_mov_b64 v[20:21], v[30:31]
  v_mov_b64 v[22:23], v[32:33]
  v_mov_b64 v[24:25], v[34:35]
  v_perm_b32 v60, v11, v10, v69
  v_accvgpr_write_b32 a96, v60
  v_perm_b32 v61, v13, v12, v69
  v_accvgpr_write_b32 a97, v61
  v_perm_b32 v60, v15, v14, v69
  v_accvgpr_write_b32 a98, v60
  v_perm_b32 v61, v17, v16, v69
  v_accvgpr_write_b32 a99, v61
  v_perm_b32 v60, v19, v18, v69
  v_accvgpr_write_b32 a100, v60
  v_perm_b32 v61, v21, v20, v69
  v_accvgpr_write_b32 a101, v61
  v_perm_b32 v60, v23, v22, v69
  v_accvgpr_write_b32 a102, v60
  v_perm_b32 v61, v25, v24, v69
  v_accvgpr_write_b32 a103, v61
  v_perm_b32 v28, v11, v10, v70
  v_perm_b32 v29, v13, v12, v70
  v_perm_b32 v30, v15, v14, v70
  v_perm_b32 v31, v17, v16, v70
  ds_write_b128 v1, v[28:31] offset:57344
  v_perm_b32 v32, v19, v18, v70
  v_perm_b32 v33, v21, v20, v70
  v_perm_b32 v34, v23, v22, v70
  v_perm_b32 v35, v25, v24, v70
  ds_write_b128 v1, v[32:35] offset:58368
  s_xor_b32 s24, s21, 3
  s_lshl_b32 s24, s24, 20
  s_add_u32 s24, s24, 32768
  s_add_u32 s23, s24, 0
  buffer_load_dword v104, v64, s[64:67], s23 offen
  s_add_u32 s23, s24, 8192
  buffer_load_dword v105, v64, s[64:67], s23 offen
  s_add_u32 s23, s24, 131072
  buffer_load_dword v106, v64, s[64:67], s23 offen
  s_add_u32 s23, s24, 139264
  buffer_load_dword v107, v64, s[64:67], s23 offen
  s_add_u32 s23, s24, 16384
  buffer_load_dword v108, v64, s[64:67], s23 offen
  s_add_u32 s23, s24, 24576
  buffer_load_dword v109, v64, s[64:67], s23 offen
  s_add_u32 s23, s24, 147456
  buffer_load_dword v110, v64, s[64:67], s23 offen
  s_add_u32 s23, s24, 155648
  buffer_load_dword v111, v64, s[64:67], s23 offen
  s_add_u32 s23, s24, 524288
  buffer_load_dword v52, v64, s[64:67], s23 offen
  s_add_u32 s23, s24, 532480
  buffer_load_dword v53, v64, s[64:67], s23 offen
  s_add_u32 s23, s24, 655360
  buffer_load_dword v54, v64, s[64:67], s23 offen
  s_add_u32 s23, s24, 663552
  buffer_load_dword v55, v64, s[64:67], s23 offen
  s_add_u32 s23, s24, 540672
  buffer_load_dword v56, v64, s[64:67], s23 offen
  s_add_u32 s23, s24, 548864
  buffer_load_dword v57, v64, s[64:67], s23 offen
  s_add_u32 s23, s24, 671744
  buffer_load_dword v58, v64, s[64:67], s23 offen
  s_add_u32 s23, s24, 679936
  buffer_load_dword v59, v64, s[64:67], s23 offen
  s_waitcnt vmcnt(32)
  s_waitcnt lgkmcnt(0)
  v_mov_b64 v[10:11], v[36:37]
  v_mov_b64 v[12:13], v[38:39]
  v_mov_b64 v[14:15], v[40:41]
  v_mov_b64 v[16:17], v[42:43]
  v_mov_b64 v[18:19], v[96:97]
  v_mov_b64 v[20:21], v[98:99]
  v_mov_b64 v[22:23], v[100:101]
  v_mov_b64 v[24:25], v[102:103]
  v_perm_b32 v36, v11, v10, v69
  v_perm_b32 v37, v13, v12, v69
  v_perm_b32 v38, v15, v14, v69
  v_perm_b32 v39, v17, v16, v69
  ds_write_b128 v27, v[36:39] offset:16384
  v_perm_b32 v40, v19, v18, v69
  v_perm_b32 v41, v21, v20, v69
  v_perm_b32 v42, v23, v22, v69
  v_perm_b32 v43, v25, v24, v69
  ds_write_b128 v27, v[40:43] offset:17408
  v_perm_b32 v96, v11, v10, v70
  v_perm_b32 v97, v13, v12, v70
  v_perm_b32 v98, v15, v14, v70
  v_perm_b32 v99, v17, v16, v70
  v_perm_b32 v100, v19, v18, v70
  v_perm_b32 v101, v21, v20, v70
  v_perm_b32 v102, v23, v22, v70
  v_perm_b32 v103, v25, v24, v70
  s_mov_b32 s24, 4194304
  s_add_u32 s23, s24, 0
  buffer_load_dword a160, v68, s[64:67], s23 offen
  s_add_u32 s23, s24, 8192
  buffer_load_dword a161, v68, s[64:67], s23 offen
  s_add_u32 s23, s24, 65536
  buffer_load_dword a162, v68, s[64:67], s23 offen
  s_add_u32 s23, s24, 73728
  buffer_load_dword a163, v68, s[64:67], s23 offen
  s_add_u32 s23, s24, 16384
  buffer_load_dword a164, v68, s[64:67], s23 offen
  s_add_u32 s23, s24, 24576
  buffer_load_dword a165, v68, s[64:67], s23 offen
  s_add_u32 s23, s24, 81920
  buffer_load_dword a166, v68, s[64:67], s23 offen
  s_add_u32 s23, s24, 90112
  buffer_load_dword a167, v68, s[64:67], s23 offen
  s_add_u32 s23, s24, 262144
  buffer_load_dword v28, v68, s[64:67], s23 offen
  s_add_u32 s23, s24, 270336
  buffer_load_dword v29, v68, s[64:67], s23 offen
  s_add_u32 s23, s24, 327680
  buffer_load_dword v30, v68, s[64:67], s23 offen
  s_add_u32 s23, s24, 335872
  buffer_load_dword v31, v68, s[64:67], s23 offen
  s_add_u32 s23, s24, 278528
  buffer_load_dword v32, v68, s[64:67], s23 offen
  s_add_u32 s23, s24, 286720
  buffer_load_dword v33, v68, s[64:67], s23 offen
  s_add_u32 s23, s24, 344064
  buffer_load_dword v34, v68, s[64:67], s23 offen
  s_add_u32 s23, s24, 352256
  buffer_load_dword v35, v68, s[64:67], s23 offen
  s_waitcnt vmcnt(32)
  s_waitcnt lgkmcnt(0)
  v_accvgpr_read_b32 v10, a128
  v_accvgpr_read_b32 v11, a129
  v_accvgpr_read_b32 v12, a130
  v_accvgpr_read_b32 v13, a131
  v_accvgpr_read_b32 v14, a132
  v_accvgpr_read_b32 v15, a133
  v_accvgpr_read_b32 v16, a134
  v_accvgpr_read_b32 v17, a135
  v_mov_b64 v[18:19], v[44:45]
  v_mov_b64 v[20:21], v[46:47]
  v_mov_b64 v[22:23], v[48:49]
  v_mov_b64 v[24:25], v[50:51]
  v_perm_b32 v60, v11, v10, v69
  v_accvgpr_write_b32 a128, v60
  v_perm_b32 v61, v13, v12, v69
  v_accvgpr_write_b32 a129, v61
  v_perm_b32 v60, v15, v14, v69
  v_accvgpr_write_b32 a130, v60
  v_perm_b32 v61, v17, v16, v69
  v_accvgpr_write_b32 a131, v61
  v_perm_b32 v60, v19, v18, v69
  v_accvgpr_write_b32 a132, v60
  v_perm_b32 v61, v21, v20, v69
  v_accvgpr_write_b32 a133, v61
  v_perm_b32 v60, v23, v22, v69
  v_accvgpr_write_b32 a134, v60
  v_perm_b32 v61, v25, v24, v69
  v_accvgpr_write_b32 a135, v61
  v_perm_b32 v44, v11, v10, v70
  v_perm_b32 v45, v13, v12, v70
  v_perm_b32 v46, v15, v14, v70
  v_perm_b32 v47, v17, v16, v70
  ds_write_b128 v26, v[44:47] offset:8192
  v_perm_b32 v48, v19, v18, v70
  v_perm_b32 v49, v21, v20, v70
  v_perm_b32 v50, v23, v22, v70
  v_perm_b32 v51, v25, v24, v70
  ds_write_b128 v26, v[48:51] offset:9216
  s_waitcnt vmcnt(16)
  s_waitcnt lgkmcnt(0)
  v_mov_b64 v[10:11], v[104:105]
  v_mov_b64 v[12:13], v[106:107]
  v_mov_b64 v[14:15], v[108:109]
  v_mov_b64 v[16:17], v[110:111]
  v_mov_b64 v[18:19], v[52:53]
  v_mov_b64 v[20:21], v[54:55]
  v_mov_b64 v[22:23], v[56:57]
  v_mov_b64 v[24:25], v[58:59]
  v_perm_b32 v104, v11, v10, v69
  v_perm_b32 v105, v13, v12, v69
  v_perm_b32 v106, v15, v14, v69
  v_perm_b32 v107, v17, v16, v69
  v_perm_b32 v108, v19, v18, v69
  v_perm_b32 v109, v21, v20, v69
  v_perm_b32 v110, v23, v22, v69
  v_perm_b32 v111, v25, v24, v69
  v_perm_b32 v52, v11, v10, v70
  v_perm_b32 v53, v13, v12, v70
  v_perm_b32 v54, v15, v14, v70
  v_perm_b32 v55, v17, v16, v70
  ds_write_b128 v27, v[52:55] offset:24576
  v_perm_b32 v56, v19, v18, v70
  v_perm_b32 v57, v21, v20, v70
  v_perm_b32 v58, v23, v22, v70
  v_perm_b32 v59, v25, v24, v70
  ds_write_b128 v27, v[56:59] offset:25600
  s_mov_b32 s51, 0
  v_readfirstlane_b32 s23, v66
  s_nop 0
  s_lshr_b32 s35, s23, 16
  s_and_b32 s23, s23, 0xffff
  s_cmp_lt_u32 s23, 32
  s_cbranch_scc1 L_notyet
  v_readfirstlane_b32 s23, v67
  s_nop 0
  s_cmp_lt_u32 s23, 84
  s_cbranch_scc1 L_notyet
  buffer_load_dwordx4 v[36:39], v1, s[8:11], s31 offen sc1
  buffer_load_dwordx4 v[40:43], v1, s[8:11], s31 offen offset:1024 sc1
  buffer_load_dwordx4 v[44:47], v1, s[8:11], s32 offen sc1
  buffer_load_dwordx4 v[48:51], v1, s[8:11], s32 offen offset:1024 sc1
  s_mov_b32 m0, 13568
  s_add_u32 s23, s31, s45
  s_add_u32 s24, s32, s45
  buffer_load_dword v2, s[52:55], s23 idxen sc1 lds
  buffer_load_dword v2, s[52:55], s24 idxen sc1 lds
  s_add_u32 s23, s31, 4261388288
  s_add_u32 s24, s31, 83861504
  buffer_load_dword v2, s[52:55], s23 idxen sc1 lds
  buffer_load_dword v2, s[52:55], s24 idxen sc1 lds
  s_mov_b32 s51, 1
L_notyet:
  s_waitcnt vmcnt(0)
  s_waitcnt lgkmcnt(0)
  v_accvgpr_read_b32 v10, a160
  v_accvgpr_read_b32 v11, a161
  v_accvgpr_read_b32 v12, a162
  v_accvgpr_read_b32 v13, a163
  v_accvgpr_read_b32 v14, a164
  v_accvgpr_read_b32 v15, a165
  v_accvgpr_read_b32 v16, a166
  v_accvgpr_read_b32 v17, a167
  v_mov_b64 v[18:19], v[28:29]
  v_mov_b64 v[20:21], v[30:31]
  v_mov_b64 v[22:23], v[32:33]
  v_mov_b64 v[24:25], v[34:35]
  v_perm_b32 v60, v11, v10, v69
  v_accvgpr_write_b32 a160, v60
  v_perm_b32 v61, v13, v12, v69
  v_accvgpr_write_b32 a161, v61
  v_perm_b32 v60, v15, v14, v69
  v_accvgpr_write_b32 a162, v60
  v_perm_b32 v61, v17, v16, v69
  v_accvgpr_write_b32 a163, v61
  v_perm_b32 v60, v19, v18, v69
  v_accvgpr_write_b32 a164, v60
  v_perm_b32 v61, v21, v20, v69
  v_accvgpr_write_b32 a165, v61
  v_perm_b32 v60, v23, v22, v69
  v_accvgpr_write_b32 a166, v60
  v_perm_b32 v61, v25, v24, v69
  v_accvgpr_write_b32 a167, v61
  v_perm_b32 v28, v11, v10, v70
  v_perm_b32 v29, v13, v12, v70
  v_perm_b32 v30, v15, v14, v70
  v_perm_b32 v31, v17, v16, v70
  ds_write_b128 v26, v[28:31] offset:24576
  v_perm_b32 v32, v19, v18, v70
  v_perm_b32 v33, v21, v20, v70
  v_perm_b32 v34, v23, v22, v70
  v_perm_b32 v35, v25, v24, v70
  ds_write_b128 v26, v[32:35] offset:25600
  s_waitcnt lgkmcnt(0)
  s_cmp_eq_u32 s51, 1
  s_cbranch_scc1 L_kvhave
  s_mov_b32 s27, 0
L_warm:
  buffer_load_dwordx2 v[66:67], off, s[16:19], 0 offset:60 sc1
  s_add_u32 s27, s27, 1
  s_cmp_gt_u32 s27, 0x40000
  s_cbranch_scc1 L_abort
  s_waitcnt vmcnt(0)
  v_readfirstlane_b32 s23, v66
  s_nop 0
  s_lshr_b32 s35, s23, 16
  s_and_b32 s23, s23, 0xffff
  s_cmp_lt_u32 s23, 32
  s_cbranch_scc1 L_warm
  v_readfirstlane_b32 s23, v67
  s_nop 0
  s_cmp_lt_u32 s23, 84
  s_cbranch_scc1 L_warm
  buffer_load_dwordx4 v[36:39], v1, s[8:11], s31 offen sc1
  buffer_load_dwordx4 v[40:43], v1, s[8:11], s31 offen offset:1024 sc1
  buffer_load_dwordx4 v[44:47], v1, s[8:11], s32 offen sc1
  buffer_load_dwordx4 v[48:51], v1, s[8:11], s32 offen offset:1024 sc1
  s_mov_b32 m0, 13568
  s_add_u32 s23, s31, s45
  s_add_u32 s24, s32, s45
  buffer_load_dword v2, s[52:55], s23 idxen sc1 lds
  buffer_load_dword v2, s[52:55], s24 idxen sc1 lds
  s_add_u32 s23, s31, 4261388288
  s_add_u32 s24, s31, 83861504
  buffer_load_dword v2, s[52:55], s23 idxen sc1 lds
  buffer_load_dword v2, s[52:55], s24 idxen sc1 lds
L_kvhave:
  s_waitcnt vmcnt(0)
  ds_write_b128 v1, v[36:39] offset:16384
  ds_write_b128 v1, v[40:43] offset:17408
  v_mov_b64 v[10:11], v[44:45]
  v_mov_b64 v[12:13], v[46:47]
  v_mov_b64 v[14:15], v[48:49]
  v_mov_b64 v[16:17], v[50:51]
  s_mov_b32 s58, 0x33333333
  s_mov_b32 s59, 0x33333333
  s_mov_b32 s22, -1
  s_mov_b32 s3, 5
  s_mov_b32 s30, 0
  s_lshl_b32 s50, s21, 2
  s_cmp_eq_u32 s21, 2
  s_cselect_b32 s50, 2, s50
  s_cmp_eq_u32 s29, 0
  s_cselect_b32 s50, 6, s50
  s_mov_b32 s51, 0
  ds_read_b128 v[18:21], v1
  ds_read_b128 v[52:55], v1 offset:24576
  ds_read_b128 v[56:59], v1 offset:25600
  s_waitcnt lgkmcnt(0)
  v_mov_b64 v[28:29], 0
  v_mov_b64 v[30:31], 0
  v_mov_b64 v[32:33], 0
  v_mov_b64 v[34:35], 0
  v_mov_b64 v[36:37], 0
  v_mov_b64 v[38:39], 0
  v_mov_b64 v[40:41], 0
  v_mov_b64 v[42:43], 0
  v_mov_b64 v[44:45], 0
  v_mov_b64 v[46:47], 0
  v_mov_b64 v[48:49], 0
  v_mov_b64 v[50:51], 0
  s_waitcnt lgkmcnt(0)
  s_cmp_lg_u32 s35, 0
  s_cbranch_scc1 L_have_img_s
  s_branch L_have_img_f
L_step_f:
  s_mov_b32 s27, 0
  buffer_load_dwordx4 v[18:21], v1, s[8:11], s43 offen sc1
  buffer_load_dword v26, v2, s[8:11], s44 offen sc1
L_p2x_f:
  ds_read_b128 v[52:55], v1 offset:24576
  ds_read_b128 v[56:59], v1 offset:25600
  s_cmp_eq_u32 s30, 0
  s_cbranch_scc1 L_p2x_0_f
L_p2x_1_f:
  s_waitcnt vmcnt(0)
  v_bitop3_b32 v27, v18, v19, v20 bitop3:0x80
  v_bitop3_b32 v27, v27, v21, v26 bitop3:0x80
  v_and_b32 v27, 1, v27
  v_cmp_ne_u32 vcc, 1, v27
  ds_write_b128 v1, v[18:21]
  ds_write_b32 v2, v26 offset:8192
  s_cbranch_vccz L_have_img_f
L_p2f_1_f:
  s_mov_b64 exec, vcc
  buffer_load_dwordx4 v[18:21], v1, s[8:11], s43 offen sc1
  buffer_load_dword v26, v2, s[8:11], s44 offen sc1
  s_mov_b64 exec, -1
  s_nop 9
L_p2r_1_f:
  s_mov_b64 exec, vcc
  buffer_load_dwordx4 v[18:21], v1, s[8:11], s43 offen sc1
  buffer_load_dword v26, v2, s[8:11], s44 offen sc1
  s_mov_b64 exec, -1
  s_add_u32 s27, s27, 1
  s_cmp_gt_u32 s27, 0x40000
  s_cbranch_scc1 L_abort
  s_waitcnt vmcnt(2)
  v_bitop3_b32 v27, v18, v19, v20 bitop3:0x80
  v_bitop3_b32 v27, v27, v21, v26 bitop3:0x80
  v_and_b32 v27, 1, v27
  v_cmp_ne_u32 vcc, 1, v27
  ds_write_b128 v1, v[18:21]
  ds_write_b32 v2, v26 offset:8192
  s_cbranch_vccnz L_p2r_1_f
  s_branch L_have_img_f
L_p2f_0_f:
  s_mov_b64 exec, vcc
  buffer_load_dwordx4 v[18:21], v1, s[8:11], s43 offen sc1
  buffer_load_dword v26, v2, s[8:11], s44 offen sc1
  s_mov_b64 exec, -1
  s_nop 9
L_p2r_0_f:
  s_mov_b64 exec, vcc
  buffer_load_dwordx4 v[18:21], v1, s[8:11], s43 offen sc1
  buffer_load_dword v26, v2, s[8:11], s44 offen sc1
  s_mov_b64 exec, -1
  s_add_u32 s27, s27, 1
  s_cmp_gt_u32 s27, 0x40000
  s_cbranch_scc1 L_abort
  s_waitcnt vmcnt(2)
  v_or3_b32 v27, v18, v19, v20
  v_or3_b32 v27, v27, v21, v26
  v_and_b32 v27, 1, v27
  v_cmp_ne_u32 vcc, 0, v27
  ds_write_b128 v1, v[18:21]
  ds_write_b32 v2, v26 offset:8192
  s_cbranch_vccnz L_p2r_0_f
  s_branch L_have_img_f
L_p2x_0_f:
  s_waitcnt vmcnt(0)
  v_or3_b32 v27, v18, v19, v20
  v_or3_b32 v27, v27, v21, v26
  v_and_b32 v27, 1, v27
  v_cmp_ne_u32 vcc, 0, v27
  ds_write_b128 v1, v[18:21]
  ds_write_b32 v2, v26 offset:8192
  s_cbranch_vccnz L_p2f_0_f
L_have_img_f:
  v_smfmac_f32_16x16x64_bf16 v[28:31], v[18:21], a[0:7], v0
  v_smfmac_f32_16x16x64_bf16 v[32:35], v[18:21], a[8:15], v0
  v_xor_b32 v68, 2048, v1
  v_smfmac_f32_16x16x64_bf16 v[36:39], v[18:21], a[16:23], v0
  s_waitcnt lgkmcnt(0)
  s_barrier
  ds_read_b128 v[68:71], v68 offset:0
  v_smfmac_f32_16x16x64_bf16 v[40:43], v[18:21], a[24:31], v0
  ds_read_b128 v[60:63], v1 offset:32768
  v_smfmac_f32_16x16x64_bf16 v[44:47], v[18:21], a[32:39], v0
  ds_read_b128 v[64:67], v1 offset:33792
  v_smfmac_f32_16x16x64_bf16 v[48:51], v[18:21], v[52:59], v0
  s_waitcnt vmcnt(0)
  ds_read_b128 v[52:55], v1 offset:40960
  s_waitcnt lgkmcnt(3)
  v_xor_b32 v18, 4096, v1
  v_smfmac_f32_16x16x64_bf16 v[28:31], v[68:71], a[40:47], v0
  ds_read_b128 v[18:21], v18 offset:0
  ds_read_b128 v[56:59], v1 offset:41984
  v_smfmac_f32_16x16x64_bf16 v[32:35], v[68:71], a[48:55], v0
  buffer_load_dwordx4 v[22:25], v1, s[8:11], s43 offen offset:1024 sc1
  s_waitcnt lgkmcnt(3)
  v_add_u32 v9, 0x10000, v1
  v_smfmac_f32_16x16x64_bf16 v[36:39], v[68:71], v[60:67], v0
  ds_read_b128 v[60:63], v1 offset:49152
  v_smfmac_f32_16x16x64_bf16 v[40:43], v[68:71], a[56:63], v0
  ds_read_b128 v[64:67], v1 offset:50176
  s_add_u32 s22, s22, 1
  v_smfmac_f32_16x16x64_bf16 v[44:47], v[68:71], a[64:71], v0
  s_add_u32 s31, s31, 262144
  s_waitcnt lgkmcnt(2)
  v_smfmac_f32_16x16x64_bf16 v[48:51], v[68:71], v[52:59], v0
  ds_read_b128 v[52:55], v1 offset:57344
  v_xor_b32 v68, 6144, v1
  v_smfmac_f32_16x16x64_bf16 v[28:31], v[18:21], a[72:79], v0
  ds_read_b128 v[68:71], v68 offset:0
  ds_read_b128 v[56:59], v1 offset:58368
  v_smfmac_f32_16x16x64_bf16 v[32:35], v[18:21], a[80:87], v0
  s_add_u32 s32, s32, 262144
  s_waitcnt lgkmcnt(3)
  v_smfmac_f32_16x16x64_bf16 v[36:39], v[18:21], v[60:67], v0
  ds_read_b128 v[60:63], v9 offset:0
  v_smfmac_f32_16x16x64_bf16 v[40:43], v[18:21], a[88:95], v0
  ds_read_b128 v[64:67], v9 offset:1024
  s_add_u32 s23, s31, s45
  v_smfmac_f32_16x16x64_bf16 v[44:47], v[18:21], a[96:103], v0
  s_add_u32 s24, s32, s45
  s_waitcnt lgkmcnt(2)
  v_smfmac_f32_16x16x64_bf16 v[48:51], v[18:21], v[52:59], v0
  ds_read_b128 v[52:55], v9 offset:8192
  v_xor_b32 v18, s36, v1
  v_smfmac_f32_16x16x64_bf16 v[28:31], v[68:71], a[104:111], v0
  ds_read_b128 v[18:21], v18 offset:8192
  ds_read_b128 v[56:59], v9 offset:9216
  v_smfmac_f32_16x16x64_bf16 v[32:35], v[68:71], a[112:119], v0
  s_add_u32 s33, s33, 262144
  s_waitcnt lgkmcnt(3)
  v_smfmac_f32_16x16x64_bf16 v[36:39], v[68:71], v[60:67], v0
  ds_read_b128 v[60:63], v9 offset:16384
  s_mov_b32 s43, 1310720
  v_smfmac_f32_16x16x64_bf16 v[40:43], v[68:71], a[120:127], v0
  ds_read_b128 v[64:67], v9 offset:17408
  s_add_u32 s34, s34, 262144
  v_smfmac_f32_16x16x64_bf16 v[44:47], v[68:71], a[128:135], v0
  s_waitcnt vmcnt(0)
  ds_write_b128 v1, v[22:25] offset:1024
  s_mov_b32 m0, 13568
  s_waitcnt lgkmcnt(3)
  v_bitop3_b32 v27, v22, v23, s30 bitop3:0x7e
  v_smfmac_f32_16x16x64_bf16 v[48:51], v[68:71], v[52:59], v0
  buffer_load_dword v2, s[52:55], s23 idxen sc1 lds
  v_bitop3_b32 v27, v27, v24, s30 bitop3:0xf6
  v_smfmac_f32_16x16x64_bf16 v[28:31], v[18:21], a[136:143], v0
  ds_read_b128 v[52:55], v9 offset:24576
  s_add_u32 s25, s22, 1
  v_bitop3_b32 v27, v27, v25, s30 bitop3:0xf6
  v_smfmac_f32_16x16x64_bf16 v[32:35], v[18:21], a[144:151], v0
  ds_read_b128 v[56:59], v9 offset:25600
  buffer_load_dword v2, s[52:55], s24 idxen sc1 lds
  s_waitcnt lgkmcnt(3)
  v_and_b32 v27, s51, v27
  v_smfmac_f32_16x16x64_bf16 v[36:39], v[18:21], v[60:67], v0
  ds_read_b128 v[60:63], v9 offset:32768
  v_cmp_ne_u32 vcc, 0, v27
  v_smfmac_f32_16x16x64_bf16 v[40:43], v[18:21], a[152:159], v0
  ds_read_b128 v[64:67], v9 offset:33792
  v_xor_b32 v68, 2048, v1
  v_smfmac_f32_16x16x64_bf16 v[44:47], v[18:21], a[160:167], v0
  s_cbranch_vccnz L_late_retry_f
L_late_ok_f:
  s_waitcnt lgkmcnt(2)
  v_mov_b32 v27, s25
  v_smfmac_f32_16x16x64_bf16 v[48:51], v[18:21], v[52:59], v0
  s_barrier
  ds_read_b128 v[52:55], v9 offset:40960
  v_xor_b32 v18, 4096, v1
  v_smfmac_f32_16x16x64_bf16 v[28:31], v[22:25], a[168:175], v0
  ds_read_b128 v[68:71], v68 offset:1024
  ds_read_b128 v[56:59], v9 offset:41984
  v_smfmac_f32_16x16x64_bf16 v[32:35], v[22:25], a[176:183], v0
  ds_read_b128 v[18:21], v18 offset:1024
  s_waitcnt lgkmcnt(4)
  v_smfmac_f32_16x16x64_bf16 v[36:39], v[22:25], v[60:67], v0
  ds_read_b128 v[60:63], v9 offset:49152
  v_smfmac_f32_16x16x64_bf16 v[40:43], v[22:25], a[184:191], v0
  ds_read_b128 v[64:67], v9 offset:50176
  buffer_store_dword v27, off, s[8:11], s37 sc1
  v_smfmac_f32_16x16x64_bf16 v[44:47], v[22:25], a[192:199], v0
  s_waitcnt lgkmcnt(3)
  v_smfmac_f32_16x16x64_bf16 v[48:51], v[22:25], v[52:59], v0
  ds_read_b128 v[52:55], v9 offset:57344
  v_xor_b32 v22, 6144, v1
  v_smfmac_f32_16x16x64_bf16 v[28:31], v[68:71], a[200:207], v0
  ds_read_b128 v[22:25], v22 offset:1024
  ds_read_b128 v[56:59], v9 offset:58368
  v_smfmac_f32_16x16x64_bf16 v[32:35], v[68:71], a[208:215], v0
  s_mov_b32 s51, 1
  s_waitcnt lgkmcnt(3)
  v_add_u32 v9, 0x20000, v1
  v_smfmac_f32_16x16x64_bf16 v[36:39], v[68:71], v[60:67], v0
  ds_read_b128 v[60:63], v9 offset:0
  s_xor_b32 s30, s30, 1
  v_smfmac_f32_16x16x64_bf16 v[40:43], v[68:71], a[216:223], v0
  ds_read_b128 v[64:67], v9 offset:1024
  v_smfmac_f32_16x16x64_bf16 v[28:31], v[18:21], a[224:231], v0
  s_waitcnt lgkmcnt(2)
  v_smfmac_f32_16x16x64_bf16 v[32:35], v[18:21], v[52:59], v0
  ds_read_b128 v[52:55], v9 offset:8192
  v_smfmac_f32_16x16x64_bf16 v[36:39], v[18:21], a[232:239], v0
  ds_read_b128 v[56:59], v9 offset:9216
  v_smfmac_f32_16x16x64_bf16 v[40:43], v[18:21], a[240:247], v0
  s_waitcnt lgkmcnt(2)
  v_xor_b32 v27, s36, v1
  v_smfmac_f32_16x16x64_bf16 v[28:31], v[22:25], v[60:67], v0
  ds_read_b128 v[60:63], v9 offset:16384
  s_xor_b32 s50, s50, 1
  v_lshlrev_b32 v26, 1, v2
  v_smfmac_f32_16x16x64_bf16 v[32:35], v[22:25], a[248:255], v0
  ds_read_b128 v[64:67], v9 offset:17408
  s_mov_b32 s27, 0
  v_smfmac_f32_16x16x64_bf16 v[36:39], v[22:25], v[72:79], v0
  s_waitcnt lgkmcnt(2)
  v_add_f32 v28, v28, v30
  v_smfmac_f32_16x16x64_bf16 v[40:43], v[22:25], v[52:59], v0
  ds_read_b128 v[52:55], v9 offset:24576
  v_add_f32 v29, v29, v31
  v_smfmac_f32_16x16x64_bf16 v[44:47], v[68:71], v[80:87], v0
  ds_read_b128 v[56:59], v9 offset:25600
  v_add_f32 v32, v32, v34
  v_add_f32 v33, v33, v35
  v_smfmac_f32_16x16x64_bf16 v[48:51], v[68:71], v[88:95], v0
  s_waitcnt lgkmcnt(2)
  v_cvt_pk_bf16_f32 v28, v28, v32
  v_cvt_pk_bf16_f32 v30, v29, v33
  v_add_f32 v36, v36, v38
  v_add_f32 v40, v40, v42
  v_add_f32 v37, v37, v39
  v_add_f32 v41, v41, v43
  v_cvt_pk_bf16_f32 v29, v36, v40
  v_cvt_pk_bf16_f32 v31, v37, v41
  ds_write2_b64 v3, v[28:29], v[30:31] offset0:0 offset1:68
  v_smfmac_f32_16x16x64_bf16 v[44:47], v[18:21], v[60:67], v0
  ds_read_b128 v[68:71], v27 offset:16384
  v_or_b32 v28, 1, v28
  v_smfmac_f32_16x16x64_bf16 v[48:51], v[18:21], v[96:103], v0
  buffer_store_dwordx2 v[28:29], v26, s[8:11], s33 offen sc1
  ds_read_b128 v[60:63], v27 offset:17408
  v_or_b32 v30, 1, v30
  v_smfmac_f32_16x16x64_bf16 v[44:47], v[22:25], v[104:111], v0
  buffer_store_dwordx2 v[30:31], v26, s[8:11], s33 offen offset:1024 sc1
  s_waitcnt lgkmcnt(3)
  v_smfmac_f32_16x16x64_bf16 v[48:51], v[22:25], v[52:59], v0
  s_waitcnt lgkmcnt(2)
  s_barrier
  ds_read_b128 v[28:31], v4 offset:0
  ds_read_b128 v[32:35], v4 offset:64
  ds_read_b128 v[40:43], v4 offset:128
  ds_read_b128 v[22:25], v4 offset:192
  s_waitcnt lgkmcnt(3)
  v_mfma_f32_16x16x32_bf16 v[36:39], v[28:31], v[28:31], 0
  ds_read_b128 v[64:67], v27 offset:18432
  s_waitcnt lgkmcnt(3)
  v_cvt_pk_bf16_f32 v44, v44, v45
  v_mfma_f32_16x16x32_bf16 v[36:39], v[32:35], v[32:35], v[36:39]
  ds_read_b128 v[18:21], v27 offset:19456
  s_waitcnt lgkmcnt(3)
  v_cvt_pk_bf16_f32 v45, v46, v47
  v_mfma_f32_16x16x32_bf16 v[36:39], v[40:43], v[40:43], v[36:39]
  ds_read_b128 v[52:55], v27 offset:20480
  s_waitcnt lgkmcnt(3)
  v_cvt_pk_bf16_f32 v46, v48, v49
  v_mfma_f32_16x16x32_bf16 v[36:39], v[22:25], v[22:25], v[36:39]
  ds_read_b128 v[56:59], v27 offset:21504
  v_cvt_pk_bf16_f32 v47, v50, v51
  v_mfma_f32_16x16x32_bf16 v[48:51], v[68:71], v[28:31], 0
  ds_read_b128 v[68:71], v27 offset:22528
  v_or_b32 v44, 1, v44
  v_mfma_f32_16x16x32_bf16 v[48:51], v[60:63], v[32:35], v[48:51]
  ds_read_b128 v[60:63], v27 offset:23552
  s_waitcnt lgkmcnt(5)
  v_mfma_f32_16x16x32_bf16 v[48:51], v[64:67], v[40:43], v[48:51]
  buffer_store_dwordx4 v[44:47], v1, s[8:11], s34 offen sc1
  s_waitcnt lgkmcnt(4)
  v_mfma_f32_16x16x32_bf16 v[48:51], v[18:21], v[22:25], v[48:51]
  s_cmp_eq_u32 s22, 63
  s_cbranch_scc1 L_done_f
  s_waitcnt lgkmcnt(3)
  v_mfma_f32_16x16x32_bf16 v[64:67], v[52:55], v[28:31], 0
  s_waitcnt lgkmcnt(2)
  v_mov_b32 v28, 0x3f803f80
  v_mfma_f32_16x16x32_bf16 v[64:67], v[56:59], v[32:35], v[64:67]
  buffer_load_dwordx4 v[52:55], v1, s[8:11], s31 offen sc1
  s_waitcnt lgkmcnt(1)
  v_max3_f32 v26, v38, v39, v48
  v_mfma_f32_16x16x32_bf16 v[64:67], v[68:71], v[40:43], v[64:67]
  s_waitcnt lgkmcnt(0)
  v_max3_f32 v26, v26, v49, v50
  v_mfma_f32_16x16x32_bf16 v[64:67], v[60:63], v[22:25], v[64:67]
  v_max_f32 v26, v26, v51
  v_mov_b32 v29, 0x3f803f80
  v_mov_b32 v30, 0x3f803f80
  v_mov_b32 v31, 0x3f803f80
  v_mov_b32 v32, 0x3f803f80
  v_mov_b32 v33, 0
  s_nop 0
  v_max3_f32 v26, v26, v64, v65
  v_max3_f32 v26, v26, v66, v67
  v_mov_b32 v24, v26
  buffer_load_dwordx4 v[56:59], v1, s[8:11], s31 offen offset:1024 sc1
  s_nop 0
  v_permlane16_swap_b32 v26, v24
  v_max_f32 v26, v26, v24
  v_mov_b32 v24, v26
  s_nop 1
  v_permlane32_swap_b32 v26, v24
  v_max_f32 v26, v26, v24
  v_mul_f32 v26, s28, v26
  v_pk_fma_f32 v[48:49], v[48:49], s[28:29], v[26:27] op_sel_hi:[1,0,0] neg_lo:[0,0,1] neg_hi:[0,0,1]
  v_pk_fma_f32 v[50:51], v[50:51], s[28:29], v[26:27] op_sel_hi:[1,0,0] neg_lo:[0,0,1] neg_hi:[0,0,1]
  v_pk_fma_f32 v[64:65], v[64:65], s[28:29], v[26:27] op_sel_hi:[1,0,0] neg_lo:[0,0,1] neg_hi:[0,0,1]
  v_pk_fma_f32 v[66:67], v[66:67], s[28:29], v[26:27] op_sel_hi:[1,0,0] neg_lo:[0,0,1] neg_hi:[0,0,1]
  v_pk_fma_f32 v[38:39], v[38:39], s[28:29], v[26:27] op_sel_hi:[1,0,0] neg_lo:[0,0,1] neg_hi:[0,0,1]
  v_exp_f32_dpp v48, v48 quad_perm:[0,1,0,1] row_mask:0xf bank_mask:0xf
  buffer_load_dwordx4 v[68:71], v1, s[8:11], s32 offen sc1
  v_exp_f32_dpp v49, v49 quad_perm:[0,1,0,1] row_mask:0xf bank_mask:0xf
  v_exp_f32_dpp v50, v50 quad_perm:[0,1,0,1] row_mask:0xf bank_mask:0xf
  v_exp_f32_dpp v51, v51 quad_perm:[0,1,0,1] row_mask:0xf bank_mask:0xf
  v_exp_f32_dpp v64, v64 quad_perm:[0,1,0,1] row_mask:0xf bank_mask:0xf
  v_exp_f32_dpp v65, v65 quad_perm:[0,1,0,1] row_mask:0xf bank_mask:0xf
  v_exp_f32_dpp v66, v66 quad_perm:[0,1,0,1] row_mask:0xf bank_mask:0xf
  v_exp_f32_dpp v67, v67 quad_perm:[0,1,0,1] row_mask:0xf bank_mask:0xf
  buffer_load_dwordx4 v[60:63], v1, s[8:11], s32 offen offset:1024 sc1
  v_cvt_pk_bf16_f32 v40, v48, v49
  v_cvt_pk_bf16_f32 v41, v50, v51
  v_cvt_pk_bf16_f32 v42, v64, v65
  v_cvt_pk_bf16_f32 v43, v66, v67
  v_exp_f32_dpp v38, v38 quad_perm:[0,1,0,1] row_mask:0xf bank_mask:0xf
  v_exp_f32_dpp v39, v39 quad_perm:[0,1,0,1] row_mask:0xf bank_mask:0xf
  v_mfma_f32_16x16x32_bf16 v[18:21], v[28:31], v[40:43], 0
  v_cvt_pk_bf16_f32 v34, v38, v39
  v_mfma_f32_16x16x32_bf16 v[22:25], v[10:13], v[40:43], 0
  v_cvt_pk_bf16_f32 v35, v38, v39
  v_mfma_f32_16x16x32_bf16 v[36:39], v[14:17], v[40:43], 0
  v_mov_b64 v[64:65], 0
  v_mfma_f32_16x16x16_bf16 v[18:21], v[32:33], v[34:35], v[18:21]
  v_mov_b64 v[66:67], 0
  v_mfma_f32_16x16x16_bf16 v[22:25], v[44:45], v[34:35], v[22:25]
  v_xor_b32 v10, 512, v5
  v_mfma_f32_16x16x16_bf16 v[36:39], v[46:47], v[34:35], v[36:39]
  v_xor_b32 v14, 1024, v5
  v_rcp_f32 v18, v18
  v_mov_b64 v[40:41], 0
  v_mov_b64 v[32:33], 0
  v_mov_b64 v[34:35], 0
  v_pk_mul_f32 v[22:23], v[22:23], v[18:19] op_sel_hi:[1,0]
  v_pk_mul_f32 v[24:25], v[24:25], v[18:19] op_sel_hi:[1,0]
  v_pk_mul_f32 v[36:37], v[36:37], v[18:19] op_sel_hi:[1,0]
  v_pk_mul_f32 v[38:39], v[38:39], v[18:19] op_sel_hi:[1,0]
  v_cvt_pk_bf16_f32 v28, v22, v36
  v_cvt_pk_bf16_f32 v29, v23, v37
  v_cvt_pk_bf16_f32 v30, v24, v38
  v_cvt_pk_bf16_f32 v31, v25, v39
  ds_write_b128 v5, v[28:31]
  v_xor_b32 v18, 1536, v5
  v_smfmac_f32_16x16x64_bf16 v[32:35], v[28:31], v[112:119], v0
  v_mov_b64 v[42:43], 0
  v_smfmac_f32_16x16x64_bf16 v[64:67], v[28:31], v[176:183], v0
  v_mov_b64 v[44:45], 0
  v_smfmac_f32_16x16x64_bf16 v[40:43], v[28:31], v[144:151], v0
  v_mov_b64 v[46:47], 0
  s_waitcnt lgkmcnt(0)
  s_barrier
  ds_read_b128 v[10:13], v10
  ds_read_b128 v[14:17], v14
  ds_read_b128 v[18:21], v18
  v_smfmac_f32_16x16x64_bf16 v[44:47], v[28:31], v[208:215], v0
  ds_read_b128 v[22:25], v27 offset:14336
  ds_read_b128 v[36:39], v27 offset:15360
  v_mov_b64 v[48:49], 0
  v_mov_b64 v[50:51], 0
  s_waitcnt lgkmcnt(4)
  v_smfmac_f32_16x16x64_bf16 v[32:35], v[10:13], v[120:127], v0
  s_waitcnt lgkmcnt(3)
  v_smfmac_f32_16x16x64_bf16 v[32:35], v[14:17], v[128:135], v0
  s_waitcnt lgkmcnt(2)
  v_smfmac_f32_16x16x64_bf16 v[32:35], v[18:21], v[136:143], v0
  v_smfmac_f32_16x16x64_bf16 v[40:43], v[10:13], v[152:159], v0
  v_smfmac_f32_16x16x64_bf16 v[40:43], v[14:17], v[160:167], v0
  v_cvt_pk_bf16_f32 v32, v32, v34
  v_smfmac_f32_16x16x64_bf16 v[40:43], v[18:21], v[168:175], v0
  s_waitcnt lgkmcnt(1)
  v_cvt_pk_bf16_f32 v33, v33, v35
  v_smfmac_f32_16x16x64_bf16 v[48:51], v[22:25], v[240:247], v0
  s_waitcnt lgkmcnt(0)
  v_and_or_b32 v32, v32, -2, s30
  v_smfmac_f32_16x16x64_bf16 v[48:51], v[36:39], v[248:255], v0
  v_cvt_pk_bf16_f32 v34, v40, v42
  v_cvt_pk_bf16_f32 v35, v41, v43
  buffer_store_dwordx4 v[32:35], v6, s[8:11], s39 offen
  v_smfmac_f32_16x16x64_bf16 v[64:67], v[10:13], v[184:191], v0
  v_smfmac_f32_16x16x64_bf16 v[64:67], v[14:17], v[192:199], v0
  v_add_f32 v48, v48, v50
  v_add_f32 v49, v49, v51
  v_cvt_pk_bf16_f32 v48, v48, v49
  v_and_or_b32 v48, v48, -2, s30
  buffer_store_dword v48, v7, s[8:11], s39 offen
  v_smfmac_f32_16x16x64_bf16 v[64:67], v[18:21], v[200:207], v0
  v_and_b32 v26, 0xf0, v1
  v_smfmac_f32_16x16x64_bf16 v[44:47], v[10:13], v[216:223], v0
  v_add_u32 v26, s49, v26
  v_smfmac_f32_16x16x64_bf16 v[44:47], v[14:17], v[224:231], v0
  v_cvt_pk_bf16_f32 v64, v64, v66
  v_smfmac_f32_16x16x64_bf16 v[44:47], v[18:21], v[232:239], v0
  v_cvt_pk_bf16_f32 v65, v65, v67
  v_and_or_b32 v64, v64, -2, s30
  s_nop 3
  v_cvt_pk_bf16_f32 v66, v44, v46
  v_cvt_pk_bf16_f32 v67, v45, v47
  buffer_store_dwordx4 v[64:67], v6, s[8:11], s41 offen
  ds_read_b128 v[22:25], v26 offset:13824
  s_cmp_ge_u32 s50, 4
  s_cbranch_scc1 L_note_f
  s_nop 15
  s_nop 15
  s_nop 7
  s_cmp_eq_u32 s50, 1
  s_cbranch_scc1 L_pE1_f
  s_cmp_eq_u32 s50, 0
  s_cbranch_scc1 L_pE0_f
  s_cmp_eq_u32 s50, 2
  s_cbranch_scc1 L_pB0_f
  s_branch L_pB1_f
L_pE0_f:
  buffer_load_dwordx4 v[28:31], v1, s[8:11], s38 offen offset:0 sc1
  buffer_load_dwordx4 v[32:35], v1, s[8:11], s38 offen offset:1024 sc1
  buffer_load_dwordx4 v[36:39], v1, s[8:11], s38 offen offset:2048 sc1
  buffer_load_dwordx4 v[40:43], v1, s[8:11], s38 offen offset:3072 sc1
  s_waitcnt lgkmcnt(0)
  s_waitcnt vmcnt(3)
  v_or3_b32 v26, v28, v28, v28
  v_mfma_f32_16x16x32_bf16 v[18:21], v[22:25], v[28:31], 0
  s_waitcnt vmcnt(2)
  v_or3_b32 v26, v26, v32, v32
  v_mfma_f32_16x16x32_bf16 v[18:21], v[22:25], v[32:35], v[18:21]
  s_waitcnt vmcnt(1)
  v_or3_b32 v26, v26, v36, v36
  v_mfma_f32_16x16x32_bf16 v[18:21], v[22:25], v[36:39], v[18:21]
  s_waitcnt vmcnt(0)
  v_or3_b32 v26, v26, v40, v40
  v_mfma_f32_16x16x32_bf16 v[18:21], v[22:25], v[40:43], v[18:21]
  v_and_b32 v26, 1, v26
  v_cmp_ne_u32 vcc, 0, v26
  s_cbranch_vccnz L_pE0_ff
  s_nop 3
  v_add_f32_dpp v18, v18, v18 row_ror:8 row_mask:0xf bank_mask:0xf
  v_add_f32_dpp v19, v19, v19 row_ror:8 row_mask:0xf bank_mask:0xf
  v_cvt_pk_bf16_f32 v18, v18, v19
  v_and_or_b32 v18, v18, -2, s30
  buffer_store_dword v18, v8, s[8:11], s43 offen
  s_branch L_redd_f
L_pE0_ff:
  s_mov_b64 exec, vcc
  buffer_load_dwordx4 v[28:31], v1, s[8:11], s38 offen offset:0 sc1
  buffer_load_dwordx4 v[32:35], v1, s[8:11], s38 offen offset:1024 sc1
  buffer_load_dwordx4 v[36:39], v1, s[8:11], s38 offen offset:2048 sc1
  buffer_load_dwordx4 v[40:43], v1, s[8:11], s38 offen offset:3072 sc1
  s_mov_b64 exec, -1
  s_nop 9
L_pE0_fr:
  s_mov_b64 exec, vcc
  buffer_load_dwordx4 v[28:31], v1, s[8:11], s38 offen offset:0 sc1
  buffer_load_dwordx4 v[32:35], v1, s[8:11], s38 offen offset:1024 sc1
  buffer_load_dwordx4 v[36:39], v1, s[8:11], s38 offen offset:2048 sc1
  buffer_load_dwordx4 v[40:43], v1, s[8:11], s38 offen offset:3072 sc1
  s_mov_b64 exec, -1
  s_add_u32 s27, s27, 1
  s_cmp_gt_u32 s27, 0x40000
  s_cbranch_scc1 L_abort
  s_waitcnt vmcnt(7)
  v_or3_b32 v26, v28, v28, v28
  v_mfma_f32_16x16x32_bf16 v[18:21], v[22:25], v[28:31], 0
  s_waitcnt vmcnt(6)
  v_or3_b32 v26, v26, v32, v32
  v_mfma_f32_16x16x32_bf16 v[18:21], v[22:25], v[32:35], v[18:21]
  s_waitcnt vmcnt(5)
  v_or3_b32 v26, v26, v36, v36
  v_mfma_f32_16x16x32_bf16 v[18:21], v[22:25], v[36:39], v[18:21]
  s_waitcnt vmcnt(4)
  v_or3_b32 v26, v26, v40, v40
  v_mfma_f32_16x16x32_bf16 v[18:21], v[22:25], v[40:43], v[18:21]
  v_and_b32 v26, 1, v26
  v_cmp_ne_u32 vcc, 0, v26
  s_cbranch_vccnz L_pE0_fr
  s_nop 3
  v_add_f32_dpp v18, v18, v18 row_ror:8 row_mask:0xf bank_mask:0xf
  v_add_f32_dpp v19, v19, v19 row_ror:8 row_mask:0xf bank_mask:0xf
  v_cvt_pk_bf16_f32 v18, v18, v19
  v_and_or_b32 v18, v18, -2, s30
  buffer_store_dword v18, v8, s[8:11], s43 offen
  s_branch L_redd_f
L_pE1_f:
  buffer_load_dwordx4 v[28:31], v1, s[8:11], s38 offen offset:0 sc1
  buffer_load_dwordx4 v[32:35], v1, s[8:11], s38 offen offset:1024 sc1
  buffer_load_dwordx4 v[36:39], v1, s[8:11], s38 offen offset:2048 sc1
  buffer_load_dwordx4 v[40:43], v1, s[8:11], s38 offen offset:3072 sc1
  s_waitcnt lgkmcnt(0)
  s_waitcnt vmcnt(3)
  v_bitop3_b32 v26, v28, v28, v28 bitop3:0x80
  v_mfma_f32_16x16x32_bf16 v[18:21], v[22:25], v[28:31], 0
  s_waitcnt vmcnt(2)
  v_bitop3_b32 v26, v26, v32, v32 bitop3:0x80
  v_mfma_f32_16x16x32_bf16 v[18:21], v[22:25], v[32:35], v[18:21]
  s_waitcnt vmcnt(1)
  v_bitop3_b32 v26, v26, v36, v36 bitop3:0x80
  v_mfma_f32_16x16x32_bf16 v[18:21], v[22:25], v[36:39], v[18:21]
  s_waitcnt vmcnt(0)
  v_bitop3_b32 v26, v26, v40, v40 bitop3:0x80
  v_mfma_f32_16x16x32_bf16 v[18:21], v[22:25], v[40:43], v[18:21]
  v_and_b32 v26, 1, v26
  v_cmp_ne_u32 vcc, 1, v26
  s_cbranch_vccnz L_pE1_ff
  s_nop 3
  v_add_f32_dpp v18, v18, v18 row_ror:8 row_mask:0xf bank_mask:0xf
  v_add_f32_dpp v19, v19, v19 row_ror:8 row_mask:0xf bank_mask:0xf
  v_cvt_pk_bf16_f32 v18, v18, v19
  v_and_or_b32 v18, v18, -2, s30
  buffer_store_dword v18, v8, s[8:11], s43 offen
  s_branch L_redd_f
L_pE1_ff:
  s_mov_b64 exec, vcc
  buffer_load_dwordx4 v[28:31], v1, s[8:11], s38 offen offset:0 sc1
  buffer_load_dwordx4 v[32:35], v1, s[8:11], s38 offen offset:1024 sc1
  buffer_load_dwordx4 v[36:39], v1, s[8:11], s38 offen offset:2048 sc1
  buffer_load_dwordx4 v[40:43], v1, s[8:11], s38 offen offset:3072 sc1
  s_mov_b64 exec, -1
  s_nop 9
L_pE1_fr:
  s_mov_b64 exec, vcc
  buffer_load_dwordx4 v[28:31], v1, s[8:11], s38 offen offset:0 sc1
  buffer_load_dwordx4 v[32:35], v1, s[8:11], s38 offen offset:1024 sc1
  buffer_load_dwordx4 v[36:39], v1, s[8:11], s38 offen offset:2048 sc1
  buffer_load_dwordx4 v[40:43], v1, s[8:11], s38 offen offset:3072 sc1
  s_mov_b64 exec, -1
  s_add_u32 s27, s27, 1
  s_cmp_gt_u32 s27, 0x40000
  s_cbranch_scc1 L_abort
  s_waitcnt vmcnt(7)
  v_bitop3_b32 v26, v28, v28, v28 bitop3:0x80
  v_mfma_f32_16x16x32_bf16 v[18:21], v[22:25], v[28:31], 0
  s_waitcnt vmcnt(6)
  v_bitop3_b32 v26, v26, v32, v32 bitop3:0x80
  v_mfma_f32_16x16x32_bf16 v[18:21], v[22:25], v[32:35], v[18:21]
  s_waitcnt vmcnt(5)
  v_bitop3_b32 v26, v26, v36, v36 bitop3:0x80
  v_mfma_f32_16x16x32_bf16 v[18:21], v[22:25], v[36:39], v[18:21]
  s_waitcnt vmcnt(4)
  v_bitop3_b32 v26, v26, v40, v40 bitop3:0x80
  v_mfma_f32_16x16x32_bf16 v[18:21], v[22:25], v[40:43], v[18:21]
  v_and_b32 v26, 1, v26
  v_cmp_ne_u32 vcc, 1, v26
  s_cbranch_vccnz L_pE1_fr
  s_nop 3
  v_add_f32_dpp v18, v18, v18 row_ror:8 row_mask:0xf bank_mask:0xf
  v_add_f32_dpp v19, v19, v19 row_ror:8 row_mask:0xf bank_mask:0xf
  v_cvt_pk_bf16_f32 v18, v18, v19
  v_and_or_b32 v18, v18, -2, s30
  buffer_store_dword v18, v8, s[8:11], s43 offen
  s_branch L_redd_f
L_pB0_f:
  buffer_load_dwordx4 v[28:31], v1, s[8:11], s38 offen offset:0 sc1
  buffer_load_dwordx4 v[32:35], v1, s[8:11], s38 offen offset:1024 sc1
  buffer_load_dwordx4 v[36:39], v1, s[8:11], s38 offen offset:2048 sc1
  buffer_load_dwordx4 v[40:43], v1, s[8:11], s38 offen offset:3072 sc1
  s_waitcnt lgkmcnt(0)
  s_waitcnt vmcnt(3)
  v_or3_b32 v26, v28, v28, v29
  v_or3_b32 v26, v26, v30, v31
  v_mfma_f32_16x16x32_bf16 v[18:21], v[22:25], v[28:31], 0
  s_waitcnt vmcnt(2)
  v_or3_b32 v26, v26, v32, v33
  v_or3_b32 v26, v26, v34, v35
  v_mfma_f32_16x16x32_bf16 v[18:21], v[22:25], v[32:35], v[18:21]
  s_waitcnt vmcnt(1)
  v_or3_b32 v26, v26, v36, v37
  v_or3_b32 v26, v26, v38, v39
  v_mfma_f32_16x16x32_bf16 v[18:21], v[22:25], v[36:39], v[18:21]
  s_waitcnt vmcnt(0)
  v_or3_b32 v26, v26, v40, v41
  v_or3_b32 v26, v26, v42, v43
  v_mfma_f32_16x16x32_bf16 v[18:21], v[22:25], v[40:43], v[18:21]
  v_and_b32 v26, 1, v26
  v_cmp_ne_u32 vcc, 0, v26
  s_cbranch_vccnz L_pB0_ff
  s_nop 3
  v_add_f32_dpp v18, v18, v18 row_ror:8 row_mask:0xf bank_mask:0xf
  v_add_f32_dpp v19, v19, v19 row_ror:8 row_mask:0xf bank_mask:0xf
  v_cvt_pk_bf16_f32 v18, v18, v19
  v_and_or_b32 v18, v18, -2, s30
  buffer_store_dword v18, v8, s[8:11], s43 offen
  s_branch L_redd_f
L_pB0_ff:
  s_mov_b64 exec, vcc
  buffer_load_dwordx4 v[28:31], v1, s[8:11], s38 offen offset:0 sc1
  buffer_load_dwordx4 v[32:35], v1, s[8:11], s38 offen offset:1024 sc1
  buffer_load_dwordx4 v[36:39], v1, s[8:11], s38 offen offset:2048 sc1
  buffer_load_dwordx4 v[40:43], v1, s[8:11], s38 offen offset:3072 sc1
  s_mov_b64 exec, -1
  s_nop 9
L_pB0_fr:
  s_mov_b64 exec, vcc
  buffer_load_dwordx4 v[28:31], v1, s[8:11], s38 offen offset:0 sc1
  buffer_load_dwordx4 v[32:35], v1, s[8:11], s38 offen offset:1024 sc1
  buffer_load_dwordx4 v[36:39], v1, s[8:11], s38 offen offset:2048 sc1
  buffer_load_dwordx4 v[40:43], v1, s[8:11], s38 offen offset:3072 sc1
  s_mov_b64 exec, -1
  s_add_u32 s27, s27, 1
  s_cmp_gt_u32 s27, 0x40000
  s_cbranch_scc1 L_abort
  s_waitcnt vmcnt(7)
  v_or3_b32 v26, v28, v28, v29
  v_or3_b32 v26, v26, v30, v31
  v_mfma_f32_16x16x32_bf16 v[18:21], v[22:25], v[28:31], 0
  s_waitcnt vmcnt(6)
  v_or3_b32 v26, v26, v32, v33
  v_or3_b32 v26, v26, v34, v35
  v_mfma_f32_16x16x32_bf16 v[18:21], v[22:25], v[32:35], v[18:21]
  s_waitcnt vmcnt(5)
  v_or3_b32 v26, v26, v36, v37
  v_or3_b32 v26, v26, v38, v39
  v_mfma_f32_16x16x32_bf16 v[18:21], v[22:25], v[36:39], v[18:21]
  s_waitcnt vmcnt(4)
  v_or3_b32 v26, v26, v40, v41
  v_or3_b32 v26, v26, v42, v43
  v_mfma_f32_16x16x32_bf16 v[18:21], v[22:25], v[40:43], v[18:21]
  v_and_b32 v26, 1, v26
  v_cmp_ne_u32 vcc, 0, v26
  s_cbranch_vccnz L_pB0_fr
  s_nop 3
  v_add_f32_dpp v18, v18, v18 row_ror:8 row_mask:0xf bank_mask:0xf
  v_add_f32_dpp v19, v19, v19 row_ror:8 row_mask:0xf bank_mask:0xf
  v_cvt_pk_bf16_f32 v18, v18, v19
  v_and_or_b32 v18, v18, -2, s30
  buffer_store_dword v18, v8, s[8:11], s43 offen
  s_branch L_redd_f
L_pB1_f:
  buffer_load_dwordx4 v[28:31], v1, s[8:11], s38 offen offset:0 sc1
  buffer_load_dwordx4 v[32:35], v1, s[8:11], s38 offen offset:1024 sc1
  buffer_load_dwordx4 v[36:39], v1, s[8:11], s38 offen offset:2048 sc1
  buffer_load_dwordx4 v[40:43], v1, s[8:11], s38 offen offset:3072 sc1
  s_waitcnt lgkmcnt(0)
  s_waitcnt vmcnt(3)
  v_bitop3_b32 v26, v28, v28, v29 bitop3:0x80
  v_bitop3_b32 v26, v26, v30, v31 bitop3:0x80
  v_mfma_f32_16x16x32_bf16 v[18:21], v[22:25], v[28:31], 0
  s_waitcnt vmcnt(2)
  v_bitop3_b32 v26, v26, v32, v33 bitop3:0x80
  v_bitop3_b32 v26, v26, v34, v35 bitop3:0x80
  v_mfma_f32_16x16x32_bf16 v[18:21], v[22:25], v[32:35], v[18:21]
  s_waitcnt vmcnt(1)
  v_bitop3_b32 v26, v26, v36, v37 bitop3:0x80
  v_bitop3_b32 v26, v26, v38, v39 bitop3:0x80
  v_mfma_f32_16x16x32_bf16 v[18:21], v[22:25], v[36:39], v[18:21]
  s_waitcnt vmcnt(0)
  v_bitop3_b32 v26, v26, v40, v41 bitop3:0x80
  v_bitop3_b32 v26, v26, v42, v43 bitop3:0x80
  v_mfma_f32_16x16x32_bf16 v[18:21], v[22:25], v[40:43], v[18:21]
  v_and_b32 v26, 1, v26
  v_cmp_ne_u32 vcc, 1, v26
  s_cbranch_vccnz L_pB1_ff
  s_nop 3
  v_add_f32_dpp v18, v18, v18 row_ror:8 row_mask:0xf bank_mask:0xf
  v_add_f32_dpp v19, v19, v19 row_ror:8 row_mask:0xf bank_mask:0xf
  v_cvt_pk_bf16_f32 v18, v18, v19
  v_and_or_b32 v18, v18, -2, s30
  buffer_store_dword v18, v8, s[8:11], s43 offen
  s_branch L_redd_f
L_pB1_ff:
  s_mov_b64 exec, vcc
  buffer_load_dwordx4 v[28:31], v1, s[8:11], s38 offen offset:0 sc1
  buffer_load_dwordx4 v[32:35], v1, s[8:11], s38 offen offset:1024 sc1
  buffer_load_dwordx4 v[36:39], v1, s[8:11], s38 offen offset:2048 sc1
  buffer_load_dwordx4 v[40:43], v1, s[8:11], s38 offen offset:3072 sc1
  s_mov_b64 exec, -1
  s_nop 9
L_pB1_fr:
  s_mov_b64 exec, vcc
  buffer_load_dwordx4 v[28:31], v1, s[8:11], s38 offen offset:0 sc1
  buffer_load_dwordx4 v[32:35], v1, s[8:11], s38 offen offset:1024 sc1
  buffer_load_dwordx4 v[36:39], v1, s[8:11], s38 offen offset:2048 sc1
  buffer_load_dwordx4 v[40:43], v1, s[8:11], s38 offen offset:3072 sc1
  s_mov_b64 exec, -1
  s_add_u32 s27, s27, 1
  s_cmp_gt_u32 s27, 0x40000
  s_cbranch_scc1 L_abort
  s_waitcnt vmcnt(7)
  v_bitop3_b32 v26, v28, v28, v29 bitop3:0x80
  v_bitop3_b32 v26, v26, v30, v31 bitop3:0x80
  v_mfma_f32_16x16x32_bf16 v[18:21], v[22:25], v[28:31], 0
  s_waitcnt vmcnt(6)
  v_bitop3_b32 v26, v26, v32, v33 bitop3:0x80
  v_bitop3_b32 v26, v26, v34, v35 bitop3:0x80
  v_mfma_f32_16x16x32_bf16 v[18:21], v[22:25], v[32:35], v[18:21]
  s_waitcnt vmcnt(5)
  v_bitop3_b32 v26, v26, v36, v37 bitop3:0x80
  v_bitop3_b32 v26, v26, v38, v39 bitop3:0x80
  v_mfma_f32_16x16x32_bf16 v[18:21], v[22:25], v[36:39], v[18:21]
  s_waitcnt vmcnt(4)
  v_bitop3_b32 v26, v26, v40, v41 bitop3:0x80
  v_bitop3_b32 v26, v26, v42, v43 bitop3:0x80
  v_mfma_f32_16x16x32_bf16 v[18:21], v[22:25], v[40:43], v[18:21]
  v_and_b32 v26, 1, v26
  v_cmp_ne_u32 vcc, 1, v26
  s_cbranch_vccnz L_pB1_fr
  s_nop 3
  v_add_f32_dpp v18, v18, v18 row_ror:8 row_mask:0xf bank_mask:0xf
  v_add_f32_dpp v19, v19, v19 row_ror:8 row_mask:0xf bank_mask:0xf
  v_cvt_pk_bf16_f32 v18, v18, v19
  v_and_or_b32 v18, v18, -2, s30
  buffer_store_dword v18, v8, s[8:11], s43 offen
  s_branch L_redd_f
L_note_f:
  s_cmp_ge_u32 s50, 6
  s_cbranch_scc1 L_nored_f
  v_mov_b64 v[28:29], 0
  v_mov_b64 v[30:31], 0
  v_mov_b64 v[32:33], 0
  v_mov_b64 v[34:35], 0
  v_mov_b64 v[36:37], 0
  v_mov_b64 v[38:39], 0
  v_mov_b64 v[40:41], 0
  v_mov_b64 v[42:43], 0
  v_mov_b64 v[44:45], 0
  v_mov_b64 v[46:47], 0
  s_nop 15
  s_nop 15
  s_nop 15
  s_nop 15
  s_nop 15
  s_cmp_eq_u32 s50, 5
  s_cbranch_scc1 L_pL1_f
L_pL0_f:
  buffer_load_dwordx4 v[10:13], v1, s[8:11], s38 offen offset:0 sc1
  buffer_load_dwordx4 v[14:17], v1, s[8:11], s38 offen offset:1024 sc1
  buffer_load_dwordx4 v[48:51], v1, s[8:11], s38 offen offset:2048 sc1
  buffer_load_dwordx4 v[64:67], v1, s[8:11], s38 offen offset:3072 sc1
  s_waitcnt lgkmcnt(0)
  s_waitcnt vmcnt(3)
  v_or3_b32 v26, v10, v10, v10
  v_mfma_f32_16x16x32_bf16 v[18:21], v[22:25], v[10:13], 0
  s_waitcnt vmcnt(2)
  v_or3_b32 v26, v26, v14, v14
  v_mfma_f32_16x16x32_bf16 v[18:21], v[22:25], v[14:17], v[18:21]
  s_waitcnt vmcnt(1)
  v_or3_b32 v26, v26, v48, v48
  v_mfma_f32_16x16x32_bf16 v[18:21], v[22:25], v[48:51], v[18:21]
  s_waitcnt vmcnt(0)
  v_or3_b32 v26, v26, v64, v64
  v_mfma_f32_16x16x32_bf16 v[18:21], v[22:25], v[64:67], v[18:21]
  v_and_b32 v26, 1, v26
  v_cmp_ne_u32 vcc, 0, v26
  s_cbranch_vccnz L_pL0_ff
  s_nop 3
  v_add_f32_dpp v18, v18, v18 row_ror:8 row_mask:0xf bank_mask:0xf
  v_add_f32_dpp v19, v19, v19 row_ror:8 row_mask:0xf bank_mask:0xf
  v_cvt_pk_bf16_f32 v18, v18, v19
  v_and_or_b32 v18, v18, -2, s30
  buffer_store_dword v18, v8, s[8:11], s43 offen
  s_branch L_d2l_f
L_pL0_ff:
  s_mov_b64 exec, vcc
  buffer_load_dwordx4 v[10:13], v1, s[8:11], s38 offen offset:0 sc1
  buffer_load_dwordx4 v[14:17], v1, s[8:11], s38 offen offset:1024 sc1
  buffer_load_dwordx4 v[48:51], v1, s[8:11], s38 offen offset:2048 sc1
  buffer_load_dwordx4 v[64:67], v1, s[8:11], s38 offen offset:3072 sc1
  s_mov_b64 exec, -1
  s_nop 9
L_pL0_fr:
  s_mov_b64 exec, vcc
  buffer_load_dwordx4 v[10:13], v1, s[8:11], s38 offen offset:0 sc1
  buffer_load_dwordx4 v[14:17], v1, s[8:11], s38 offen offset:1024 sc1
  buffer_load_dwordx4 v[48:51], v1, s[8:11], s38 offen offset:2048 sc1
  buffer_load_dwordx4 v[64:67], v1, s[8:11], s38 offen offset:3072 sc1
  s_mov_b64 exec, -1
  s_add_u32 s27, s27, 1
  s_cmp_gt_u32 s27, 0x40000
  s_cbranch_scc1 L_abort
  s_waitcnt vmcnt(7)
  v_or3_b32 v26, v10, v10, v10
  v_mfma_f32_16x16x32_bf16 v[18:21], v[22:25], v[10:13], 0
  s_waitcnt vmcnt(6)
  v_or3_b32 v26, v26, v14, v14
  v_mfma_f32_16x16x32_bf16 v[18:21], v[22:25], v[14:17], v[18:21]
  s_waitcnt vmcnt(5)
  v_or3_b32 v26, v26, v48, v48
  v_mfma_f32_16x16x32_bf16 v[18:21], v[22:25], v[48:51], v[18:21]
  s_waitcnt vmcnt(4)
  v_or3_b32 v26, v26, v64, v64
  v_mfma_f32_16x16x32_bf16 v[18:21], v[22:25], v[64:67], v[18:21]
  v_and_b32 v26, 1, v26
  v_cmp_ne_u32 vcc, 0, v26
  s_cbranch_vccnz L_pL0_fr
  s_nop 3
  v_add_f32_dpp v18, v18, v18 row_ror:8 row_mask:0xf bank_mask:0xf
  v_add_f32_dpp v19, v19, v19 row_ror:8 row_mask:0xf bank_mask:0xf
  v_cvt_pk_bf16_f32 v18, v18, v19
  v_and_or_b32 v18, v18, -2, s30
  buffer_store_dword v18, v8, s[8:11], s43 offen
  s_branch L_d2l_f
L_pL1_f:
  buffer_load_dwordx4 v[10:13], v1, s[8:11], s38 offen offset:0 sc1
  buffer_load_dwordx4 v[14:17], v1, s[8:11], s38 offen offset:1024 sc1
  buffer_load_dwordx4 v[48:51], v1, s[8:11], s38 offen offset:2048 sc1
  buffer_load_dwordx4 v[64:67], v1, s[8:11], s38 offen offset:3072 sc1
  s_waitcnt lgkmcnt(0)
  s_waitcnt vmcnt(3)
  v_bitop3_b32 v26, v10, v10, v10 bitop3:0x80
  v_mfma_f32_16x16x32_bf16 v[18:21], v[22:25], v[10:13], 0
  s_waitcnt vmcnt(2)
  v_bitop3_b32 v26, v26, v14, v14 bitop3:0x80
  v_mfma_f32_16x16x32_bf16 v[18:21], v[22:25], v[14:17], v[18:21]
  s_waitcnt vmcnt(1)
  v_bitop3_b32 v26, v26, v48, v48 bitop3:0x80
  v_mfma_f32_16x16x32_bf16 v[18:21], v[22:25], v[48:51], v[18:21]
  s_waitcnt vmcnt(0)
  v_bitop3_b32 v26, v26, v64, v64 bitop3:0x80
  v_mfma_f32_16x16x32_bf16 v[18:21], v[22:25], v[64:67], v[18:21]
  v_and_b32 v26, 1, v26
  v_cmp_ne_u32 vcc, 1, v26
  s_cbranch_vccnz L_pL1_ff
  s_nop 3
  v_add_f32_dpp v18, v18, v18 row_ror:8 row_mask:0xf bank_mask:0xf
  v_add_f32_dpp v19, v19, v19 row_ror:8 row_mask:0xf bank_mask:0xf
  v_cvt_pk_bf16_f32 v18, v18, v19
  v_and_or_b32 v18, v18, -2, s30
  buffer_store_dword v18, v8, s[8:11], s43 offen
  s_branch L_d2l_f
L_pL1_ff:
  s_mov_b64 exec, vcc
  buffer_load_dwordx4 v[10:13], v1, s[8:11], s38 offen offset:0 sc1
  buffer_load_dwordx4 v[14:17], v1, s[8:11], s38 offen offset:1024 sc1
  buffer_load_dwordx4 v[48:51], v1, s[8:11], s38 offen offset:2048 sc1
  buffer_load_dwordx4 v[64:67], v1, s[8:11], s38 offen offset:3072 sc1
  s_mov_b64 exec, -1
  s_nop 9
L_pL1_fr:
  s_mov_b64 exec, vcc
  buffer_load_dwordx4 v[10:13], v1, s[8:11], s38 offen offset:0 sc1
  buffer_load_dwordx4 v[14:17], v1, s[8:11], s38 offen offset:1024 sc1
  buffer_load_dwordx4 v[48:51], v1, s[8:11], s38 offen offset:2048 sc1
  buffer_load_dwordx4 v[64:67], v1, s[8:11], s38 offen offset:3072 sc1
  s_mov_b64 exec, -1
  s_add_u32 s27, s27, 1
  s_cmp_gt_u32 s27, 0x40000
  s_cbranch_scc1 L_abort
  s_waitcnt vmcnt(7)
  v_bitop3_b32 v26, v10, v10, v10 bitop3:0x80
  v_mfma_f32_16x16x32_bf16 v[18:21], v[22:25], v[10:13], 0
  s_waitcnt vmcnt(6)
  v_bitop3_b32 v26, v26, v14, v14 bitop3:0x80
  v_mfma_f32_16x16x32_bf16 v[18:21], v[22:25], v[14:17], v[18:21]
  s_waitcnt vmcnt(5)
  v_bitop3_b32 v26, v26, v48, v48 bitop3:0x80
  v_mfma_f32_16x16x32_bf16 v[18:21], v[22:25], v[48:51], v[18:21]
  s_waitcnt vmcnt(4)
  v_bitop3_b32 v26, v26, v64, v64 bitop3:0x80
  v_mfma_f32_16x16x32_bf16 v[18:21], v[22:25], v[64:67], v[18:21]
  v_and_b32 v26, 1, v26
  v_cmp_ne_u32 vcc, 1, v26
  s_cbranch_vccnz L_pL1_fr
  s_nop 3
  v_add_f32_dpp v18, v18, v18 row_ror:8 row_mask:0xf bank_mask:0xf
  v_add_f32_dpp v19, v19, v19 row_ror:8 row_mask:0xf bank_mask:0xf
  v_cvt_pk_bf16_f32 v18, v18, v19
  v_and_or_b32 v18, v18, -2, s30
  buffer_store_dword v18, v8, s[8:11], s43 offen
  s_branch L_d2l_f
L_late_retry_f:
  s_mov_b32 s27, 0
L_late_loop_f:
  buffer_load_dwordx4 v[22:25], v1, s[8:11], s43 offen offset:1024 sc1
  s_add_u32 s27, s27, 1
  s_cmp_gt_u32 s27, 0x40000
  s_cbranch_scc1 L_abort
  s_waitcnt vmcnt(0)
  v_bitop3_b32 v27, v22, v23, s30 bitop3:0x7e
  v_bitop3_b32 v27, v27, v24, s30 bitop3:0xf6
  v_bitop3_b32 v27, v27, v25, s30 bitop3:0xf6
  v_and_b32 v27, 1, v27
  v_cmp_ne_u32 vcc, 0, v27
  s_cbranch_vccnz L_late_loop_f
  ds_write_b128 v1, v[22:25] offset:1024
  s_waitcnt lgkmcnt(0)
  s_branch L_late_ok_f
L_nored_f:
  s_cmp_lt_u32 s22, s3
  s_cbranch_scc1 L_kvok_f
  s_mov_b32 s27, 0
  v_and_b32 v27, 28, v2
L_kvw_f:
  buffer_load_dword v26, v27, s[16:19], 0 offen offset:64 sc1
  s_add_u32 s27, s27, 1
  s_cmp_gt_u32 s27, 0x40000
  s_cbranch_scc1 L_abort
  s_waitcnt vmcnt(0)
  v_cmp_gt_u32 vcc, 28, v26
  s_nop 1
  s_ff1_i32_b32 s3, vcc_lo
  s_and_b32 s3, s3, 15
  s_lshl_b32 s3, s3, 3
  s_sub_u32 s3, s3, 3
  s_cmp_ge_u32 s22, s3
  s_cbranch_scc1 L_kvw_f
  s_waitcnt vmcnt(3)
  ds_write_b128 v1, v[52:55] offset:16384
  ds_write_b128 v1, v[56:59] offset:17408
  v_mov_b64 v[10:11], v[68:69]
  v_mov_b64 v[12:13], v[70:71]
  v_mov_b64 v[14:15], v[60:61]
  v_mov_b64 v[16:17], v[62:63]
  v_mov_b64 v[28:29], 0
  v_mov_b64 v[30:31], 0
  v_mov_b64 v[32:33], 0
  v_mov_b64 v[34:35], 0
  v_mov_b64 v[36:37], 0
  v_mov_b64 v[38:39], 0
  v_mov_b64 v[40:41], 0
  v_mov_b64 v[42:43], 0
  v_mov_b64 v[44:45], 0
  v_mov_b64 v[46:47], 0
  v_mov_b64 v[48:49], 0
  v_mov_b64 v[50:51], 0
  s_branch L_post_f
L_kvok_f:
  s_waitcnt vmcnt(3)
  ds_write_b128 v1, v[52:55] offset:16384
  ds_write_b128 v1, v[56:59] offset:17408
  v_mov_b64 v[10:11], v[68:69]
  v_mov_b64 v[12:13], v[70:71]
  v_mov_b64 v[14:15], v[60:61]
  v_mov_b64 v[16:17], v[62:63]
  v_mov_b64 v[28:29], 0
  v_mov_b64 v[30:31], 0
  v_mov_b64 v[32:33], 0
  v_mov_b64 v[34:35], 0
  v_mov_b64 v[36:37], 0
  v_mov_b64 v[38:39], 0
  v_mov_b64 v[40:41], 0
  v_mov_b64 v[42:43], 0
  v_mov_b64 v[44:45], 0
  v_mov_b64 v[46:47], 0
  v_mov_b64 v[48:49], 0
  v_mov_b64 v[50:51], 0
  s_nop 15
  s_nop 15
  s_nop 15
  s_nop 15
  s_nop 15
  s_nop 15
  s_nop 15
  s_nop 7
  s_branch L_post_f
L_redd_f:
  s_waitcnt vmcnt(1)
  ds_write_b128 v1, v[52:55] offset:16384
  ds_write_b128 v1, v[56:59] offset:17408
  v_mov_b64 v[10:11], v[68:69]
  v_mov_b64 v[12:13], v[70:71]
  v_mov_b64 v[14:15], v[60:61]
  v_mov_b64 v[16:17], v[62:63]
  v_mov_b64 v[28:29], 0
  v_mov_b64 v[30:31], 0
  v_mov_b64 v[32:33], 0
  v_mov_b64 v[34:35], 0
  v_mov_b64 v[36:37], 0
  v_mov_b64 v[38:39], 0
  v_mov_b64 v[40:41], 0
  v_mov_b64 v[42:43], 0
  v_mov_b64 v[44:45], 0
  v_mov_b64 v[46:47], 0
  v_mov_b64 v[48:49], 0
  v_mov_b64 v[50:51], 0
  s_branch L_post_f
L_d2l_f:
  buffer_load_dwordx4 v[18:21], v1, s[8:11], s43 offen sc1
  buffer_load_dword v26, v2, s[8:11], s44 offen sc1
  s_waitcnt vmcnt(3)
  ds_write_b128 v1, v[52:55] offset:16384
  ds_write_b128 v1, v[56:59] offset:17408
  v_mov_b64 v[10:11], v[68:69]
  v_mov_b64 v[12:13], v[70:71]
  v_mov_b64 v[14:15], v[60:61]
  v_mov_b64 v[16:17], v[62:63]
  v_mov_b64 v[48:49], 0
  v_mov_b64 v[50:51], 0
  s_mov_b32 s27, 0
  s_branch L_p2x_f
L_post_f:
  s_branch L_step_f
L_done_f:
  s_waitcnt vmcnt(0)
  s_endpgm
L_step_s:
  s_mov_b32 s27, 0
  buffer_load_dwordx4 v[18:21], v1, s[8:11], s43 offen sc1
  buffer_load_dword v26, v2, s[8:11], s44 offen sc1
L_p2x_s:
  ds_read_b128 v[52:55], v1 offset:24576
  ds_read_b128 v[56:59], v1 offset:25600
  s_cmp_eq_u32 s30, 0
  s_cbranch_scc1 L_p2x_0_s
L_p2x_1_s:
  s_waitcnt vmcnt(0)
  v_bitop3_b32 v27, v18, v19, v20 bitop3:0x80
  v_bitop3_b32 v27, v27, v21, v26 bitop3:0x80
  v_and_b32 v27, 1, v27
  v_cmp_ne_u32 vcc, 1, v27
  ds_write_b128 v1, v[18:21]
  ds_write_b32 v2, v26 offset:8192
  s_cbranch_vccz L_have_img_s
L_p2f_1_s:
  s_mov_b64 exec, vcc
  buffer_load_dwordx4 v[18:21], v1, s[8:11], s43 offen sc1
  buffer_load_dword v26, v2, s[8:11], s44 offen sc1
  s_mov_b64 exec, -1
  s_nop 9
L_p2r_1_s:
  s_mov_b64 exec, vcc
  buffer_load_dwordx4 v[18:21], v1, s[8:11], s43 offen sc1
  buffer_load_dword v26, v2, s[8:11], s44 offen sc1
  s_mov_b64 exec, -1
  s_add_u32 s27, s27, 1
  s_cmp_gt_u32 s27, 0x40000
  s_cbranch_scc1 L_abort
  s_waitcnt vmcnt(2)
  v_bitop3_b32 v27, v18, v19, v20 bitop3:0x80
  v_bitop3_b32 v27, v27, v21, v26 bitop3:0x80
  v_and_b32 v27, 1, v27
  v_cmp_ne_u32 vcc, 1, v27
  ds_write_b128 v1, v[18:21]
  ds_write_b32 v2, v26 offset:8192
  s_cbranch_vccnz L_p2r_1_s
  s_branch L_have_img_s
L_p2f_0_s:
  s_mov_b64 exec, vcc
  buffer_load_dwordx4 v[18:21], v1, s[8:11], s43 offen sc1
  buffer_load_dword v26, v2, s[8:11], s44 offen sc1
  s_mov_b64 exec, -1
  s_nop 9
L_p2r_0_s:
  s_mov_b64 exec, vcc
  buffer_load_dwordx4 v[18:21], v1, s[8:11], s43 offen sc1
  buffer_load_dword v26, v2, s[8:11], s44 offen sc1
  s_mov_b64 exec, -1
  s_add_u32 s27, s27, 1
  s_cmp_gt_u32 s27, 0x40000
  s_cbranch_scc1 L_abort
  s_waitcnt vmcnt(2)
  v_or3_b32 v27, v18, v19, v20
  v_or3_b32 v27, v27, v21, v26
  v_and_b32 v27, 1, v27
  v_cmp_ne_u32 vcc, 0, v27
  ds_write_b128 v1, v[18:21]
  ds_write_b32 v2, v26 offset:8192
  s_cbranch_vccnz L_p2r_0_s
  s_branch L_have_img_s
L_p2x_0_s:
  s_waitcnt vmcnt(0)
  v_or3_b32 v27, v18, v19, v20
  v_or3_b32 v27, v27, v21, v26
  v_and_b32 v27, 1, v27
  v_cmp_ne_u32 vcc, 0, v27
  ds_write_b128 v1, v[18:21]
  ds_write_b32 v2, v26 offset:8192
  s_cbranch_vccnz L_p2f_0_s
L_have_img_s:
  v_smfmac_f32_16x16x64_bf16 v[28:31], v[18:21], a[0:7], v0
  v_smfmac_f32_16x16x64_bf16 v[32:35], v[18:21], a[8:15], v0
  v_xor_b32 v68, 2048, v1
  v_smfmac_f32_16x16x64_bf16 v[36:39], v[18:21], a[16:23], v0
  s_waitcnt lgkmcnt(0)
  s_barrier
  ds_read_b128 v[68:71], v68 offset:0
  v_smfmac_f32_16x16x64_bf16 v[40:43], v[18:21], a[24:31], v0
  ds_read_b128 v[60:63], v1 offset:32768
  v_smfmac_f32_16x16x64_bf16 v[44:47], v[18:21], a[32:39], v0
  ds_read_b128 v[64:67], v1 offset:33792
  v_smfmac_f32_16x16x64_bf16 v[48:51], v[18:21], v[52:59], v0
  s_waitcnt vmcnt(0)
  ds_read_b128 v[52:55], v1 offset:40960
  s_waitcnt lgkmcnt(3)
  v_xor_b32 v18, 4096, v1
  v_smfmac_f32_16x16x64_bf16 v[28:31], v[68:71], a[40:47], v0
  ds_read_b128 v[18:21], v18 offset:0
  ds_read_b128 v[56:59], v1 offset:41984
  v_smfmac_f32_16x16x64_bf16 v[32:35], v[68:71], a[48:55], v0
  buffer_load_dwordx4 v[22:25], v1, s[8:11], s43 offen offset:1024 sc1
  s_waitcnt lgkmcnt(3)
  v_add_u32 v9, 0x10000, v1
  v_smfmac_f32_16x16x64_bf16 v[36:39], v[68:71], v[60:67], v0
  ds_read_b128 v[60:63], v1 offset:49152
  v_smfmac_f32_16x16x64_bf16 v[40:43], v[68:71], a[56:63], v0
  ds_read_b128 v[64:67], v1 offset:50176
  s_add_u32 s22, s22, 1
  v_smfmac_f32_16x16x64_bf16 v[44:47], v[68:71], a[64:71], v0
  s_add_u32 s31, s31, 262144
  s_waitcnt lgkmcnt(2)
  v_smfmac_f32_16x16x64_bf16 v[48:51], v[68:71], v[52:59], v0
  ds_read_b128 v[52:55], v1 offset:57344
  v_xor_b32 v68, 6144, v1
  v_smfmac_f32_16x16x64_bf16 v[28:31], v[18:21], a[72:79], v0
  ds_read_b128 v[68:71], v68 offset:0
  ds_read_b128 v[56:59], v1 offset:58368
  v_smfmac_f32_16x16x64_bf16 v[32:35], v[18:21], a[80:87], v0
  s_add_u32 s32, s32, 262144
  s_waitcnt lgkmcnt(3)
  v_smfmac_f32_16x16x64_bf16 v[36:39], v[18:21], v[60:67], v0
  ds_read_b128 v[60:63], v9 offset:0
  v_smfmac_f32_16x16x64_bf16 v[40:43], v[18:21], a[88:95], v0
  ds_read_b128 v[64:67], v9 offset:1024
  s_add_u32 s23, s31, s45
  v_smfmac_f32_16x16x64_bf16 v[44:47], v[18:21], a[96:103], v0
  s_add_u32 s24, s32, s45
  s_waitcnt lgkmcnt(2)
  v_smfmac_f32_16x16x64_bf16 v[48:51], v[18:21], v[52:59], v0
  ds_read_b128 v[52:55], v9 offset:8192
  v_xor_b32 v18, s36, v1
  v_smfmac_f32_16x16x64_bf16 v[28:31], v[68:71], a[104:111], v0
  ds_read_b128 v[18:21], v18 offset:8192
  ds_read_b128 v[56:59], v9 offset:9216
  v_smfmac_f32_16x16x64_bf16 v[32:35], v[68:71], a[112:119], v0
  s_add_u32 s33, s33, 262144
  s_waitcnt lgkmcnt(3)
  v_smfmac_f32_16x16x64_bf16 v[36:39], v[68:71], v[60:67], v0
  ds_read_b128 v[60:63], v9 offset:16384
  s_mov_b32 s43, 1310720
  v_smfmac_f32_16x16x64_bf16 v[40:43], v[68:71], a[120:127], v0
  ds_read_b128 v[64:67], v9 offset:17408
  s_add_u32 s34, s34, 262144
  v_smfmac_f32_16x16x64_bf16 v[44:47], v[68:71], a[128:135], v0
  s_waitcnt vmcnt(0)
  ds_write_b128 v1, v[22:25] offset:1024
  s_mov_b32 m0, 13568
  s_waitcnt lgkmcnt(3)
  v_bitop3_b32 v27, v22, v23, s30 bitop3:0x7e
  v_smfmac_f32_16x16x64_bf16 v[48:51], v[68:71], v[52:59], v0
  buffer_load_dword v2, s[52:55], s23 idxen sc1 lds
  v_bitop3_b32 v27, v27, v24, s30 bitop3:0xf6
  v_smfmac_f32_16x16x64_bf16 v[28:31], v[18:21], a[136:143], v0
  ds_read_b128 v[52:55], v9 offset:24576
  s_add_u32 s25, s22, 1
  v_bitop3_b32 v27, v27, v25, s30 bitop3:0xf6
  v_smfmac_f32_16x16x64_bf16 v[32:35], v[18:21], a[144:151], v0
  ds_read_b128 v[56:59], v9 offset:25600
  buffer_load_dword v2, s[52:55], s24 idxen sc1 lds
  s_waitcnt lgkmcnt(3)
  v_and_b32 v27, s51, v27
  v_smfmac_f32_16x16x64_bf16 v[36:39], v[18:21], v[60:67], v0
  ds_read_b128 v[60:63], v9 offset:32768
  v_cmp_ne_u32 vcc, 0, v27
  v_smfmac_f32_16x16x64_bf16 v[40:43], v[18:21], a[152:159], v0
  ds_read_b128 v[64:67], v9 offset:33792
  v_xor_b32 v68, 2048, v1
  v_smfmac_f32_16x16x64_bf16 v[44:47], v[18:21], a[160:167], v0
  s_cbranch_vccnz L_late_retry_s
L_late_ok_s:
  s_waitcnt lgkmcnt(2)
  v_mov_b32 v27, s25
  v_smfmac_f32_16x16x64_bf16 v[48:51], v[18:21], v[52:59], v0
  s_barrier
  ds_read_b128 v[52:55], v9 offset:40960
  v_xor_b32 v18, 4096, v1
  v_smfmac_f32_16x16x64_bf16 v[28:31], v[22:25], a[168:175], v0
  ds_read_b128 v[68:71], v68 offset:1024
  ds_read_b128 v[56:59], v9 offset:41984
  v_smfmac_f32_16x16x64_bf16 v[32:35], v[22:25], a[176:183], v0
  ds_read_b128 v[18:21], v18 offset:1024
  s_waitcnt lgkmcnt(4)
  v_smfmac_f32_16x16x64_bf16 v[36:39], v[22:25], v[60:67], v0
  ds_read_b128 v[60:63], v9 offset:49152
  v_smfmac_f32_16x16x64_bf16 v[40:43], v[22:25], a[184:191], v0
  ds_read_b128 v[64:67], v9 offset:50176
  buffer_store_dword v27, off, s[8:11], s37 sc1
  v_smfmac_f32_16x16x64_bf16 v[44:47], v[22:25], a[192:199], v0
  s_waitcnt lgkmcnt(3)
  v_smfmac_f32_16x16x64_bf16 v[48:51], v[22:25], v[52:59], v0
  ds_read_b128 v[52:55], v9 offset:57344
  v_xor_b32 v22, 6144, v1
  v_smfmac_f32_16x16x64_bf16 v[28:31], v[68:71], a[200:207], v0
  ds_read_b128 v[22:25], v22 offset:1024
  ds_read_b128 v[56:59], v9 offset:58368
  v_smfmac_f32_16x16x64_bf16 v[32:35], v[68:71], a[208:215], v0
  s_mov_b32 s51, 1
  s_waitcnt lgkmcnt(3)
  v_add_u32 v9, 0x20000, v1
  v_smfmac_f32_16x16x64_bf16 v[36:39], v[68:71], v[60:67], v0
  ds_read_b128 v[60:63], v9 offset:0
  s_xor_b32 s30, s30, 1
  v_smfmac_f32_16x16x64_bf16 v[40:43], v[68:71], a[216:223], v0
  ds_read_b128 v[64:67], v9 offset:1024
  v_smfmac_f32_16x16x64_bf16 v[28:31], v[18:21], a[224:231], v0
  s_waitcnt lgkmcnt(2)
  v_smfmac_f32_16x16x64_bf16 v[32:35], v[18:21], v[52:59], v0
  ds_read_b128 v[52:55], v9 offset:8192
  v_smfmac_f32_16x16x64_bf16 v[36:39], v[18:21], a[232:239], v0
  ds_read_b128 v[56:59], v9 offset:9216
  v_smfmac_f32_16x16x64_bf16 v[40:43], v[18:21], a[240:247], v0
  s_waitcnt lgkmcnt(2)
  v_xor_b32 v27, s36, v1
  v_smfmac_f32_16x16x64_bf16 v[28:31], v[22:25], v[60:67], v0
  ds_read_b128 v[60:63], v9 offset:16384
  s_xor_b32 s50, s50, 1
  v_lshlrev_b32 v26, 1, v2
  v_smfmac_f32_16x16x64_bf16 v[32:35], v[22:25], a[248:255], v0
  ds_read_b128 v[64:67], v9 offset:17408
  s_mov_b32 s27, 0
  v_smfmac_f32_16x16x64_bf16 v[36:39], v[22:25], v[72:79], v0
  s_waitcnt lgkmcnt(2)
  v_add_f32 v28, v28, v30
  v_smfmac_f32_16x16x64_bf16 v[40:43], v[22:25], v[52:59], v0
  ds_read_b128 v[52:55], v9 offset:24576
  v_add_f32 v29, v29, v31
  v_smfmac_f32_16x16x64_bf16 v[44:47], v[68:71], v[80:87], v0
  ds_read_b128 v[56:59], v9 offset:25600
  v_add_f32 v32, v32, v34
  v_add_f32 v33, v33, v35
  v_smfmac_f32_16x16x64_bf16 v[48:51], v[68:71], v[88:95], v0
  s_waitcnt lgkmcnt(2)
  v_cvt_pk_bf16_f32 v28, v28, v32
  v_cvt_pk_bf16_f32 v30, v29, v33
  v_add_f32 v36, v36, v38
  v_add_f32 v40, v40, v42
  v_add_f32 v37, v37, v39
  v_add_f32 v41, v41, v43
  v_cvt_pk_bf16_f32 v29, v36, v40
  v_cvt_pk_bf16_f32 v31, v37, v41
  ds_write2_b64 v3, v[28:29], v[30:31] offset0:0 offset1:68
  v_smfmac_f32_16x16x64_bf16 v[44:47], v[18:21], v[60:67], v0
  ds_read_b128 v[68:71], v27 offset:16384
  v_or_b32 v28, 1, v28
  v_smfmac_f32_16x16x64_bf16 v[48:51], v[18:21], v[96:103], v0
  buffer_store_dwordx2 v[28:29], v26, s[8:11], s33 offen sc1
  ds_read_b128 v[60:63], v27 offset:17408
  v_or_b32 v30, 1, v30
  v_smfmac_f32_16x16x64_bf16 v[44:47], v[22:25], v[104:111], v0
  buffer_store_dwordx2 v[30:31], v26, s[8:11], s33 offen offset:1024 sc1
  s_waitcnt lgkmcnt(3)
  v_smfmac_f32_16x16x64_bf16 v[48:51], v[22:25], v[52:59], v0
  s_waitcnt lgkmcnt(2)
  s_barrier
  ds_read_b128 v[28:31], v4 offset:0
  ds_read_b128 v[32:35], v4 offset:64
  ds_read_b128 v[40:43], v4 offset:128
  ds_read_b128 v[22:25], v4 offset:192
  s_waitcnt lgkmcnt(3)
  v_mfma_f32_16x16x32_bf16 v[36:39], v[28:31], v[28:31], 0
  ds_read_b128 v[64:67], v27 offset:18432
  s_waitcnt lgkmcnt(3)
  v_cvt_pk_bf16_f32 v44, v44, v45
  v_mfma_f32_16x16x32_bf16 v[36:39], v[32:35], v[32:35], v[36:39]
  ds_read_b128 v[18:21], v27 offset:19456
  s_waitcnt lgkmcnt(3)
  v_cvt_pk_bf16_f32 v45, v46, v47
  v_mfma_f32_16x16x32_bf16 v[36:39], v[40:43], v[40:43], v[36:39]
  ds_read_b128 v[52:55], v27 offset:20480
  s_waitcnt lgkmcnt(3)
  v_cvt_pk_bf16_f32 v46, v48, v49
  v_mfma_f32_16x16x32_bf16 v[36:39], v[22:25], v[22:25], v[36:39]
  ds_read_b128 v[56:59], v27 offset:21504
  v_cvt_pk_bf16_f32 v47, v50, v51
  v_mfma_f32_16x16x32_bf16 v[48:51], v[68:71], v[28:31], 0
  ds_read_b128 v[68:71], v27 offset:22528
  v_or_b32 v44, 1, v44
  v_mfma_f32_16x16x32_bf16 v[48:51], v[60:63], v[32:35], v[48:51]
  ds_read_b128 v[60:63], v27 offset:23552
  s_waitcnt lgkmcnt(5)
  v_mfma_f32_16x16x32_bf16 v[48:51], v[64:67], v[40:43], v[48:51]
  buffer_store_dwordx4 v[44:47], v1, s[8:11], s34 offen sc1
  s_waitcnt lgkmcnt(4)
  v_mfma_f32_16x16x32_bf16 v[48:51], v[18:21], v[22:25], v[48:51]
  s_cmp_eq_u32 s22, 63
  s_cbranch_scc1 L_done_s
  s_waitcnt lgkmcnt(3)
  v_mfma_f32_16x16x32_bf16 v[64:67], v[52:55], v[28:31], 0
  s_waitcnt lgkmcnt(2)
  v_mov_b32 v28, 0x3f803f80
  v_mfma_f32_16x16x32_bf16 v[64:67], v[56:59], v[32:35], v[64:67]
  buffer_load_dwordx4 v[52:55], v1, s[8:11], s31 offen sc1
  s_waitcnt lgkmcnt(1)
  v_max3_f32 v26, v38, v39, v48
  v_mfma_f32_16x16x32_bf16 v[64:67], v[68:71], v[40:43], v[64:67]
  s_waitcnt lgkmcnt(0)
  v_max3_f32 v26, v26, v49, v50
  v_mfma_f32_16x16x32_bf16 v[64:67], v[60:63], v[22:25], v[64:67]
  v_max_f32 v26, v26, v51
  v_mov_b32 v29, 0x3f803f80
  v_mov_b32 v30, 0x3f803f80
  v_mov_b32 v31, 0x3f803f80
  v_mov_b32 v32, 0x3f803f80
  v_mov_b32 v33, 0
  s_nop 0
  v_max3_f32 v26, v26, v64, v65
  v_max3_f32 v26, v26, v66, v67
  v_mov_b32 v24, v26
  buffer_load_dwordx4 v[56:59], v1, s[8:11], s31 offen offset:1024 sc1
  s_nop 0
  v_permlane16_swap_b32 v26, v24
  v_max_f32 v26, v26, v24
  v_mov_b32 v24, v26
  s_nop 1
  v_permlane32_swap_b32 v26, v24
  v_max_f32 v26, v26, v24
  v_mul_f32 v26, s28, v26
  v_pk_fma_f32 v[48:49], v[48:49], s[28:29], v[26:27] op_sel_hi:[1,0,0] neg_lo:[0,0,1] neg_hi:[0,0,1]
  v_pk_fma_f32 v[50:51], v[50:51], s[28:29], v[26:27] op_sel_hi:[1,0,0] neg_lo:[0,0,1] neg_hi:[0,0,1]
  v_pk_fma_f32 v[64:65], v[64:65], s[28:29], v[26:27] op_sel_hi:[1,0,0] neg_lo:[0,0,1] neg_hi:[0,0,1]
  v_pk_fma_f32 v[66:67], v[66:67], s[28:29], v[26:27] op_sel_hi:[1,0,0] neg_lo:[0,0,1] neg_hi:[0,0,1]
  v_pk_fma_f32 v[38:39], v[38:39], s[28:29], v[26:27] op_sel_hi:[1,0,0] neg_lo:[0,0,1] neg_hi:[0,0,1]
  v_exp_f32_dpp v48, v48 quad_perm:[0,1,0,1] row_mask:0xf bank_mask:0xf
  buffer_load_dwordx4 v[68:71], v1, s[8:11], s32 offen sc1
  v_exp_f32_dpp v49, v49 quad_perm:[0,1,0,1] row_mask:0xf bank_mask:0xf
  v_exp_f32_dpp v50, v50 quad_perm:[0,1,0,1] row_mask:0xf bank_mask:0xf
  v_exp_f32_dpp v51, v51 quad_perm:[0,1,0,1] row_mask:0xf bank_mask:0xf
  v_exp_f32_dpp v64, v64 quad_perm:[0,1,0,1] row_mask:0xf bank_mask:0xf
  v_exp_f32_dpp v65, v65 quad_perm:[0,1,0,1] row_mask:0xf bank_mask:0xf
  v_exp_f32_dpp v66, v66 quad_perm:[0,1,0,1] row_mask:0xf bank_mask:0xf
  v_exp_f32_dpp v67, v67 quad_perm:[0,1,0,1] row_mask:0xf bank_mask:0xf
  buffer_load_dwordx4 v[60:63], v1, s[8:11], s32 offen offset:1024 sc1
  v_cvt_pk_bf16_f32 v40, v48, v49
  v_cvt_pk_bf16_f32 v41, v50, v51
  v_cvt_pk_bf16_f32 v42, v64, v65
  v_cvt_pk_bf16_f32 v43, v66, v67
  v_exp_f32_dpp v38, v38 quad_perm:[0,1,0,1] row_mask:0xf bank_mask:0xf
  v_exp_f32_dpp v39, v39 quad_perm:[0,1,0,1] row_mask:0xf bank_mask:0xf
  v_mfma_f32_16x16x32_bf16 v[18:21], v[28:31], v[40:43], 0
  v_cvt_pk_bf16_f32 v34, v38, v39
  v_mfma_f32_16x16x32_bf16 v[22:25], v[10:13], v[40:43], 0
  v_cvt_pk_bf16_f32 v35, v38, v39
  v_mfma_f32_16x16x32_bf16 v[36:39], v[14:17], v[40:43], 0
  v_mov_b64 v[64:65], 0
  v_mfma_f32_16x16x16_bf16 v[18:21], v[32:33], v[34:35], v[18:21]
  v_mov_b64 v[66:67], 0
  v_mfma_f32_16x16x16_bf16 v[22:25], v[44:45], v[34:35], v[22:25]
  v_xor_b32 v10, 512, v5
  v_mfma_f32_16x16x16_bf16 v[36:39], v[46:47], v[34:35], v[36:39]
  v_xor_b32 v14, 1024, v5
  v_rcp_f32 v18, v18
  v_mov_b64 v[40:41], 0
  v_mov_b64 v[32:33], 0
  v_mov_b64 v[34:35], 0
  v_pk_mul_f32 v[22:23], v[22:23], v[18:19] op_sel_hi:[1,0]
  v_pk_mul_f32 v[24:25], v[24:25], v[18:19] op_sel_hi:[1,0]
  v_pk_mul_f32 v[36:37], v[36:37], v[18:19] op_sel_hi:[1,0]
  v_pk_mul_f32 v[38:39], v[38:39], v[18:19] op_sel_hi:[1,0]
  v_cvt_pk_bf16_f32 v28, v22, v36
  v_cvt_pk_bf16_f32 v29, v23, v37
  v_cvt_pk_bf16_f32 v30, v24, v38
  v_cvt_pk_bf16_f32 v31, v25, v39
  ds_write_b128 v5, v[28:31]
  v_xor_b32 v18, 1536, v5
  v_smfmac_f32_16x16x64_bf16 v[32:35], v[28:31], v[112:119], v0
  v_mov_b64 v[42:43], 0
  v_smfmac_f32_16x16x64_bf16 v[64:67], v[28:31], v[176:183], v0
  v_mov_b64 v[44:45], 0
  v_smfmac_f32_16x16x64_bf16 v[40:43], v[28:31], v[144:151], v0
  v_mov_b64 v[46:47], 0
  s_waitcnt lgkmcnt(0)
  s_barrier
  ds_read_b128 v[10:13], v10
  ds_read_b128 v[14:17], v14
  ds_read_b128 v[18:21], v18
  v_smfmac_f32_16x16x64_bf16 v[44:47], v[28:31], v[208:215], v0
  ds_read_b128 v[22:25], v27 offset:14336
  ds_read_b128 v[36:39], v27 offset:15360
  v_mov_b64 v[48:49], 0
  v_mov_b64 v[50:51], 0
  s_waitcnt lgkmcnt(4)
  v_smfmac_f32_16x16x64_bf16 v[32:35], v[10:13], v[120:127], v0
  s_waitcnt lgkmcnt(3)
  v_smfmac_f32_16x16x64_bf16 v[32:35], v[14:17], v[128:135], v0
  s_waitcnt lgkmcnt(2)
  v_smfmac_f32_16x16x64_bf16 v[32:35], v[18:21], v[136:143], v0
  v_smfmac_f32_16x16x64_bf16 v[40:43], v[10:13], v[152:159], v0
  v_smfmac_f32_16x16x64_bf16 v[40:43], v[14:17], v[160:167], v0
  v_cvt_pk_bf16_f32 v32, v32, v34
  v_smfmac_f32_16x16x64_bf16 v[40:43], v[18:21], v[168:175], v0
  s_waitcnt lgkmcnt(1)
  v_cvt_pk_bf16_f32 v33, v33, v35
  v_smfmac_f32_16x16x64_bf16 v[48:51], v[22:25], v[240:247], v0
  s_waitcnt lgkmcnt(0)
  v_and_or_b32 v32, v32, -2, s30
  v_smfmac_f32_16x16x64_bf16 v[48:51], v[36:39], v[248:255], v0
  v_cvt_pk_bf16_f32 v34, v40, v42
  v_cvt_pk_bf16_f32 v35, v41, v43
  buffer_store_dwordx4 v[32:35], v6, s[8:11], s39 offen sc1
  v_smfmac_f32_16x16x64_bf16 v[64:67], v[10:13], v[184:191], v0
  v_smfmac_f32_16x16x64_bf16 v[64:67], v[14:17], v[192:199], v0
  v_add_f32 v48, v48, v50
  v_add_f32 v49, v49, v51
  v_cvt_pk_bf16_f32 v48, v48, v49
  v_and_or_b32 v48, v48, -2, s30
  buffer_store_dword v48, v7, s[8:11], s39 offen sc1
  v_smfmac_f32_16x16x64_bf16 v[64:67], v[18:21], v[200:207], v0
  v_and_b32 v26, 0xf0, v1
  v_smfmac_f32_16x16x64_bf16 v[44:47], v[10:13], v[216:223], v0
  v_add_u32 v26, s49, v26
  v_smfmac_f32_16x16x64_bf16 v[44:47], v[14:17], v[224:231], v0
  v_cvt_pk_bf16_f32 v64, v64, v66
  v_smfmac_f32_16x16x64_bf16 v[44:47], v[18:21], v[232:239], v0
  v_cvt_pk_bf16_f32 v65, v65, v67
  v_and_or_b32 v64, v64, -2, s30
  s_nop 3
  v_cvt_pk_bf16_f32 v66, v44, v46
  v_cvt_pk_bf16_f32 v67, v45, v47
  buffer_store_dwordx4 v[64:67], v6, s[8:11], s41 offen sc1
  ds_read_b128 v[22:25], v26 offset:13824
  s_cmp_ge_u32 s50, 4
  s_cbranch_scc1 L_note_s
  s_nop 15
  s_nop 15
  s_nop 7
  s_cmp_eq_u32 s50, 1
  s_cbranch_scc1 L_pE1_s
  s_cmp_eq_u32 s50, 0
  s_cbranch_scc1 L_pE0_s
  s_cmp_eq_u32 s50, 2
  s_cbranch_scc1 L_pB0_s
  s_branch L_pB1_s
L_pE0_s:
  buffer_load_dwordx4 v[28:31], v1, s[8:11], s38 offen offset:0 sc1
  buffer_load_dwordx4 v[32:35], v1, s[8:11], s38 offen offset:1024 sc1
  buffer_load_dwordx4 v[36:39], v1, s[8:11], s38 offen offset:2048 sc1
  buffer_load_dwordx4 v[40:43], v1, s[8:11], s38 offen offset:3072 sc1
  s_waitcnt lgkmcnt(0)
  s_waitcnt vmcnt(3)
  v_or3_b32 v26, v28, v28, v28
  v_mfma_f32_16x16x32_bf16 v[18:21], v[22:25], v[28:31], 0
  s_waitcnt vmcnt(2)
  v_or3_b32 v26, v26, v32, v32
  v_mfma_f32_16x16x32_bf16 v[18:21], v[22:25], v[32:35], v[18:21]
  s_waitcnt vmcnt(1)
  v_or3_b32 v26, v26, v36, v36
  v_mfma_f32_16x16x32_bf16 v[18:21], v[22:25], v[36:39], v[18:21]
  s_waitcnt vmcnt(0)
  v_or3_b32 v26, v26, v40, v40
  v_mfma_f32_16x16x32_bf16 v[18:21], v[22:25], v[40:43], v[18:21]
  v_and_b32 v26, 1, v26
  v_cmp_ne_u32 vcc, 0, v26
  s_cbranch_vccnz L_pE0_sf
  s_nop 3
  v_add_f32_dpp v18, v18, v18 row_ror:8 row_mask:0xf bank_mask:0xf
  v_add_f32_dpp v19, v19, v19 row_ror:8 row_mask:0xf bank_mask:0xf
  v_cvt_pk_bf16_f32 v18, v18, v19
  v_and_or_b32 v18, v18, -2, s30
  buffer_store_dword v18, v8, s[8:11], s43 offen sc1
  s_branch L_redd_s
L_pE0_sf:
  s_mov_b64 exec, vcc
  buffer_load_dwordx4 v[28:31], v1, s[8:11], s38 offen offset:0 sc1
  buffer_load_dwordx4 v[32:35], v1, s[8:11], s38 offen offset:1024 sc1
  buffer_load_dwordx4 v[36:39], v1, s[8:11], s38 offen offset:2048 sc1
  buffer_load_dwordx4 v[40:43], v1, s[8:11], s38 offen offset:3072 sc1
  s_mov_b64 exec, -1
  s_nop 9
L_pE0_sr:
  s_mov_b64 exec, vcc
  buffer_load_dwordx4 v[28:31], v1, s[8:11], s38 offen offset:0 sc1
  buffer_load_dwordx4 v[32:35], v1, s[8:11], s38 offen offset:1024 sc1
  buffer_load_dwordx4 v[36:39], v1, s[8:11], s38 offen offset:2048 sc1
  buffer_load_dwordx4 v[40:43], v1, s[8:11], s38 offen offset:3072 sc1
  s_mov_b64 exec, -1
  s_add_u32 s27, s27, 1
  s_cmp_gt_u32 s27, 0x40000
  s_cbranch_scc1 L_abort
  s_waitcnt vmcnt(7)
  v_or3_b32 v26, v28, v28, v28
  v_mfma_f32_16x16x32_bf16 v[18:21], v[22:25], v[28:31], 0
  s_waitcnt vmcnt(6)
  v_or3_b32 v26, v26, v32, v32
  v_mfma_f32_16x16x32_bf16 v[18:21], v[22:25], v[32:35], v[18:21]
  s_waitcnt vmcnt(5)
  v_or3_b32 v26, v26, v36, v36
  v_mfma_f32_16x16x32_bf16 v[18:21], v[22:25], v[36:39], v[18:21]
  s_waitcnt vmcnt(4)
  v_or3_b32 v26, v26, v40, v40
  v_mfma_f32_16x16x32_bf16 v[18:21], v[22:25], v[40:43], v[18:21]
  v_and_b32 v26, 1, v26
  v_cmp_ne_u32 vcc, 0, v26
  s_cbranch_vccnz L_pE0_sr
  s_nop 3
  v_add_f32_dpp v18, v18, v18 row_ror:8 row_mask:0xf bank_mask:0xf
  v_add_f32_dpp v19, v19, v19 row_ror:8 row_mask:0xf bank_mask:0xf
  v_cvt_pk_bf16_f32 v18, v18, v19
  v_and_or_b32 v18, v18, -2, s30
  buffer_store_dword v18, v8, s[8:11], s43 offen sc1
  s_branch L_redd_s
L_pE1_s:
  buffer_load_dwordx4 v[28:31], v1, s[8:11], s38 offen offset:0 sc1
  buffer_load_dwordx4 v[32:35], v1, s[8:11], s38 offen offset:1024 sc1
  buffer_load_dwordx4 v[36:39], v1, s[8:11], s38 offen offset:2048 sc1
  buffer_load_dwordx4 v[40:43], v1, s[8:11], s38 offen offset:3072 sc1
  s_waitcnt lgkmcnt(0)
  s_waitcnt vmcnt(3)
  v_bitop3_b32 v26, v28, v28, v28 bitop3:0x80
  v_mfma_f32_16x16x32_bf16 v[18:21], v[22:25], v[28:31], 0
  s_waitcnt vmcnt(2)
  v_bitop3_b32 v26, v26, v32, v32 bitop3:0x80
  v_mfma_f32_16x16x32_bf16 v[18:21], v[22:25], v[32:35], v[18:21]
  s_waitcnt vmcnt(1)
  v_bitop3_b32 v26, v26, v36, v36 bitop3:0x80
  v_mfma_f32_16x16x32_bf16 v[18:21], v[22:25], v[36:39], v[18:21]
  s_waitcnt vmcnt(0)
  v_bitop3_b32 v26, v26, v40, v40 bitop3:0x80
  v_mfma_f32_16x16x32_bf16 v[18:21], v[22:25], v[40:43], v[18:21]
  v_and_b32 v26, 1, v26
  v_cmp_ne_u32 vcc, 1, v26
  s_cbranch_vccnz L_pE1_sf
  s_nop 3
  v_add_f32_dpp v18, v18, v18 row_ror:8 row_mask:0xf bank_mask:0xf
  v_add_f32_dpp v19, v19, v19 row_ror:8 row_mask:0xf bank_mask:0xf
  v_cvt_pk_bf16_f32 v18, v18, v19
  v_and_or_b32 v18, v18, -2, s30
  buffer_store_dword v18, v8, s[8:11], s43 offen sc1
  s_branch L_redd_s
L_pE1_sf:
  s_mov_b64 exec, vcc
  buffer_load_dwordx4 v[28:31], v1, s[8:11], s38 offen offset:0 sc1
  buffer_load_dwordx4 v[32:35], v1, s[8:11], s38 offen offset:1024 sc1
  buffer_load_dwordx4 v[36:39], v1, s[8:11], s38 offen offset:2048 sc1
  buffer_load_dwordx4 v[40:43], v1, s[8:11], s38 offen offset:3072 sc1
  s_mov_b64 exec, -1
  s_nop 9
L_pE1_sr:
  s_mov_b64 exec, vcc
  buffer_load_dwordx4 v[28:31], v1, s[8:11], s38 offen offset:0 sc1
  buffer_load_dwordx4 v[32:35], v1, s[8:11], s38 offen offset:1024 sc1
  buffer_load_dwordx4 v[36:39], v1, s[8:11], s38 offen offset:2048 sc1
  buffer_load_dwordx4 v[40:43], v1, s[8:11], s38 offen offset:3072 sc1
  s_mov_b64 exec, -1
  s_add_u32 s27, s27, 1
  s_cmp_gt_u32 s27, 0x40000
  s_cbranch_scc1 L_abort
  s_waitcnt vmcnt(7)
  v_bitop3_b32 v26, v28, v28, v28 bitop3:0x80
  v_mfma_f32_16x16x32_bf16 v[18:21], v[22:25], v[28:31], 0
  s_waitcnt vmcnt(6)
  v_bitop3_b32 v26, v26, v32, v32 bitop3:0x80
  v_mfma_f32_16x16x32_bf16 v[18:21], v[22:25], v[32:35], v[18:21]
  s_waitcnt vmcnt(5)
  v_bitop3_b32 v26, v26, v36, v36 bitop3:0x80
  v_mfma_f32_16x16x32_bf16 v[18:21], v[22:25], v[36:39], v[18:21]
  s_waitcnt vmcnt(4)
  v_bitop3_b32 v26, v26, v40, v40 bitop3:0x80
  v_mfma_f32_16x16x32_bf16 v[18:21], v[22:25], v[40:43], v[18:21]
  v_and_b32 v26, 1, v26
  v_cmp_ne_u32 vcc, 1, v26
  s_cbranch_vccnz L_pE1_sr
  s_nop 3
  v_add_f32_dpp v18, v18, v18 row_ror:8 row_mask:0xf bank_mask:0xf
  v_add_f32_dpp v19, v19, v19 row_ror:8 row_mask:0xf bank_mask:0xf
  v_cvt_pk_bf16_f32 v18, v18, v19
  v_and_or_b32 v18, v18, -2, s30
  buffer_store_dword v18, v8, s[8:11], s43 offen sc1
  s_branch L_redd_s
L_pB0_s:
  buffer_load_dwordx4 v[28:31], v1, s[8:11], s38 offen offset:0 sc1
  buffer_load_dwordx4 v[32:35], v1, s[8:11], s38 offen offset:1024 sc1
  buffer_load_dwordx4 v[36:39], v1, s[8:11], s38 offen offset:2048 sc1
  buffer_load_dwordx4 v[40:43], v1, s[8:11], s38 offen offset:3072 sc1
  s_waitcnt lgkmcnt(0)
  s_waitcnt vmcnt(3)
  v_or3_b32 v26, v28, v28, v29
  v_or3_b32 v26, v26, v30, v31
  v_mfma_f32_16x16x32_bf16 v[18:21], v[22:25], v[28:31], 0
  s_waitcnt vmcnt(2)
  v_or3_b32 v26, v26, v32, v33
  v_or3_b32 v26, v26, v34, v35
  v_mfma_f32_16x16x32_bf16 v[18:21], v[22:25], v[32:35], v[18:21]
  s_waitcnt vmcnt(1)
  v_or3_b32 v26, v26, v36, v37
  v_or3_b32 v26, v26, v38, v39
  v_mfma_f32_16x16x32_bf16 v[18:21], v[22:25], v[36:39], v[18:21]
  s_waitcnt vmcnt(0)
  v_or3_b32 v26, v26, v40, v41
  v_or3_b32 v26, v26, v42, v43
  v_mfma_f32_16x16x32_bf16 v[18:21], v[22:25], v[40:43], v[18:21]
  v_and_b32 v26, 1, v26
  v_cmp_ne_u32 vcc, 0, v26
  s_cbranch_vccnz L_pB0_sf
  s_nop 3
  v_add_f32_dpp v18, v18, v18 row_ror:8 row_mask:0xf bank_mask:0xf
  v_add_f32_dpp v19, v19, v19 row_ror:8 row_mask:0xf bank_mask:0xf
  v_cvt_pk_bf16_f32 v18, v18, v19
  v_and_or_b32 v18, v18, -2, s30
  buffer_store_dword v18, v8, s[8:11], s43 offen sc1
  s_branch L_redd_s
L_pB0_sf:
  s_mov_b64 exec, vcc
  buffer_load_dwordx4 v[28:31], v1, s[8:11], s38 offen offset:0 sc1
  buffer_load_dwordx4 v[32:35], v1, s[8:11], s38 offen offset:1024 sc1
  buffer_load_dwordx4 v[36:39], v1, s[8:11], s38 offen offset:2048 sc1
  buffer_load_dwordx4 v[40:43], v1, s[8:11], s38 offen offset:3072 sc1
  s_mov_b64 exec, -1
  s_nop 9
L_pB0_sr:
  s_mov_b64 exec, vcc
  buffer_load_dwordx4 v[28:31], v1, s[8:11], s38 offen offset:0 sc1
  buffer_load_dwordx4 v[32:35], v1, s[8:11], s38 offen offset:1024 sc1
  buffer_load_dwordx4 v[36:39], v1, s[8:11], s38 offen offset:2048 sc1
  buffer_load_dwordx4 v[40:43], v1, s[8:11], s38 offen offset:3072 sc1
  s_mov_b64 exec, -1
  s_add_u32 s27, s27, 1
  s_cmp_gt_u32 s27, 0x40000
  s_cbranch_scc1 L_abort
  s_waitcnt vmcnt(7)
  v_or3_b32 v26, v28, v28, v29
  v_or3_b32 v26, v26, v30, v31
  v_mfma_f32_16x16x32_bf16 v[18:21], v[22:25], v[28:31], 0
  s_waitcnt vmcnt(6)
  v_or3_b32 v26, v26, v32, v33
  v_or3_b32 v26, v26, v34, v35
  v_mfma_f32_16x16x32_bf16 v[18:21], v[22:25], v[32:35], v[18:21]
  s_waitcnt vmcnt(5)
  v_or3_b32 v26, v26, v36, v37
  v_or3_b32 v26, v26, v38, v39
  v_mfma_f32_16x16x32_bf16 v[18:21], v[22:25], v[36:39], v[18:21]
  s_waitcnt vmcnt(4)
  v_or3_b32 v26, v26, v40, v41
  v_or3_b32 v26, v26, v42, v43
  v_mfma_f32_16x16x32_bf16 v[18:21], v[22:25], v[40:43], v[18:21]
  v_and_b32 v26, 1, v26
  v_cmp_ne_u32 vcc, 0, v26
  s_cbranch_vccnz L_pB0_sr
  s_nop 3
  v_add_f32_dpp v18, v18, v18 row_ror:8 row_mask:0xf bank_mask:0xf
  v_add_f32_dpp v19, v19, v19 row_ror:8 row_mask:0xf bank_mask:0xf
  v_cvt_pk_bf16_f32 v18, v18, v19
  v_and_or_b32 v18, v18, -2, s30
  buffer_store_dword v18, v8, s[8:11], s43 offen sc1
  s_branch L_redd_s
L_pB1_s:
  buffer_load_dwordx4 v[28:31], v1, s[8:11], s38 offen offset:0 sc1
  buffer_load_dwordx4 v[32:35], v1, s[8:11], s38 offen offset:1024 sc1
  buffer_load_dwordx4 v[36:39], v1, s[8:11], s38 offen offset:2048 sc1
  buffer_load_dwordx4 v[40:43], v1, s[8:11], s38 offen offset:3072 sc1
  s_waitcnt lgkmcnt(0)
  s_waitcnt vmcnt(3)
  v_bitop3_b32 v26, v28, v28, v29 bitop3:0x80
  v_bitop3_b32 v26, v26, v30, v31 bitop3:0x80
  v_mfma_f32_16x16x32_bf16 v[18:21], v[22:25], v[28:31], 0
  s_waitcnt vmcnt(2)
  v_bitop3_b32 v26, v26, v32, v33 bitop3:0x80
  v_bitop3_b32 v26, v26, v34, v35 bitop3:0x80
  v_mfma_f32_16x16x32_bf16 v[18:21], v[22:25], v[32:35], v[18:21]
  s_waitcnt vmcnt(1)
  v_bitop3_b32 v26, v26, v36, v37 bitop3:0x80
  v_bitop3_b32 v26, v26, v38, v39 bitop3:0x80
  v_mfma_f32_16x16x32_bf16 v[18:21], v[22:25], v[36:39], v[18:21]
  s_waitcnt vmcnt(0)
  v_bitop3_b32 v26, v26, v40, v41 bitop3:0x80
  v_bitop3_b32 v26, v26, v42, v43 bitop3:0x80
  v_mfma_f32_16x16x32_bf16 v[18:21], v[22:25], v[40:43], v[18:21]
  v_and_b32 v26, 1, v26
  v_cmp_ne_u32 vcc, 1, v26
  s_cbranch_vccnz L_pB1_sf
  s_nop 3
  v_add_f32_dpp v18, v18, v18 row_ror:8 row_mask:0xf bank_mask:0xf
  v_add_f32_dpp v19, v19, v19 row_ror:8 row_mask:0xf bank_mask:0xf
  v_cvt_pk_bf16_f32 v18, v18, v19
  v_and_or_b32 v18, v18, -2, s30
  buffer_store_dword v18, v8, s[8:11], s43 offen sc1
  s_branch L_redd_s
L_pB1_sf:
  s_mov_b64 exec, vcc
  buffer_load_dwordx4 v[28:31], v1, s[8:11], s38 offen offset:0 sc1
  buffer_load_dwordx4 v[32:35], v1, s[8:11], s38 offen offset:1024 sc1
  buffer_load_dwordx4 v[36:39], v1, s[8:11], s38 offen offset:2048 sc1
  buffer_load_dwordx4 v[40:43], v1, s[8:11], s38 offen offset:3072 sc1
  s_mov_b64 exec, -1
  s_nop 9
L_pB1_sr:
  s_mov_b64 exec, vcc
  buffer_load_dwordx4 v[28:31], v1, s[8:11], s38 offen offset:0 sc1
  buffer_load_dwordx4 v[32:35], v1, s[8:11], s38 offen offset:1024 sc1
  buffer_load_dwordx4 v[36:39], v1, s[8:11], s38 offen offset:2048 sc1
  buffer_load_dwordx4 v[40:43], v1, s[8:11], s38 offen offset:3072 sc1
  s_mov_b64 exec, -1
  s_add_u32 s27, s27, 1
  s_cmp_gt_u32 s27, 0x40000
  s_cbranch_scc1 L_abort
  s_waitcnt vmcnt(7)
  v_bitop3_b32 v26, v28, v28, v29 bitop3:0x80
  v_bitop3_b32 v26, v26, v30, v31 bitop3:0x80
  v_mfma_f32_16x16x32_bf16 v[18:21], v[22:25], v[28:31], 0
  s_waitcnt vmcnt(6)
  v_bitop3_b32 v26, v26, v32, v33 bitop3:0x80
  v_bitop3_b32 v26, v26, v34, v35 bitop3:0x80
  v_mfma_f32_16x16x32_bf16 v[18:21], v[22:25], v[32:35], v[18:21]
  s_waitcnt vmcnt(5)
  v_bitop3_b32 v26, v26, v36, v37 bitop3:0x80
  v_bitop3_b32 v26, v26, v38, v39 bitop3:0x80
  v_mfma_f32_16x16x32_bf16 v[18:21], v[22:25], v[36:39], v[18:21]
  s_waitcnt vmcnt(4)
  v_bitop3_b32 v26, v26, v40, v41 bitop3:0x80
  v_bitop3_b32 v26, v26, v42, v43 bitop3:0x80
  v_mfma_f32_16x16x32_bf16 v[18:21], v[22:25], v[40:43], v[18:21]
  v_and_b32 v26, 1, v26
  v_cmp_ne_u32 vcc, 1, v26
  s_cbranch_vccnz L_pB1_sr
  s_nop 3
  v_add_f32_dpp v18, v18, v18 row_ror:8 row_mask:0xf bank_mask:0xf
  v_add_f32_dpp v19, v19, v19 row_ror:8 row_mask:0xf bank_mask:0xf
  v_cvt_pk_bf16_f32 v18, v18, v19
  v_and_or_b32 v18, v18, -2, s30
  buffer_store_dword v18, v8, s[8:11], s43 offen sc1
  s_branch L_redd_s
L_note_s:
  s_cmp_ge_u32 s50, 6
  s_cbranch_scc1 L_nored_s
  v_mov_b64 v[28:29], 0
  v_mov_b64 v[30:31], 0
  v_mov_b64 v[32:33], 0
  v_mov_b64 v[34:35], 0
  v_mov_b64 v[36:37], 0
  v_mov_b64 v[38:39], 0
  v_mov_b64 v[40:41], 0
  v_mov_b64 v[42:43], 0
  v_mov_b64 v[44:45], 0
  v_mov_b64 v[46:47], 0
  s_nop 15
  s_nop 15
  s_nop 15
  s_nop 15
  s_nop 15
  s_cmp_eq_u32 s50, 5
  s_cbranch_scc1 L_pL1_s
L_pL0_s:
  buffer_load_dwordx4 v[10:13], v1, s[8:11], s38 offen offset:0 sc1
  buffer_load_dwordx4 v[14:17], v1, s[8:11], s38 offen offset:1024 sc1
  buffer_load_dwordx4 v[48:51], v1, s[8:11], s38 offen offset:2048 sc1
  buffer_load_dwordx4 v[64:67], v1, s[8:11], s38 offen offset:3072 sc1
  s_waitcnt lgkmcnt(0)
  s_waitcnt vmcnt(3)
  v_or3_b32 v26, v10, v10, v10
  v_mfma_f32_16x16x32_bf16 v[18:21], v[22:25], v[10:13], 0
  s_waitcnt vmcnt(2)
  v_or3_b32 v26, v26, v14, v14
  v_mfma_f32_16x16x32_bf16 v[18:21], v[22:25], v[14:17], v[18:21]
  s_waitcnt vmcnt(1)
  v_or3_b32 v26, v26, v48, v48
  v_mfma_f32_16x16x32_bf16 v[18:21], v[22:25], v[48:51], v[18:21]
  s_waitcnt vmcnt(0)
  v_or3_b32 v26, v26, v64, v64
  v_mfma_f32_16x16x32_bf16 v[18:21], v[22:25], v[64:67], v[18:21]
  v_and_b32 v26, 1, v26
  v_cmp_ne_u32 vcc, 0, v26
  s_cbranch_vccnz L_pL0_sf
  s_nop 3
  v_add_f32_dpp v18, v18, v18 row_ror:8 row_mask:0xf bank_mask:0xf
  v_add_f32_dpp v19, v19, v19 row_ror:8 row_mask:0xf bank_mask:0xf
  v_cvt_pk_bf16_f32 v18, v18, v19
  v_and_or_b32 v18, v18, -2, s30
  buffer_store_dword v18, v8, s[8:11], s43 offen sc1
  s_branch L_d2l_s
L_pL0_sf:
  s_mov_b64 exec, vcc
  buffer_load_dwordx4 v[10:13], v1, s[8:11], s38 offen offset:0 sc1
  buffer_load_dwordx4 v[14:17], v1, s[8:11], s38 offen offset:1024 sc1
  buffer_load_dwordx4 v[48:51], v1, s[8:11], s38 offen offset:2048 sc1
  buffer_load_dwordx4 v[64:67], v1, s[8:11], s38 offen offset:3072 sc1
  s_mov_b64 exec, -1
  s_nop 9
L_pL0_sr:
  s_mov_b64 exec, vcc
  buffer_load_dwordx4 v[10:13], v1, s[8:11], s38 offen offset:0 sc1
  buffer_load_dwordx4 v[14:17], v1, s[8:11], s38 offen offset:1024 sc1
  buffer_load_dwordx4 v[48:51], v1, s[8:11], s38 offen offset:2048 sc1
  buffer_load_dwordx4 v[64:67], v1, s[8:11], s38 offen offset:3072 sc1
  s_mov_b64 exec, -1
  s_add_u32 s27, s27, 1
  s_cmp_gt_u32 s27, 0x40000
  s_cbranch_scc1 L_abort
  s_waitcnt vmcnt(7)
  v_or3_b32 v26, v10, v10, v10
  v_mfma_f32_16x16x32_bf16 v[18:21], v[22:25], v[10:13], 0
  s_waitcnt vmcnt(6)
  v_or3_b32 v26, v26, v14, v14
  v_mfma_f32_16x16x32_bf16 v[18:21], v[22:25], v[14:17], v[18:21]
  s_waitcnt vmcnt(5)
  v_or3_b32 v26, v26, v48, v48
  v_mfma_f32_16x16x32_bf16 v[18:21], v[22:25], v[48:51], v[18:21]
  s_waitcnt vmcnt(4)
  v_or3_b32 v26, v26, v64, v64
  v_mfma_f32_16x16x32_bf16 v[18:21], v[22:25], v[64:67], v[18:21]
  v_and_b32 v26, 1, v26
  v_cmp_ne_u32 vcc, 0, v26
  s_cbranch_vccnz L_pL0_sr
  s_nop 3
  v_add_f32_dpp v18, v18, v18 row_ror:8 row_mask:0xf bank_mask:0xf
  v_add_f32_dpp v19, v19, v19 row_ror:8 row_mask:0xf bank_mask:0xf
  v_cvt_pk_bf16_f32 v18, v18, v19
  v_and_or_b32 v18, v18, -2, s30
  buffer_store_dword v18, v8, s[8:11], s43 offen sc1
  s_branch L_d2l_s
L_pL1_s:
  buffer_load_dwordx4 v[10:13], v1, s[8:11], s38 offen offset:0 sc1
  buffer_load_dwordx4 v[14:17], v1, s[8:11], s38 offen offset:1024 sc1
  buffer_load_dwordx4 v[48:51], v1, s[8:11], s38 offen offset:2048 sc1
  buffer_load_dwordx4 v[64:67], v1, s[8:11], s38 offen offset:3072 sc1
  s_waitcnt lgkmcnt(0)
  s_waitcnt vmcnt(3)
  v_bitop3_b32 v26, v10, v10, v10 bitop3:0x80
  v_mfma_f32_16x16x32_bf16 v[18:21], v[22:25], v[10:13], 0
  s_waitcnt vmcnt(2)
  v_bitop3_b32 v26, v26, v14, v14 bitop3:0x80
  v_mfma_f32_16x16x32_bf16 v[18:21], v[22:25], v[14:17], v[18:21]
  s_waitcnt vmcnt(1)
  v_bitop3_b32 v26, v26, v48, v48 bitop3:0x80
  v_mfma_f32_16x16x32_bf16 v[18:21], v[22:25], v[48:51], v[18:21]
  s_waitcnt vmcnt(0)
  v_bitop3_b32 v26, v26, v64, v64 bitop3:0x80
  v_mfma_f32_16x16x32_bf16 v[18:21], v[22:25], v[64:67], v[18:21]
  v_and_b32 v26, 1, v26
  v_cmp_ne_u32 vcc, 1, v26
  s_cbranch_vccnz L_pL1_sf
  s_nop 3
  v_add_f32_dpp v18, v18, v18 row_ror:8 row_mask:0xf bank_mask:0xf
  v_add_f32_dpp v19, v19, v19 row_ror:8 row_mask:0xf bank_mask:0xf
  v_cvt_pk_bf16_f32 v18, v18, v19
  v_and_or_b32 v18, v18, -2, s30
  buffer_store_dword v18, v8, s[8:11], s43 offen sc1
  s_branch L_d2l_s
L_pL1_sf:
  s_mov_b64 exec, vcc
  buffer_load_dwordx4 v[10:13], v1, s[8:11], s38 offen offset:0 sc1
  buffer_load_dwordx4 v[14:17], v1, s[8:11], s38 offen offset:1024 sc1
  buffer_load_dwordx4 v[48:51], v1, s[8:11], s38 offen offset:2048 sc1
  buffer_load_dwordx4 v[64:67], v1, s[8:11], s38 offen offset:3072 sc1
  s_mov_b64 exec, -1
  s_nop 9
L_pL1_sr:
  s_mov_b64 exec, vcc
  buffer_load_dwordx4 v[10:13], v1, s[8:11], s38 offen offset:0 sc1
  buffer_load_dwordx4 v[14:17], v1, s[8:11], s38 offen offset:1024 sc1
  buffer_load_dwordx4 v[48:51], v1, s[8:11], s38 offen offset:2048 sc1
  buffer_load_dwordx4 v[64:67], v1, s[8:11], s38 offen offset:3072 sc1
  s_mov_b64 exec, -1
  s_add_u32 s27, s27, 1
  s_cmp_gt_u32 s27, 0x40000
  s_cbranch_scc1 L_abort
  s_waitcnt vmcnt(7)
  v_bitop3_b32 v26, v10, v10, v10 bitop3:0x80
  v_mfma_f32_16x16x32_bf16 v[18:21], v[22:25], v[10:13], 0
  s_waitcnt vmcnt(6)
  v_bitop3_b32 v26, v26, v14, v14 bitop3:0x80
  v_mfma_f32_16x16x32_bf16 v[18:21], v[22:25], v[14:17], v[18:21]
  s_waitcnt vmcnt(5)
  v_bitop3_b32 v26, v26, v48, v48 bitop3:0x80
  v_mfma_f32_16x16x32_bf16 v[18:21], v[22:25], v[48:51], v[18:21]
  s_waitcnt vmcnt(4)
  v_bitop3_b32 v26, v26, v64, v64 bitop3:0x80
  v_mfma_f32_16x16x32_bf16 v[18:21], v[22:25], v[64:67], v[18:21]
  v_and_b32 v26, 1, v26
  v_cmp_ne_u32 vcc, 1, v26
  s_cbranch_vccnz L_pL1_sr
  s_nop 3
  v_add_f32_dpp v18, v18, v18 row_ror:8 row_mask:0xf bank_mask:0xf
  v_add_f32_dpp v19, v19, v19 row_ror:8 row_mask:0xf bank_mask:0xf
  v_cvt_pk_bf16_f32 v18, v18, v19
  v_and_or_b32 v18, v18, -2, s30
  buffer_store_dword v18, v8, s[8:11], s43 offen sc1
  s_branch L_d2l_s
L_late_retry_s:
  s_mov_b32 s27, 0
L_late_loop_s:
  buffer_load_dwordx4 v[22:25], v1, s[8:11], s43 offen offset:1024 sc1
  s_add_u32 s27, s27, 1
  s_cmp_gt_u32 s27, 0x40000
  s_cbranch_scc1 L_abort
  s_waitcnt vmcnt(0)
  v_bitop3_b32 v27, v22, v23, s30 bitop3:0x7e
  v_bitop3_b32 v27, v27, v24, s30 bitop3:0xf6
  v_bitop3_b32 v27, v27, v25, s30 bitop3:0xf6
  v_and_b32 v27, 1, v27
  v_cmp_ne_u32 vcc, 0, v27
  s_cbranch_vccnz L_late_loop_s
  ds_write_b128 v1, v[22:25] offset:1024
  s_waitcnt lgkmcnt(0)
  s_branch L_late_ok_s
L_nored_s:
  s_cmp_lt_u32 s22, s3
  s_cbranch_scc1 L_kvok_s
  s_mov_b32 s27, 0
  v_and_b32 v27, 28, v2
L_kvw_s:
  buffer_load_dword v26, v27, s[16:19], 0 offen offset:64 sc1
  s_add_u32 s27, s27, 1
  s_cmp_gt_u32 s27, 0x40000
  s_cbranch_scc1 L_abort
  s_waitcnt vmcnt(0)
  v_cmp_gt_u32 vcc, 28, v26
  s_nop 1
  s_ff1_i32_b32 s3, vcc_lo
  s_and_b32 s3, s3, 15
  s_lshl_b32 s3, s3, 3
  s_sub_u32 s3, s3, 3
  s_cmp_ge_u32 s22, s3
  s_cbranch_scc1 L_kvw_s
  s_waitcnt vmcnt(3)
  ds_write_b128 v1, v[52:55] offset:16384
  ds_write_b128 v1, v[56:59] offset:17408
  v_mov_b64 v[10:11], v[68:69]
  v_mov_b64 v[12:13], v[70:71]
  v_mov_b64 v[14:15], v[60:61]
  v_mov_b64 v[16:17], v[62:63]
  v_mov_b64 v[28:29], 0
  v_mov_b64 v[30:31], 0
  v_mov_b64 v[32:33], 0
  v_mov_b64 v[34:35], 0
  v_mov_b64 v[36:37], 0
  v_mov_b64 v[38:39], 0
  v_mov_b64 v[40:41], 0
  v_mov_b64 v[42:43], 0
  v_mov_b64 v[44:45], 0
  v_mov_b64 v[46:47], 0
  v_mov_b64 v[48:49], 0
  v_mov_b64 v[50:51], 0
  s_branch L_post_s
L_kvok_s:
  s_waitcnt vmcnt(3)
  ds_write_b128 v1, v[52:55] offset:16384
  ds_write_b128 v1, v[56:59] offset:17408
  v_mov_b64 v[10:11], v[68:69]
  v_mov_b64 v[12:13], v[70:71]
  v_mov_b64 v[14:15], v[60:61]
  v_mov_b64 v[16:17], v[62:63]
  v_mov_b64 v[28:29], 0
  v_mov_b64 v[30:31], 0
  v_mov_b64 v[32:33], 0
  v_mov_b64 v[34:35], 0
  v_mov_b64 v[36:37], 0
  v_mov_b64 v[38:39], 0
  v_mov_b64 v[40:41], 0
  v_mov_b64 v[42:43], 0
  v_mov_b64 v[44:45], 0
  v_mov_b64 v[46:47], 0
  v_mov_b64 v[48:49], 0
  v_mov_b64 v[50:51], 0
  s_nop 15
  s_nop 15
  s_nop 15
  s_nop 15
  s_nop 15
  s_nop 15
  s_nop 15
  s_nop 7
  s_branch L_post_s
L_redd_s:
  s_waitcnt vmcnt(1)
  ds_write_b128 v1, v[52:55] offset:16384
  ds_write_b128 v1, v[56:59] offset:17408
  v_mov_b64 v[10:11], v[68:69]
  v_mov_b64 v[12:13], v[70:71]
  v_mov_b64 v[14:15], v[60:61]
  v_mov_b64 v[16:17], v[62:63]
  v_mov_b64 v[28:29], 0
  v_mov_b64 v[30:31], 0
  v_mov_b64 v[32:33], 0
  v_mov_b64 v[34:35], 0
  v_mov_b64 v[36:37], 0
  v_mov_b64 v[38:39], 0
  v_mov_b64 v[40:41], 0
  v_mov_b64 v[42:43], 0
  v_mov_b64 v[44:45], 0
  v_mov_b64 v[46:47], 0
  v_mov_b64 v[48:49], 0
  v_mov_b64 v[50:51], 0
  s_branch L_post_s
L_d2l_s:
  buffer_load_dwordx4 v[18:21], v1, s[8:11], s43 offen sc1
  buffer_load_dword v26, v2, s[8:11], s44 offen sc1
  s_waitcnt vmcnt(3)
  ds_write_b128 v1, v[52:55] offset:16384
  ds_write_b128 v1, v[56:59] offset:17408
  v_mov_b64 v[10:11], v[68:69]
  v_mov_b64 v[12:13], v[70:71]
  v_mov_b64 v[14:15], v[60:61]
  v_mov_b64 v[16:17], v[62:63]
  v_mov_b64 v[48:49], 0
  v_mov_b64 v[50:51], 0
  s_mov_b32 s27, 0
  s_branch L_p2x_s
L_post_s:
  s_branch L_step_s
L_done_s:
  s_waitcnt vmcnt(0)
  s_endpgm
L_abort:
  v_mov_b32 v16, 0xdead
  buffer_store_dword v16, off, s[16:19], 0 offset:40
  s_waitcnt vmcnt(0)
  s_endpgm
L_nonchain:
  s_lshr_b32 s20, s24, 5
  s_sub_u32 s20, s20, 1
  s_and_b32 s21, s24, 31
  v_lshrrev_b32 v18, 6, v0
  v_and_b32 v1, 63, v0
  v_readfirstlane_b32 s22, v18
  s_load_dwordx2 s[42:43], s[0:1], 16
  s_load_dwordx2 s[44:45], s[0:1], 24
  s_load_dwordx2 s[46:47], s[0:1], 32
  s_load_dwordx2 s[48:49], s[0:1], 64
  s_load_dwordx2 s[50:51], s[0:1], 72
  s_load_dwordx2 s[54:55], s[0:1], 0
  s_lshr_b32 s71, s21, 2
  s_and_b32 s24, s21, 3
  s_lshl_b32 s29, s20, 2
  s_add_u32 s24, s24, s29
  s_mov_b32 s41, 0
  s_waitcnt lgkmcnt(0)
  s_cmp_eq_u32 s71, 0
  s_cbranch_scc1 L_runA0
  s_cmp_ge_u32 s71, 6
  s_cbranch_scc1 L_runA
  s_cmp_lt_u32 s71, 2
  s_cbranch_scc1 L_runB
L_runB:
  s_mov_b32 s23, s71
  s_mov_b32 s58, s24
  s_mov_b32 s67, 28
  s_mov_b32 s68, 28
  s_mov_b32 s69, 11
  s_mov_b32 s70, 4
  s_cmp_lt_u32 s71, 5
  s_cbranch_scc1 L_run
  s_add_u32 s58, s24, 196
  s_mov_b32 s70, 9
  s_branch L_run
    L_runA0:
  s_mov_b32 s58, s24
  s_cmp_lt_u32 s24, 12
  s_cselect_b32 s69, 9, 8
  s_mov_b32 s70, 1
  s_branch L_runA1
    L_runA:
  s_sub_u32 s29, s71, 5
  s_mul_i32 s29, s29, 28
  s_add_u32 s58, s24, s29
  s_cmp_lt_u32 s58, 44
  s_cselect_b32 s69, 1, 0
  s_mov_b32 s70, s69
    L_runA1:
  s_mov_b32 s23, 0
  s_mov_b32 s67, 84
  s_mov_b32 s68, 44
    L_run:
  s_lshl_b32 s35, s23, 3
  s_lshl_b32 s29, s22, 1
  s_add_u32 s35, s35, s29
  v_lshrrev_b32 v18, 3, v1
  v_and_b32 v19, 7, v1
  v_bfe_u32 v20, v18, 1, 1
  v_lshlrev_b32 v20, 2, v20
  v_xor_b32 v19, v19, v20
  v_lshlrev_b32 v3, 4, v19
  v_and_b32 v4, 63, v3
  v_cmp_le_u32 s[52:53], 4, v19
  s_lshl_b32 s29, s22, 3
  v_add_u32 v2, s29, v18
  s_waitcnt lgkmcnt(0)
  s_mov_b32 s12, s54
  s_and_b32 s13, s55, 0xffff
  s_mov_b32 s14, 2359296
  s_mov_b32 s15, 0x20000
  s_lshl_b32 s30, s35, 18
  s_add_u32 s61, s30, 50331648
  s_add_u32 s62, s30, 67108864
  s_add_u32 s63, s30, 33554432
  s_mul_i32 s30, s35, 294912
  s_add_u32 s64, s30, 100663296
  s_mov_b32 s65, 9216
  s_mov_b32 s66, 8192
  s_cmp_lt_u32 s71, 3
  s_cbranch_scc1 L_nowpf
  s_cmp_ge_u32 s71, 6
  s_cbranch_scc1 L_nowpf
  s_load_dwordx2 s[76:77], s[0:1], 40
  s_sub_u32 s29, s71, 3
  s_mul_i32 s29, s29, 28
  s_add_u32 s29, s29, s24
  s_lshl_b32 s29, s29, 2
  s_add_u32 s29, s29, s22
  s_mul_i32 s29, s29, 16384
  v_mul_u32_u24 v44, 128, v1
  s_waitcnt lgkmcnt(0)
  s_mov_b32 s80, s76
  s_and_b32 s81, s77, 0xffff
  s_mov_b32 s82, 4718592
  s_mov_b32 s83, 0x20000
  s_mov_b32 s30, s29
  buffer_load_dword v45, v44, s[80:83], s30 offen
  s_add_u32 s30, s30, 8192
  buffer_load_dword v45, v44, s[80:83], s30 offen
  s_add_u32 s30, s30, 8192
  s_mov_b32 s80, s42
  s_and_b32 s81, s43, 0xffff
  s_mov_b32 s82, 4718592
  s_mov_b32 s83, 0x20000
  s_mov_b32 s30, s29
  buffer_load_dword v45, v44, s[80:83], s30 offen
  s_add_u32 s30, s30, 8192
  buffer_load_dword v45, v44, s[80:83], s30 offen
  s_add_u32 s30, s30, 8192
  s_mov_b32 s80, s44
  s_and_b32 s81, s45, 0xffff
  s_mov_b32 s82, 4718592
  s_mov_b32 s83, 0x20000
  s_mov_b32 s30, s29
  buffer_load_dword v45, v44, s[80:83], s30 offen
  s_add_u32 s30, s30, 8192
  buffer_load_dword v45, v44, s[80:83], s30 offen
  s_add_u32 s30, s30, 8192
  s_mov_b32 s80, s46
  s_and_b32 s81, s47, 0xffff
  s_mov_b32 s82, 4718592
  s_mov_b32 s83, 0x20000
  s_mov_b32 s30, s29
  buffer_load_dword v45, v44, s[80:83], s30 offen
  s_add_u32 s30, s30, 8192
  buffer_load_dword v45, v44, s[80:83], s30 offen
  s_add_u32 s30, s30, 8192
L_nowpf:
  s_mov_b32 s60, 0
  s_lshr_b32 s30, s58, 6
  s_cmp_eq_u32 s30, 1
  s_cselect_b32 s28, 1, 0
  s_cselect_b64 s[36:37], s[46:47], s[44:45]
  s_cselect_b32 s31, s62, s61
  s_cselect_b32 s32, 12, 11
  s_cmp_eq_u32 s30, 2
  s_cselect_b64 s[36:37], s[42:43], s[36:37]
  s_cselect_b32 s31, s63, s31
  s_and_b32 s30, s58, 63
  s_lshr_b32 s59, s30, 1
  s_lshl_b32 s59, s59, 13
  s_add_u32 s59, s59, s31
  s_and_b32 s31, s58, 1
  s_lshl_b32 s31, s31, s32
  s_add_u32 s59, s59, s31
  s_lshl_b32 s30, s30, 7
  s_sub_u32 s31, s58, 192
  s_lshl_b32 s32, s31, 11
  s_add_u32 s32, s32, s64
  s_lshl_b32 s31, s31, 6
  s_cmp_ge_u32 s58, 192
  s_cselect_b32 s28, 2, s28
  s_cselect_b32 s59, s32, s59
  s_cselect_b32 s30, s31, s30
  s_cselect_b64 s[38:39], s[50:51], s[36:37]
  s_cselect_b64 s[36:37], s[48:49], s[36:37]
  s_cselect_b32 s31, s65, s66
  s_cselect_b32 s32, 63, 127
  s_lshl_b32 s40, s31, 5
  s_cmp_eq_u32 s28, 1
  s_cselect_b64 s[56:57], -1, 0
  v_mul_u32_u24 v18, s31, v2
  v_and_b32 v19, s32, v3
  v_add3_u32 v18, v18, v19, s30
  v_mov_b32 v19, s36
  v_mov_b32 v20, s38
  v_cndmask_b32 v16, v19, v20, s[52:53]
  v_mov_b32 v19, s37
  v_mov_b32 v20, s39
  v_cndmask_b32 v17, v19, v20, s[52:53]
  v_add_co_u32 v16, vcc, v16, v18
  s_nop 1
  v_addc_co_u32 v17, vcc, 0, v17, vcc
  s_lshl_b32 s29, s22, 10
  s_mov_b32 m0, s29
  s_nop 0
  global_load_lds_dwordx4 v[16:17], off
  s_add_u32 m0, m0, 4096
  v_lshl_add_u64 v[16:17], v[16:17], 0, s[40:41]
  global_load_lds_dwordx4 v[16:17], off
  s_add_u32 m0, m0, 4096
  v_lshl_add_u64 v[16:17], v[16:17], 0, s[40:41]
  global_load_lds_dwordx4 v[16:17], off
  s_add_u32 m0, m0, 4096
  v_lshl_add_u64 v[16:17], v[16:17], 0, s[40:41]
  global_load_lds_dwordx4 v[16:17], off
  s_add_u32 m0, m0, 4096
  v_lshl_add_u64 v[16:17], v[16:17], 0, s[40:41]
  global_load_lds_dwordx4 v[16:17], off
  s_add_u32 m0, m0, 4096
  v_lshl_add_u64 v[16:17], v[16:17], 0, s[40:41]
  global_load_lds_dwordx4 v[16:17], off
  s_add_u32 m0, m0, 4096
  v_lshl_add_u64 v[16:17], v[16:17], 0, s[40:41]
  global_load_lds_dwordx4 v[16:17], off
  s_add_u32 m0, m0, 4096
  v_lshl_add_u64 v[16:17], v[16:17], 0, s[40:41]
  global_load_lds_dwordx4 v[16:17], off
  s_add_u32 m0, m0, 4096
  v_lshl_add_u64 v[16:17], v[16:17], 0, s[40:41]
  global_load_lds_dwordx4 v[16:17], off
  s_add_u32 m0, m0, 4096
  v_lshl_add_u64 v[16:17], v[16:17], 0, s[40:41]
  global_load_lds_dwordx4 v[16:17], off
  s_add_u32 m0, m0, 4096
  v_lshl_add_u64 v[16:17], v[16:17], 0, s[40:41]
  global_load_lds_dwordx4 v[16:17], off
  s_add_u32 m0, m0, 4096
  v_lshl_add_u64 v[16:17], v[16:17], 0, s[40:41]
  global_load_lds_dwordx4 v[16:17], off
  s_add_u32 m0, m0, 4096
  v_lshl_add_u64 v[16:17], v[16:17], 0, s[40:41]
  global_load_lds_dwordx4 v[16:17], off
  s_add_u32 m0, m0, 4096
  v_lshl_add_u64 v[16:17], v[16:17], 0, s[40:41]
  global_load_lds_dwordx4 v[16:17], off
  s_add_u32 m0, m0, 4096
  v_lshl_add_u64 v[16:17], v[16:17], 0, s[40:41]
  global_load_lds_dwordx4 v[16:17], off
  s_add_u32 m0, m0, 4096
  v_lshl_add_u64 v[16:17], v[16:17], 0, s[40:41]
  global_load_lds_dwordx4 v[16:17], off
  s_add_u32 m0, m0, 4096
  v_lshl_add_u64 v[16:17], v[16:17], 0, s[40:41]
  global_load_lds_dwordx4 v[16:17], off
  s_add_u32 m0, m0, 4096
  v_lshl_add_u64 v[16:17], v[16:17], 0, s[40:41]
  global_load_lds_dwordx4 v[16:17], off
  s_add_u32 m0, m0, 4096
  v_lshl_add_u64 v[16:17], v[16:17], 0, s[40:41]
  v_mul_u32_u24 v44, 128, v1
  s_and_b32 s29, s21, 3
  s_lshl_b32 s29, s29, 2
  s_add_u32 s29, s29, s22
  s_mul_i32 s29, s29, 18432
  s_mul_i32 s30, s23, 294912
  s_add_u32 s29, s29, s30
  buffer_load_dword v45, v44, s[12:15], s29 offen
  s_add_u32 s29, s29, 8192
  buffer_load_dword v45, v44, s[12:15], s29 offen
  s_add_u32 s29, s29, 8192
  buffer_load_dword v45, v44, s[12:15], s29 offen
  s_add_u32 s29, s29, 8192
  v_and_b32 v18, 31, v1
  v_lshrrev_b32 v19, 5, v1
  v_add_u32 v24, 0, v1
  v_mul_u32_u24 v25, 3450, v24
  v_lshrrev_b32 v25, 16, v25
  v_mul_u32_u24 v26, 19, v25
  v_sub_u32 v24, v24, v26
  v_min_u32 v24, 17, v24
  v_min_u32 v25, 31, v25
  v_mul_u32_u24 v25, 1152, v25
  v_lshl_add_u32 v32, v24, 4, v25
  v_add_u32 v24, 64, v1
  v_mul_u32_u24 v25, 3450, v24
  v_lshrrev_b32 v25, 16, v25
  v_mul_u32_u24 v26, 19, v25
  v_sub_u32 v24, v24, v26
  v_min_u32 v24, 17, v24
  v_min_u32 v25, 31, v25
  v_mul_u32_u24 v25, 1152, v25
  v_lshl_add_u32 v33, v24, 4, v25
  v_add_u32 v24, 128, v1
  v_mul_u32_u24 v25, 3450, v24
  v_lshrrev_b32 v25, 16, v25
  v_mul_u32_u24 v26, 19, v25
  v_sub_u32 v24, v24, v26
  v_min_u32 v24, 17, v24
  v_min_u32 v25, 31, v25
  v_mul_u32_u24 v25, 1152, v25
  v_lshl_add_u32 v34, v24, 4, v25
  v_add_u32 v24, 192, v1
  v_mul_u32_u24 v25, 3450, v24
  v_lshrrev_b32 v25, 16, v25
  v_mul_u32_u24 v26, 19, v25
  v_sub_u32 v24, v24, v26
  v_min_u32 v24, 17, v24
  v_min_u32 v25, 31, v25
  v_mul_u32_u24 v25, 1152, v25
  v_lshl_add_u32 v35, v24, 4, v25
  v_add_u32 v24, 256, v1
  v_mul_u32_u24 v25, 3450, v24
  v_lshrrev_b32 v25, 16, v25
  v_mul_u32_u24 v26, 19, v25
  v_sub_u32 v24, v24, v26
  v_min_u32 v24, 17, v24
  v_min_u32 v25, 31, v25
  v_mul_u32_u24 v25, 1152, v25
  v_lshl_add_u32 v36, v24, 4, v25
  v_add_u32 v24, 320, v1
  v_mul_u32_u24 v25, 3450, v24
  v_lshrrev_b32 v25, 16, v25
  v_mul_u32_u24 v26, 19, v25
  v_sub_u32 v24, v24, v26
  v_min_u32 v24, 17, v24
  v_min_u32 v25, 31, v25
  v_mul_u32_u24 v25, 1152, v25
  v_lshl_add_u32 v37, v24, 4, v25
  v_add_u32 v24, 384, v1
  v_mul_u32_u24 v25, 3450, v24
  v_lshrrev_b32 v25, 16, v25
  v_mul_u32_u24 v26, 19, v25
  v_sub_u32 v24, v24, v26
  v_min_u32 v24, 17, v24
  v_min_u32 v25, 31, v25
  v_mul_u32_u24 v25, 1152, v25
  v_lshl_add_u32 v38, v24, 4, v25
  v_add_u32 v24, 448, v1
  v_mul_u32_u24 v25, 3450, v24
  v_lshrrev_b32 v25, 16, v25
  v_mul_u32_u24 v26, 19, v25
  v_sub_u32 v24, v24, v26
  v_min_u32 v24, 17, v24
  v_min_u32 v25, 31, v25
  v_mul_u32_u24 v25, 1152, v25
  v_lshl_add_u32 v39, v24, 4, v25
  v_add_u32 v24, 512, v1
  v_mul_u32_u24 v25, 3450, v24
  v_lshrrev_b32 v25, 16, v25
  v_mul_u32_u24 v26, 19, v25
  v_sub_u32 v24, v24, v26
  v_min_u32 v24, 17, v24
  v_min_u32 v25, 31, v25
  v_mul_u32_u24 v25, 1152, v25
  v_lshl_add_u32 v40, v24, 4, v25
  v_add_u32 v24, 576, v1
  v_mul_u32_u24 v25, 3450, v24
  v_lshrrev_b32 v25, 16, v25
  v_mul_u32_u24 v26, 19, v25
  v_sub_u32 v24, v24, v26
  v_min_u32 v24, 17, v24
  v_min_u32 v25, 31, v25
  v_mul_u32_u24 v25, 1152, v25
  v_lshl_add_u32 v41, v24, 4, v25
  s_mul_i32 s32, s22, 20480
  s_add_u32 s32, s32, 73728
  v_mul_u32_u24 v24, 19, v18
  v_add_u32 v24, v24, v19
  v_lshlrev_b32 v24, 4, v24
  v_add_u32 v42, s32, v24
  s_mul_i32 s25, s35, 36864
  s_mov_b32 s27, s32
  s_add_u32 s26, s25, 0
  s_add_u32 m0, s27, 0
  s_nop 0
  buffer_load_dwordx4 v32, s[12:15], s26 offen lds
  s_add_u32 m0, m0, 1024
  s_nop 0
  buffer_load_dwordx4 v33, s[12:15], s26 offen lds
  s_add_u32 m0, m0, 1024
  s_nop 0
  buffer_load_dwordx4 v34, s[12:15], s26 offen lds
  s_add_u32 m0, m0, 1024
  s_nop 0
  buffer_load_dwordx4 v35, s[12:15], s26 offen lds
  s_add_u32 m0, m0, 1024
  s_nop 0
  buffer_load_dwordx4 v36, s[12:15], s26 offen lds
  s_add_u32 m0, m0, 1024
  s_nop 0
  buffer_load_dwordx4 v37, s[12:15], s26 offen lds
  s_add_u32 m0, m0, 1024
  s_nop 0
  buffer_load_dwordx4 v38, s[12:15], s26 offen lds
  s_add_u32 m0, m0, 1024
  s_nop 0
  buffer_load_dwordx4 v39, s[12:15], s26 offen lds
  s_add_u32 m0, m0, 1024
  s_nop 0
  buffer_load_dwordx4 v40, s[12:15], s26 offen lds
  s_add_u32 m0, m0, 1024
  s_nop 0
  buffer_load_dwordx4 v41, s[12:15], s26 offen lds
  s_add_u32 s26, s25, 288
  s_add_u32 m0, s27, 10240
  s_nop 0
  buffer_load_dwordx4 v32, s[12:15], s26 offen lds
  s_add_u32 m0, m0, 1024
  s_nop 0
  buffer_load_dwordx4 v33, s[12:15], s26 offen lds
  s_add_u32 m0, m0, 1024
  s_nop 0
  buffer_load_dwordx4 v34, s[12:15], s26 offen lds
  s_add_u32 m0, m0, 1024
  s_nop 0
  buffer_load_dwordx4 v35, s[12:15], s26 offen lds
  s_add_u32 m0, m0, 1024
  s_nop 0
  buffer_load_dwordx4 v36, s[12:15], s26 offen lds
  s_add_u32 m0, m0, 1024
  s_nop 0
  buffer_load_dwordx4 v37, s[12:15], s26 offen lds
  s_add_u32 m0, m0, 1024
  s_nop 0
  buffer_load_dwordx4 v38, s[12:15], s26 offen lds
  s_add_u32 m0, m0, 1024
  s_nop 0
  buffer_load_dwordx4 v39, s[12:15], s26 offen lds
  s_add_u32 m0, m0, 1024
  s_nop 0
  buffer_load_dwordx4 v40, s[12:15], s26 offen lds
  s_add_u32 m0, m0, 1024
  s_nop 0
  buffer_load_dwordx4 v41, s[12:15], s26 offen lds
  v_lshrrev_b32 v21, 4, v18
  v_lshlrev_b32 v21, 12, v21
  v_lshl_add_u32 v21, v19, 8, v21
  v_and_b32 v22, 15, v18
  v_lshl_add_u32 v13, v22, 4, v21
  v_and_b32 v21, 1, v18
  v_lshlrev_b32 v21, 10, v21
  v_lshl_add_u32 v21, v19, 8, v21
  v_lshrrev_b32 v22, 1, v18
  v_lshl_add_u32 v14, v22, 4, v21
  v_lshlrev_b32 v15, 4, v1
  v_bfe_u32 v21, v1, 2, 2
  v_lshl_add_u32 v22, v19, 3, v21
  v_lshlrev_b32 v22, 7, v22
  v_bfe_u32 v21, v21, 1, 1
  v_lshlrev_b32 v21, 6, v21
  v_add_u32 v22, v22, v21
  v_bfe_u32 v23, v1, 4, 1
  v_and_b32 v24, 3, v1
  v_lshl_add_u32 v23, v23, 2, v24
  v_lshl_add_u32 v7, v23, 3, v22
  v_xor_b32 v8, 64, v7
  v_and_b32 v24, 4, v23
  v_and_b32 v25, 1, v23
  v_lshl_add_u32 v24, v25, 1, v24
  v_bfe_u32 v25, v23, 1, 1
  v_add_u32 v24, v24, v25
  v_lshl_add_u32 v5, v24, 3, v22
  v_xor_b32 v6, 64, v5
  v_cndmask_b32 v21, v5, v7, s[56:57]
  v_add_u32 v21, s60, v21
  s_waitcnt vmcnt(10)
  ds_read_b128 a[0:3], v42 offset:0
  ds_read_b128 a[4:7], v42 offset:32
  ds_read_b128 a[8:11], v42 offset:64
  ds_read_b128 a[12:15], v42 offset:96
  ds_read_b128 a[16:19], v42 offset:128
  ds_read_b128 a[20:23], v42 offset:160
  ds_read_b128 a[24:27], v42 offset:192
  ds_read_b128 a[28:31], v42 offset:224
  ds_read_b128 a[32:35], v42 offset:256
  s_waitcnt lgkmcnt(0)
  s_add_u32 s26, s25, 576
  s_add_u32 m0, s27, 0
  s_nop 0
  buffer_load_dwordx4 v32, s[12:15], s26 offen lds
  s_add_u32 m0, m0, 1024
  s_nop 0
  buffer_load_dwordx4 v33, s[12:15], s26 offen lds
  s_add_u32 m0, m0, 1024
  s_nop 0
  buffer_load_dwordx4 v34, s[12:15], s26 offen lds
  s_add_u32 m0, m0, 1024
  s_nop 0
  buffer_load_dwordx4 v35, s[12:15], s26 offen lds
  s_add_u32 m0, m0, 1024
  s_nop 0
  buffer_load_dwordx4 v36, s[12:15], s26 offen lds
  s_add_u32 m0, m0, 1024
  s_nop 0
  buffer_load_dwordx4 v37, s[12:15], s26 offen lds
  s_add_u32 m0, m0, 1024
  s_nop 0
  buffer_load_dwordx4 v38, s[12:15], s26 offen lds
  s_add_u32 m0, m0, 1024
  s_nop 0
  buffer_load_dwordx4 v39, s[12:15], s26 offen lds
  s_add_u32 m0, m0, 1024
  s_nop 0
  buffer_load_dwordx4 v40, s[12:15], s26 offen lds
  s_add_u32 m0, m0, 1024
  s_nop 0
  buffer_load_dwordx4 v41, s[12:15], s26 offen lds
  s_waitcnt vmcnt(10)
  ds_read_b128 a[36:39], v42 offset:10240
  ds_read_b128 a[40:43], v42 offset:10272
  ds_read_b128 a[44:47], v42 offset:10304
  ds_read_b128 a[48:51], v42 offset:10336
  ds_read_b128 a[52:55], v42 offset:10368
  ds_read_b128 a[56:59], v42 offset:10400
  ds_read_b128 a[60:63], v42 offset:10432
  ds_read_b128 a[64:67], v42 offset:10464
  ds_read_b128 a[68:71], v42 offset:10496
  s_waitcnt lgkmcnt(0)
  s_add_u32 s26, s25, 864
  s_add_u32 m0, s27, 10240
  s_nop 0
  buffer_load_dwordx4 v32, s[12:15], s26 offen lds
  s_add_u32 m0, m0, 1024
  s_nop 0
  buffer_load_dwordx4 v33, s[12:15], s26 offen lds
  s_add_u32 m0, m0, 1024
  s_nop 0
  buffer_load_dwordx4 v34, s[12:15], s26 offen lds
  s_add_u32 m0, m0, 1024
  s_nop 0
  buffer_load_dwordx4 v35, s[12:15], s26 offen lds
  s_add_u32 m0, m0, 1024
  s_nop 0
  buffer_load_dwordx4 v36, s[12:15], s26 offen lds
  s_add_u32 m0, m0, 1024
  s_nop 0
  buffer_load_dwordx4 v37, s[12:15], s26 offen lds
  s_add_u32 m0, m0, 1024
  s_nop 0
  buffer_load_dwordx4 v38, s[12:15], s26 offen lds
  s_add_u32 m0, m0, 1024
  s_nop 0
  buffer_load_dwordx4 v39, s[12:15], s26 offen lds
  s_add_u32 m0, m0, 1024
  s_nop 0
  buffer_load_dwordx4 v40, s[12:15], s26 offen lds
  s_add_u32 m0, m0, 1024
  s_nop 0
  buffer_load_dwordx4 v41, s[12:15], s26 offen lds
  s_waitcnt vmcnt(10)
  ds_read_b128 a[72:75], v42 offset:0
  ds_read_b128 a[76:79], v42 offset:32
  ds_read_b128 a[80:83], v42 offset:64
  ds_read_b128 a[84:87], v42 offset:96
  ds_read_b128 a[88:91], v42 offset:128
  ds_read_b128 a[92:95], v42 offset:160
  ds_read_b128 a[96:99], v42 offset:192
  ds_read_b128 a[100:103], v42 offset:224
  ds_read_b128 a[104:107], v42 offset:256
  s_waitcnt lgkmcnt(0)
  s_add_u32 s26, s25, 36864
  s_add_u32 m0, s27, 0
  s_nop 0
  buffer_load_dwordx4 v32, s[12:15], s26 offen lds
  s_add_u32 m0, m0, 1024
  s_nop 0
  buffer_load_dwordx4 v33, s[12:15], s26 offen lds
  s_add_u32 m0, m0, 1024
  s_nop 0
  buffer_load_dwordx4 v34, s[12:15], s26 offen lds
  s_add_u32 m0, m0, 1024
  s_nop 0
  buffer_load_dwordx4 v35, s[12:15], s26 offen lds
  s_add_u32 m0, m0, 1024
  s_nop 0
  buffer_load_dwordx4 v36, s[12:15], s26 offen lds
  s_add_u32 m0, m0, 1024
  s_nop 0
  buffer_load_dwordx4 v37, s[12:15], s26 offen lds
  s_add_u32 m0, m0, 1024
  s_nop 0
  buffer_load_dwordx4 v38, s[12:15], s26 offen lds
  s_add_u32 m0, m0, 1024
  s_nop 0
  buffer_load_dwordx4 v39, s[12:15], s26 offen lds
  s_add_u32 m0, m0, 1024
  s_nop 0
  buffer_load_dwordx4 v40, s[12:15], s26 offen lds
  s_add_u32 m0, m0, 1024
  s_nop 0
  buffer_load_dwordx4 v41, s[12:15], s26 offen lds
  s_waitcnt vmcnt(10)
  ds_read_b128 a[108:111], v42 offset:10240
  ds_read_b128 a[112:115], v42 offset:10272
  ds_read_b128 a[116:119], v42 offset:10304
  ds_read_b128 a[120:123], v42 offset:10336
  ds_read_b128 a[124:127], v42 offset:10368
  ds_read_b128 a[128:131], v42 offset:10400
  ds_read_b128 a[132:135], v42 offset:10432
  ds_read_b128 a[136:139], v42 offset:10464
  ds_read_b128 a[140:143], v42 offset:10496
  v_mov_b32 v43, s93
  s_cmp_lg_u32 s22, 3
  s_cbranch_scc1 L_reg_g
  s_mov_b64 exec, 1
  buffer_atomic_or v43, off, s[16:19], s92 offset:0 sc0
  s_mov_b64 exec, -1
    L_reg_g:
  s_waitcnt lgkmcnt(0)
  s_add_u32 s26, s25, 37152
  s_add_u32 m0, s27, 10240
  s_nop 0
  buffer_load_dwordx4 v32, s[12:15], s26 offen lds
  s_add_u32 m0, m0, 1024
  s_nop 0
  buffer_load_dwordx4 v33, s[12:15], s26 offen lds
  s_add_u32 m0, m0, 1024
  s_nop 0
  buffer_load_dwordx4 v34, s[12:15], s26 offen lds
  s_add_u32 m0, m0, 1024
  s_nop 0
  buffer_load_dwordx4 v35, s[12:15], s26 offen lds
  s_add_u32 m0, m0, 1024
  s_nop 0
  buffer_load_dwordx4 v36, s[12:15], s26 offen lds
  s_add_u32 m0, m0, 1024
  s_nop 0
  buffer_load_dwordx4 v37, s[12:15], s26 offen lds
  s_add_u32 m0, m0, 1024
  s_nop 0
  buffer_load_dwordx4 v38, s[12:15], s26 offen lds
  s_add_u32 m0, m0, 1024
  s_nop 0
  buffer_load_dwordx4 v39, s[12:15], s26 offen lds
  s_add_u32 m0, m0, 1024
  s_nop 0
  buffer_load_dwordx4 v40, s[12:15], s26 offen lds
  s_add_u32 m0, m0, 1024
  s_nop 0
  buffer_load_dwordx4 v41, s[12:15], s26 offen lds
  s_waitcnt vmcnt(10)
  ds_read_b128 a[144:147], v42 offset:0
  ds_read_b128 a[148:151], v42 offset:32
  ds_read_b128 a[152:155], v42 offset:64
  ds_read_b128 a[156:159], v42 offset:96
  ds_read_b128 a[160:163], v42 offset:128
  ds_read_b128 a[164:167], v42 offset:160
  ds_read_b128 a[168:171], v42 offset:192
  ds_read_b128 a[172:175], v42 offset:224
  ds_read_b128 a[176:179], v42 offset:256
  s_waitcnt lgkmcnt(0)
  s_add_u32 s26, s25, 37440
  s_add_u32 m0, s27, 0
  s_nop 0
  buffer_load_dwordx4 v32, s[12:15], s26 offen lds
  s_add_u32 m0, m0, 1024
  s_nop 0
  buffer_load_dwordx4 v33, s[12:15], s26 offen lds
  s_add_u32 m0, m0, 1024
  s_nop 0
  buffer_load_dwordx4 v34, s[12:15], s26 offen lds
  s_add_u32 m0, m0, 1024
  s_nop 0
  buffer_load_dwordx4 v35, s[12:15], s26 offen lds
  s_add_u32 m0, m0, 1024
  s_nop 0
  buffer_load_dwordx4 v36, s[12:15], s26 offen lds
  s_add_u32 m0, m0, 1024
  s_nop 0
  buffer_load_dwordx4 v37, s[12:15], s26 offen lds
  s_add_u32 m0, m0, 1024
  s_nop 0
  buffer_load_dwordx4 v38, s[12:15], s26 offen lds
  s_add_u32 m0, m0, 1024
  s_nop 0
  buffer_load_dwordx4 v39, s[12:15], s26 offen lds
  s_add_u32 m0, m0, 1024
  s_nop 0
  buffer_load_dwordx4 v40, s[12:15], s26 offen lds
  s_add_u32 m0, m0, 1024
  s_nop 0
  buffer_load_dwordx4 v41, s[12:15], s26 offen lds
  s_waitcnt vmcnt(10)
  ds_read_b128 a[180:183], v42 offset:10240
  ds_read_b128 a[184:187], v42 offset:10272
  ds_read_b128 a[188:191], v42 offset:10304
  ds_read_b128 a[192:195], v42 offset:10336
  ds_read_b128 a[196:199], v42 offset:10368
  ds_read_b128 a[200:203], v42 offset:10400
  ds_read_b128 a[204:207], v42 offset:10432
  ds_read_b128 a[208:211], v42 offset:10464
  ds_read_b128 a[212:215], v42 offset:10496
  s_waitcnt lgkmcnt(0)
  s_add_u32 s26, s25, 37728
  s_add_u32 m0, s27, 10240
  s_nop 0
  buffer_load_dwordx4 v32, s[12:15], s26 offen lds
  s_add_u32 m0, m0, 1024
  s_nop 0
  buffer_load_dwordx4 v33, s[12:15], s26 offen lds
  s_add_u32 m0, m0, 1024
  s_nop 0
  buffer_load_dwordx4 v34, s[12:15], s26 offen lds
  s_add_u32 m0, m0, 1024
  s_nop 0
  buffer_load_dwordx4 v35, s[12:15], s26 offen lds
  s_add_u32 m0, m0, 1024
  s_nop 0
  buffer_load_dwordx4 v36, s[12:15], s26 offen lds
  s_add_u32 m0, m0, 1024
  s_nop 0
  buffer_load_dwordx4 v37, s[12:15], s26 offen lds
  s_add_u32 m0, m0, 1024
  s_nop 0
  buffer_load_dwordx4 v38, s[12:15], s26 offen lds
  s_add_u32 m0, m0, 1024
  s_nop 0
  buffer_load_dwordx4 v39, s[12:15], s26 offen lds
  s_add_u32 m0, m0, 1024
  s_nop 0
  buffer_load_dwordx4 v40, s[12:15], s26 offen lds
  s_add_u32 m0, m0, 1024
  s_nop 0
  buffer_load_dwordx4 v41, s[12:15], s26 offen lds
  s_waitcnt vmcnt(10)
  ds_read_b128 a[216:219], v42 offset:0
  ds_read_b128 a[220:223], v42 offset:32
  ds_read_b128 a[224:227], v42 offset:64
  ds_read_b128 a[228:231], v42 offset:96
  ds_read_b128 a[232:235], v42 offset:128
  ds_read_b128 a[236:239], v42 offset:160
  ds_read_b128 a[240:243], v42 offset:192
  ds_read_b128 a[244:247], v42 offset:224
  ds_read_b128 a[248:251], v42 offset:256
  s_waitcnt vmcnt(0)
  ds_read_b128 a[252:255], v42 offset:10240
  ds_read_b128 v[224:227], v42 offset:10272
  ds_read_b128 v[228:231], v42 offset:10304
  ds_read_b128 v[232:235], v42 offset:10336
  ds_read_b128 v[236:239], v42 offset:10368
  ds_read_b128 v[240:243], v42 offset:10400
  ds_read_b128 v[244:247], v42 offset:10432
  ds_read_b128 v[248:251], v42 offset:10464
  ds_read_b128 v[252:255], v42 offset:10496
  s_cmp_lg_u32 s22, 3
  s_cbranch_scc1 L_reg_g2
  v_and_b32 v43, s93, v43
  v_mov_b32 v44, 163836
  s_mov_b64 exec, 1
  ds_write_b32 v44, v43
  s_mov_b64 exec, -1
  s_waitcnt lgkmcnt(0)
    L_reg_g2:
  s_waitcnt lgkmcnt(0)
  s_barrier
  v_mov_b32 v44, 163836
  ds_read_b32 v43, v44
  s_waitcnt lgkmcnt(0)
  v_readfirstlane_b32 s29, v43
  s_nop 0
  s_cmp_lg_u32 s29, 0
  s_cbranch_scc1 L_conflict
  s_mov_b32 s93, 0
  s_cmp_lg_u32 s23, s71
  s_cbranch_scc1 L_noz
  s_cmp_lg_u32 s24, 0
  s_cbranch_scc1 L_noz
  v_mov_b32 v28, 0
  v_and_b32 v29, 7, v1
  v_lshlrev_b32 v29, 7, v29
  s_lshl_b32 s29, s23, 10
  s_add_u32 s29, s29, 1384448
  buffer_store_dword v28, v29, s[8:11], s29 offen sc1
    L_noz:
  v_mov_b64 v[24:25], 0
  v_mov_b64 v[26:27], 0
  s_mov_b32 s25, 0
L_g1loop:
  v_mov_b32 v9, v21
  v_xor_b32 v10, 64, v21
  v_add_u32 v11, 0x10000, v21
  v_add_u32 v12, 0x10000, v10
  s_mov_b32 s26, s28
  s_mov_b32 s27, s59
  s_cmp_eq_u32 s26, 1
  s_cbranch_scc1 L_bodyV
  ds_read_b64_tr_b16 v[192:193], v9 offset:0
  ds_read_b64_tr_b16 v[194:195], v9 offset:512
  ds_read_b64_tr_b16 v[196:197], v10 offset:0
  ds_read_b64_tr_b16 v[198:199], v10 offset:512
  ds_read_b64_tr_b16 v[200:201], v9 offset:2048
  ds_read_b64_tr_b16 v[202:203], v9 offset:2560
  ds_read_b64_tr_b16 v[204:205], v10 offset:2048
  ds_read_b64_tr_b16 v[206:207], v10 offset:2560
  s_waitcnt lgkmcnt(6)
  v_mfma_f32_32x32x16_bf16 v[128:143], v[192:195], a[0:3], 0
  ds_read_b64_tr_b16 v[208:209], v9 offset:4096
  s_cmp_eq_u32 s25, s69
  s_cselect_b32 s67, 0, s67
  s_add_u32 s58, s58, s67
  v_mfma_f32_32x32x16_bf16 v[144:159], v[192:195], a[144:147], 0
  ds_read_b64_tr_b16 v[210:211], v9 offset:4608
  s_sub_u32 s29, s58, 336
  s_cselect_b32 s58, s58, s29
  s_mov_b32 s67, s68
  s_waitcnt lgkmcnt(6)
  v_mfma_f32_32x32x16_bf16 v[160:175], v[196:199], a[0:3], 0
  ds_read_b64_tr_b16 v[212:213], v10 offset:4096
  s_mov_b32 s68, 28
  s_sub_u32 s60, 73728, s60
  s_lshl_b32 s29, s22, 10
  v_mfma_f32_32x32x16_bf16 v[176:191], v[196:199], a[144:147], 0
  ds_read_b64_tr_b16 v[214:215], v10 offset:4608
  s_add_u32 s29, s29, s60
  s_mov_b32 m0, s29
  s_lshr_b32 s30, s58, 6
  s_waitcnt lgkmcnt(6)
  v_mfma_f32_32x32x16_bf16 v[128:143], v[200:203], a[4:7], v[128:143]
  ds_read_b64_tr_b16 v[192:193], v9 offset:6144
  s_cmp_eq_u32 s30, 1
  s_cselect_b32 s28, 1, 0
  s_cselect_b64 s[36:37], s[46:47], s[44:45]
  v_mfma_f32_32x32x16_bf16 v[144:159], v[200:203], a[148:151], v[144:159]
  ds_read_b64_tr_b16 v[194:195], v9 offset:6656
  s_cselect_b32 s31, s62, s61
  s_cselect_b32 s32, 12, 11
  s_cmp_eq_u32 s30, 2
  s_waitcnt lgkmcnt(6)
  v_mfma_f32_32x32x16_bf16 v[160:175], v[204:207], a[4:7], v[160:175]
  ds_read_b64_tr_b16 v[196:197], v10 offset:6144
  s_cselect_b64 s[36:37], s[42:43], s[36:37]
  s_cselect_b32 s31, s63, s31
  s_and_b32 s30, s58, 63
  v_mfma_f32_32x32x16_bf16 v[176:191], v[204:207], a[148:151], v[176:191]
  ds_read_b64_tr_b16 v[198:199], v10 offset:6656
  s_lshr_b32 s59, s30, 1
  s_lshl_b32 s59, s59, 13
  s_add_u32 s59, s59, s31
  s_waitcnt lgkmcnt(6)
  v_mfma_f32_32x32x16_bf16 v[128:143], v[208:211], a[8:11], v[128:143]
  ds_read_b64_tr_b16 v[200:201], v9 offset:8192
  s_and_b32 s31, s58, 1
  s_lshl_b32 s31, s31, s32
  s_add_u32 s59, s59, s31
  v_mfma_f32_32x32x16_bf16 v[144:159], v[208:211], a[152:155], v[144:159]
  ds_read_b64_tr_b16 v[202:203], v9 offset:8704
  s_lshl_b32 s30, s30, 7
  s_sub_u32 s31, s58, 192
  s_lshl_b32 s32, s31, 11
  s_waitcnt lgkmcnt(6)
  v_mfma_f32_32x32x16_bf16 v[160:175], v[212:215], a[8:11], v[160:175]
  ds_read_b64_tr_b16 v[204:205], v10 offset:8192
  s_add_u32 s32, s32, s64
  s_lshl_b32 s31, s31, 6
  s_cmp_ge_u32 s58, 192
  v_mfma_f32_32x32x16_bf16 v[176:191], v[212:215], a[152:155], v[176:191]
  ds_read_b64_tr_b16 v[206:207], v10 offset:8704
  s_cselect_b32 s28, 2, s28
  s_cselect_b32 s59, s32, s59
  s_cselect_b32 s30, s31, s30
  s_waitcnt lgkmcnt(6)
  v_mfma_f32_32x32x16_bf16 v[128:143], v[192:195], a[12:15], v[128:143]
  ds_read_b64_tr_b16 v[208:209], v9 offset:10240
  s_cselect_b64 s[38:39], s[50:51], s[36:37]
  s_cselect_b64 s[36:37], s[48:49], s[36:37]
  s_cselect_b32 s31, s65, s66
  v_mfma_f32_32x32x16_bf16 v[144:159], v[192:195], a[156:159], v[144:159]
  ds_read_b64_tr_b16 v[210:211], v9 offset:10752
  s_cselect_b32 s32, 63, 127
  s_lshl_b32 s40, s31, 5
  s_cmp_eq_u32 s28, 1
  s_waitcnt lgkmcnt(6)
  v_mfma_f32_32x32x16_bf16 v[160:175], v[196:199], a[12:15], v[160:175]
  ds_read_b64_tr_b16 v[212:213], v10 offset:10240
  s_cselect_b64 s[56:57], -1, 0
  v_mfma_f32_32x32x16_bf16 v[176:191], v[196:199], a[156:159], v[176:191]
  ds_read_b64_tr_b16 v[214:215], v10 offset:10752
  v_mul_u32_u24 v18, s31, v2
  v_and_b32 v19, s32, v3
  s_waitcnt lgkmcnt(6)
  v_mfma_f32_32x32x16_bf16 v[128:143], v[200:203], a[16:19], v[128:143]
  ds_read_b64_tr_b16 v[192:193], v9 offset:12288
  v_add3_u32 v18, v18, v19, s30
  v_mov_b32 v19, s36
  v_mfma_f32_32x32x16_bf16 v[144:159], v[200:203], a[160:163], v[144:159]
  ds_read_b64_tr_b16 v[194:195], v9 offset:12800
  v_mov_b32 v20, s38
  v_cndmask_b32 v16, v19, v20, s[52:53]
  s_waitcnt lgkmcnt(6)
  v_mfma_f32_32x32x16_bf16 v[160:175], v[204:207], a[16:19], v[160:175]
  ds_read_b64_tr_b16 v[196:197], v10 offset:12288
  v_mov_b32 v19, s37
  v_mov_b32 v20, s39
  v_mfma_f32_32x32x16_bf16 v[176:191], v[204:207], a[160:163], v[176:191]
  ds_read_b64_tr_b16 v[198:199], v10 offset:12800
  v_cndmask_b32 v17, v19, v20, s[52:53]
  v_add_co_u32 v16, vcc, v16, v18
  s_waitcnt lgkmcnt(6)
  v_mfma_f32_32x32x16_bf16 v[128:143], v[208:211], a[20:23], v[128:143]
  ds_read_b64_tr_b16 v[200:201], v9 offset:14336
  v_cndmask_b32 v21, v5, v7, s[56:57]
  v_add_u32 v21, s60, v21
  v_mfma_f32_32x32x16_bf16 v[144:159], v[208:211], a[164:167], v[144:159]
  ds_read_b64_tr_b16 v[202:203], v9 offset:14848
  v_addc_co_u32 v17, vcc, 0, v17, vcc
  s_waitcnt lgkmcnt(6)
  v_mfma_f32_32x32x16_bf16 v[160:175], v[212:215], a[20:23], v[160:175]
  ds_read_b64_tr_b16 v[204:205], v10 offset:14336
  v_mfma_f32_32x32x16_bf16 v[176:191], v[212:215], a[164:167], v[176:191]
  ds_read_b64_tr_b16 v[206:207], v10 offset:14848
  s_waitcnt lgkmcnt(6)
  v_mfma_f32_32x32x16_bf16 v[128:143], v[192:195], a[24:27], v[128:143]
  ds_read_b64_tr_b16 v[208:209], v9 offset:16384
  v_mfma_f32_32x32x16_bf16 v[144:159], v[192:195], a[168:171], v[144:159]
  ds_read_b64_tr_b16 v[210:211], v9 offset:16896
  global_load_lds_dwordx4 v[16:17], off
  s_add_u32 m0, m0, 4096
  v_lshl_add_u64 v[16:17], v[16:17], 0, s[40:41]
  s_waitcnt lgkmcnt(6)
  v_mfma_f32_32x32x16_bf16 v[160:175], v[196:199], a[24:27], v[160:175]
  ds_read_b64_tr_b16 v[212:213], v10 offset:16384
  v_mfma_f32_32x32x16_bf16 v[176:191], v[196:199], a[168:171], v[176:191]
  ds_read_b64_tr_b16 v[214:215], v10 offset:16896
  s_waitcnt lgkmcnt(6)
  v_mfma_f32_32x32x16_bf16 v[128:143], v[200:203], a[28:31], v[128:143]
  ds_read_b64_tr_b16 v[192:193], v9 offset:18432
  v_mfma_f32_32x32x16_bf16 v[144:159], v[200:203], a[172:175], v[144:159]
  ds_read_b64_tr_b16 v[194:195], v9 offset:18944
  global_load_lds_dwordx4 v[16:17], off
  s_add_u32 m0, m0, 4096
  v_lshl_add_u64 v[16:17], v[16:17], 0, s[40:41]
  s_waitcnt lgkmcnt(6)
  v_mfma_f32_32x32x16_bf16 v[160:175], v[204:207], a[28:31], v[160:175]
  ds_read_b64_tr_b16 v[196:197], v10 offset:18432
  v_mfma_f32_32x32x16_bf16 v[176:191], v[204:207], a[172:175], v[176:191]
  ds_read_b64_tr_b16 v[198:199], v10 offset:18944
  s_waitcnt lgkmcnt(6)
  v_mfma_f32_32x32x16_bf16 v[128:143], v[208:211], a[32:35], v[128:143]
  ds_read_b64_tr_b16 v[200:201], v9 offset:20480
  v_mfma_f32_32x32x16_bf16 v[144:159], v[208:211], a[176:179], v[144:159]
  ds_read_b64_tr_b16 v[202:203], v9 offset:20992
  global_load_lds_dwordx4 v[16:17], off
  s_add_u32 m0, m0, 4096
  v_lshl_add_u64 v[16:17], v[16:17], 0, s[40:41]
  s_waitcnt lgkmcnt(6)
  v_mfma_f32_32x32x16_bf16 v[160:175], v[212:215], a[32:35], v[160:175]
  ds_read_b64_tr_b16 v[204:205], v10 offset:20480
  v_mfma_f32_32x32x16_bf16 v[176:191], v[212:215], a[176:179], v[176:191]
  ds_read_b64_tr_b16 v[206:207], v10 offset:20992
  s_waitcnt lgkmcnt(6)
  v_mfma_f32_32x32x16_bf16 v[128:143], v[192:195], a[36:39], v[128:143]
  ds_read_b64_tr_b16 v[208:209], v9 offset:22528
  v_mfma_f32_32x32x16_bf16 v[144:159], v[192:195], a[180:183], v[144:159]
  ds_read_b64_tr_b16 v[210:211], v9 offset:23040
  global_load_lds_dwordx4 v[16:17], off
  s_add_u32 m0, m0, 4096
  v_lshl_add_u64 v[16:17], v[16:17], 0, s[40:41]
  s_waitcnt lgkmcnt(6)
  v_mfma_f32_32x32x16_bf16 v[160:175], v[196:199], a[36:39], v[160:175]
  ds_read_b64_tr_b16 v[212:213], v10 offset:22528
  v_mfma_f32_32x32x16_bf16 v[176:191], v[196:199], a[180:183], v[176:191]
  ds_read_b64_tr_b16 v[214:215], v10 offset:23040
  s_waitcnt lgkmcnt(6)
  v_mfma_f32_32x32x16_bf16 v[128:143], v[200:203], a[40:43], v[128:143]
  ds_read_b64_tr_b16 v[192:193], v9 offset:24576
  v_mfma_f32_32x32x16_bf16 v[144:159], v[200:203], a[184:187], v[144:159]
  ds_read_b64_tr_b16 v[194:195], v9 offset:25088
  global_load_lds_dwordx4 v[16:17], off
  s_add_u32 m0, m0, 4096
  v_lshl_add_u64 v[16:17], v[16:17], 0, s[40:41]
  s_waitcnt lgkmcnt(6)
  v_mfma_f32_32x32x16_bf16 v[160:175], v[204:207], a[40:43], v[160:175]
  ds_read_b64_tr_b16 v[196:197], v10 offset:24576
  v_mfma_f32_32x32x16_bf16 v[176:191], v[204:207], a[184:187], v[176:191]
  ds_read_b64_tr_b16 v[198:199], v10 offset:25088
  s_waitcnt lgkmcnt(6)
  v_mfma_f32_32x32x16_bf16 v[128:143], v[208:211], a[44:47], v[128:143]
  ds_read_b64_tr_b16 v[200:201], v9 offset:26624
  v_mfma_f32_32x32x16_bf16 v[144:159], v[208:211], a[188:191], v[144:159]
  ds_read_b64_tr_b16 v[202:203], v9 offset:27136
  global_load_lds_dwordx4 v[16:17], off
  s_add_u32 m0, m0, 4096
  v_lshl_add_u64 v[16:17], v[16:17], 0, s[40:41]
  s_waitcnt lgkmcnt(6)
  v_mfma_f32_32x32x16_bf16 v[160:175], v[212:215], a[44:47], v[160:175]
  ds_read_b64_tr_b16 v[204:205], v10 offset:26624
  v_mfma_f32_32x32x16_bf16 v[176:191], v[212:215], a[188:191], v[176:191]
  ds_read_b64_tr_b16 v[206:207], v10 offset:27136
  s_waitcnt lgkmcnt(6)
  v_mfma_f32_32x32x16_bf16 v[128:143], v[192:195], a[48:51], v[128:143]
  ds_read_b64_tr_b16 v[208:209], v9 offset:28672
  v_mfma_f32_32x32x16_bf16 v[144:159], v[192:195], a[192:195], v[144:159]
  ds_read_b64_tr_b16 v[210:211], v9 offset:29184
  global_load_lds_dwordx4 v[16:17], off
  s_add_u32 m0, m0, 4096
  v_lshl_add_u64 v[16:17], v[16:17], 0, s[40:41]
  s_waitcnt lgkmcnt(6)
  v_mfma_f32_32x32x16_bf16 v[160:175], v[196:199], a[48:51], v[160:175]
  ds_read_b64_tr_b16 v[212:213], v10 offset:28672
  v_mfma_f32_32x32x16_bf16 v[176:191], v[196:199], a[192:195], v[176:191]
  ds_read_b64_tr_b16 v[214:215], v10 offset:29184
  s_waitcnt lgkmcnt(6)
  v_mfma_f32_32x32x16_bf16 v[128:143], v[200:203], a[52:55], v[128:143]
  ds_read_b64_tr_b16 v[192:193], v9 offset:30720
  v_mfma_f32_32x32x16_bf16 v[144:159], v[200:203], a[196:199], v[144:159]
  ds_read_b64_tr_b16 v[194:195], v9 offset:31232
  global_load_lds_dwordx4 v[16:17], off
  s_add_u32 m0, m0, 4096
  v_lshl_add_u64 v[16:17], v[16:17], 0, s[40:41]
  s_waitcnt lgkmcnt(6)
  v_mfma_f32_32x32x16_bf16 v[160:175], v[204:207], a[52:55], v[160:175]
  ds_read_b64_tr_b16 v[196:197], v10 offset:30720
  v_mfma_f32_32x32x16_bf16 v[176:191], v[204:207], a[196:199], v[176:191]
  ds_read_b64_tr_b16 v[198:199], v10 offset:31232
  s_waitcnt lgkmcnt(6)
  v_mfma_f32_32x32x16_bf16 v[128:143], v[208:211], a[56:59], v[128:143]
  ds_read_b64_tr_b16 v[200:201], v9 offset:32768
  v_mfma_f32_32x32x16_bf16 v[144:159], v[208:211], a[200:203], v[144:159]
  ds_read_b64_tr_b16 v[202:203], v9 offset:33280
  global_load_lds_dwordx4 v[16:17], off
  s_add_u32 m0, m0, 4096
  v_lshl_add_u64 v[16:17], v[16:17], 0, s[40:41]
  s_waitcnt lgkmcnt(6)
  v_mfma_f32_32x32x16_bf16 v[160:175], v[212:215], a[56:59], v[160:175]
  ds_read_b64_tr_b16 v[204:205], v10 offset:32768
  v_mfma_f32_32x32x16_bf16 v[176:191], v[212:215], a[200:203], v[176:191]
  ds_read_b64_tr_b16 v[206:207], v10 offset:33280
  s_waitcnt lgkmcnt(6)
  v_mfma_f32_32x32x16_bf16 v[128:143], v[192:195], a[60:63], v[128:143]
  ds_read_b64_tr_b16 v[208:209], v9 offset:34816
  v_mfma_f32_32x32x16_bf16 v[144:159], v[192:195], a[204:207], v[144:159]
  ds_read_b64_tr_b16 v[210:211], v9 offset:35328
  global_load_lds_dwordx4 v[16:17], off
  s_add_u32 m0, m0, 4096
  v_lshl_add_u64 v[16:17], v[16:17], 0, s[40:41]
  s_waitcnt lgkmcnt(6)
  v_mfma_f32_32x32x16_bf16 v[160:175], v[196:199], a[60:63], v[160:175]
  ds_read_b64_tr_b16 v[212:213], v10 offset:34816
  v_mfma_f32_32x32x16_bf16 v[176:191], v[196:199], a[204:207], v[176:191]
  ds_read_b64_tr_b16 v[214:215], v10 offset:35328
  s_waitcnt lgkmcnt(6)
  v_mfma_f32_32x32x16_bf16 v[128:143], v[200:203], a[64:67], v[128:143]
  ds_read_b64_tr_b16 v[192:193], v9 offset:36864
  v_mfma_f32_32x32x16_bf16 v[144:159], v[200:203], a[208:211], v[144:159]
  ds_read_b64_tr_b16 v[194:195], v9 offset:37376
  global_load_lds_dwordx4 v[16:17], off
  s_add_u32 m0, m0, 4096
  v_lshl_add_u64 v[16:17], v[16:17], 0, s[40:41]
  s_waitcnt lgkmcnt(6)
  v_mfma_f32_32x32x16_bf16 v[160:175], v[204:207], a[64:67], v[160:175]
  ds_read_b64_tr_b16 v[196:197], v10 offset:36864
  v_mfma_f32_32x32x16_bf16 v[176:191], v[204:207], a[208:211], v[176:191]
  ds_read_b64_tr_b16 v[198:199], v10 offset:37376
  s_waitcnt lgkmcnt(6)
  v_mfma_f32_32x32x16_bf16 v[128:143], v[208:211], a[68:71], v[128:143]
  ds_read_b64_tr_b16 v[200:201], v9 offset:38912
  v_mfma_f32_32x32x16_bf16 v[144:159], v[208:211], a[212:215], v[144:159]
  ds_read_b64_tr_b16 v[202:203], v9 offset:39424
  global_load_lds_dwordx4 v[16:17], off
  s_add_u32 m0, m0, 4096
  v_lshl_add_u64 v[16:17], v[16:17], 0, s[40:41]
  s_waitcnt lgkmcnt(6)
  v_mfma_f32_32x32x16_bf16 v[160:175], v[212:215], a[68:71], v[160:175]
  ds_read_b64_tr_b16 v[204:205], v10 offset:38912
  v_mfma_f32_32x32x16_bf16 v[176:191], v[212:215], a[212:215], v[176:191]
  ds_read_b64_tr_b16 v[206:207], v10 offset:39424
  s_waitcnt lgkmcnt(6)
  v_mfma_f32_32x32x16_bf16 v[128:143], v[192:195], a[72:75], v[128:143]
  ds_read_b64_tr_b16 v[208:209], v9 offset:40960
  v_mfma_f32_32x32x16_bf16 v[144:159], v[192:195], a[216:219], v[144:159]
  ds_read_b64_tr_b16 v[210:211], v9 offset:41472
  global_load_lds_dwordx4 v[16:17], off
  s_add_u32 m0, m0, 4096
  v_lshl_add_u64 v[16:17], v[16:17], 0, s[40:41]
  s_waitcnt lgkmcnt(6)
  v_mfma_f32_32x32x16_bf16 v[160:175], v[196:199], a[72:75], v[160:175]
  ds_read_b64_tr_b16 v[212:213], v10 offset:40960
  v_mfma_f32_32x32x16_bf16 v[176:191], v[196:199], a[216:219], v[176:191]
  ds_read_b64_tr_b16 v[214:215], v10 offset:41472
  s_waitcnt lgkmcnt(6)
  v_mfma_f32_32x32x16_bf16 v[128:143], v[200:203], a[76:79], v[128:143]
  ds_read_b64_tr_b16 v[192:193], v9 offset:43008
  v_mfma_f32_32x32x16_bf16 v[144:159], v[200:203], a[220:223], v[144:159]
  ds_read_b64_tr_b16 v[194:195], v9 offset:43520
  global_load_lds_dwordx4 v[16:17], off
  s_add_u32 m0, m0, 4096
  v_lshl_add_u64 v[16:17], v[16:17], 0, s[40:41]
  s_waitcnt lgkmcnt(6)
  v_mfma_f32_32x32x16_bf16 v[160:175], v[204:207], a[76:79], v[160:175]
  ds_read_b64_tr_b16 v[196:197], v10 offset:43008
  v_mfma_f32_32x32x16_bf16 v[176:191], v[204:207], a[220:223], v[176:191]
  ds_read_b64_tr_b16 v[198:199], v10 offset:43520
  s_waitcnt lgkmcnt(6)
  v_mfma_f32_32x32x16_bf16 v[128:143], v[208:211], a[80:83], v[128:143]
  ds_read_b64_tr_b16 v[200:201], v9 offset:45056
  v_mfma_f32_32x32x16_bf16 v[144:159], v[208:211], a[224:227], v[144:159]
  ds_read_b64_tr_b16 v[202:203], v9 offset:45568
  global_load_lds_dwordx4 v[16:17], off
  s_add_u32 m0, m0, 4096
  v_lshl_add_u64 v[16:17], v[16:17], 0, s[40:41]
  s_waitcnt lgkmcnt(6)
  v_mfma_f32_32x32x16_bf16 v[160:175], v[212:215], a[80:83], v[160:175]
  ds_read_b64_tr_b16 v[204:205], v10 offset:45056
  v_mfma_f32_32x32x16_bf16 v[176:191], v[212:215], a[224:227], v[176:191]
  ds_read_b64_tr_b16 v[206:207], v10 offset:45568
  s_waitcnt lgkmcnt(6)
  v_mfma_f32_32x32x16_bf16 v[128:143], v[192:195], a[84:87], v[128:143]
  ds_read_b64_tr_b16 v[208:209], v9 offset:47104
  v_mfma_f32_32x32x16_bf16 v[144:159], v[192:195], a[228:231], v[144:159]
  ds_read_b64_tr_b16 v[210:211], v9 offset:47616
  global_load_lds_dwordx4 v[16:17], off
  s_add_u32 m0, m0, 4096
  v_lshl_add_u64 v[16:17], v[16:17], 0, s[40:41]
  s_waitcnt lgkmcnt(6)
  v_mfma_f32_32x32x16_bf16 v[160:175], v[196:199], a[84:87], v[160:175]
  ds_read_b64_tr_b16 v[212:213], v10 offset:47104
  v_mfma_f32_32x32x16_bf16 v[176:191], v[196:199], a[228:231], v[176:191]
  ds_read_b64_tr_b16 v[214:215], v10 offset:47616
  s_waitcnt lgkmcnt(6)
  v_mfma_f32_32x32x16_bf16 v[128:143], v[200:203], a[88:91], v[128:143]
  ds_read_b64_tr_b16 v[192:193], v9 offset:49152
  v_mfma_f32_32x32x16_bf16 v[144:159], v[200:203], a[232:235], v[144:159]
  ds_read_b64_tr_b16 v[194:195], v9 offset:49664
  global_load_lds_dwordx4 v[16:17], off
  s_add_u32 m0, m0, 4096
  v_lshl_add_u64 v[16:17], v[16:17], 0, s[40:41]
  s_waitcnt lgkmcnt(6)
  v_mfma_f32_32x32x16_bf16 v[160:175], v[204:207], a[88:91], v[160:175]
  ds_read_b64_tr_b16 v[196:197], v10 offset:49152
  v_mfma_f32_32x32x16_bf16 v[176:191], v[204:207], a[232:235], v[176:191]
  ds_read_b64_tr_b16 v[198:199], v10 offset:49664
  s_waitcnt lgkmcnt(6)
  v_mfma_f32_32x32x16_bf16 v[128:143], v[208:211], a[92:95], v[128:143]
  ds_read_b64_tr_b16 v[200:201], v9 offset:51200
  v_mfma_f32_32x32x16_bf16 v[144:159], v[208:211], a[236:239], v[144:159]
  ds_read_b64_tr_b16 v[202:203], v9 offset:51712
  global_load_lds_dwordx4 v[16:17], off
  s_add_u32 m0, m0, 4096
  v_lshl_add_u64 v[16:17], v[16:17], 0, s[40:41]
  s_waitcnt lgkmcnt(6)
  v_mfma_f32_32x32x16_bf16 v[160:175], v[212:215], a[92:95], v[160:175]
  ds_read_b64_tr_b16 v[204:205], v10 offset:51200
  v_mfma_f32_32x32x16_bf16 v[176:191], v[212:215], a[236:239], v[176:191]
  ds_read_b64_tr_b16 v[206:207], v10 offset:51712
  s_waitcnt lgkmcnt(6)
  v_mfma_f32_32x32x16_bf16 v[128:143], v[192:195], a[96:99], v[128:143]
  ds_read_b64_tr_b16 v[208:209], v9 offset:53248
  v_mfma_f32_32x32x16_bf16 v[144:159], v[192:195], a[240:243], v[144:159]
  ds_read_b64_tr_b16 v[210:211], v9 offset:53760
  s_waitcnt lgkmcnt(6)
  v_mfma_f32_32x32x16_bf16 v[160:175], v[196:199], a[96:99], v[160:175]
  ds_read_b64_tr_b16 v[212:213], v10 offset:53248
  v_mfma_f32_32x32x16_bf16 v[176:191], v[196:199], a[240:243], v[176:191]
  ds_read_b64_tr_b16 v[214:215], v10 offset:53760
  s_waitcnt lgkmcnt(6)
  v_mfma_f32_32x32x16_bf16 v[128:143], v[200:203], a[100:103], v[128:143]
  ds_read_b64_tr_b16 v[192:193], v9 offset:55296
  v_mfma_f32_32x32x16_bf16 v[144:159], v[200:203], a[244:247], v[144:159]
  ds_read_b64_tr_b16 v[194:195], v9 offset:55808
  s_waitcnt lgkmcnt(6)
  v_mfma_f32_32x32x16_bf16 v[160:175], v[204:207], a[100:103], v[160:175]
  ds_read_b64_tr_b16 v[196:197], v10 offset:55296
  v_mfma_f32_32x32x16_bf16 v[176:191], v[204:207], a[244:247], v[176:191]
  ds_read_b64_tr_b16 v[198:199], v10 offset:55808
  s_waitcnt lgkmcnt(6)
  v_mfma_f32_32x32x16_bf16 v[128:143], v[208:211], a[104:107], v[128:143]
  ds_read_b64_tr_b16 v[200:201], v9 offset:57344
  v_mfma_f32_32x32x16_bf16 v[144:159], v[208:211], a[248:251], v[144:159]
  ds_read_b64_tr_b16 v[202:203], v9 offset:57856
  s_waitcnt lgkmcnt(6)
  v_mfma_f32_32x32x16_bf16 v[160:175], v[212:215], a[104:107], v[160:175]
  ds_read_b64_tr_b16 v[204:205], v10 offset:57344
  v_mfma_f32_32x32x16_bf16 v[176:191], v[212:215], a[248:251], v[176:191]
  ds_read_b64_tr_b16 v[206:207], v10 offset:57856
  s_waitcnt lgkmcnt(6)
  v_mfma_f32_32x32x16_bf16 v[128:143], v[192:195], a[108:111], v[128:143]
  ds_read_b64_tr_b16 v[208:209], v9 offset:59392
  v_mfma_f32_32x32x16_bf16 v[144:159], v[192:195], a[252:255], v[144:159]
  ds_read_b64_tr_b16 v[210:211], v9 offset:59904
  s_waitcnt lgkmcnt(6)
  v_mfma_f32_32x32x16_bf16 v[160:175], v[196:199], a[108:111], v[160:175]
  ds_read_b64_tr_b16 v[212:213], v10 offset:59392
  v_mfma_f32_32x32x16_bf16 v[176:191], v[196:199], a[252:255], v[176:191]
  ds_read_b64_tr_b16 v[214:215], v10 offset:59904
  s_waitcnt lgkmcnt(6)
  v_mfma_f32_32x32x16_bf16 v[128:143], v[200:203], a[112:115], v[128:143]
  ds_read_b64_tr_b16 v[192:193], v9 offset:61440
  v_mfma_f32_32x32x16_bf16 v[144:159], v[200:203], v[224:227], v[144:159]
  ds_read_b64_tr_b16 v[194:195], v9 offset:61952
  s_waitcnt lgkmcnt(6)
  v_mfma_f32_32x32x16_bf16 v[160:175], v[204:207], a[112:115], v[160:175]
  ds_read_b64_tr_b16 v[196:197], v10 offset:61440
  v_mfma_f32_32x32x16_bf16 v[176:191], v[204:207], v[224:227], v[176:191]
  ds_read_b64_tr_b16 v[198:199], v10 offset:61952
  s_waitcnt lgkmcnt(6)
  v_mfma_f32_32x32x16_bf16 v[128:143], v[208:211], a[116:119], v[128:143]
  ds_read_b64_tr_b16 v[200:201], v9 offset:63488
  v_mfma_f32_32x32x16_bf16 v[144:159], v[208:211], v[228:231], v[144:159]
  ds_read_b64_tr_b16 v[202:203], v9 offset:64000
  s_waitcnt lgkmcnt(6)
  v_mfma_f32_32x32x16_bf16 v[160:175], v[212:215], a[116:119], v[160:175]
  ds_read_b64_tr_b16 v[204:205], v10 offset:63488
  v_mfma_f32_32x32x16_bf16 v[176:191], v[212:215], v[228:231], v[176:191]
  ds_read_b64_tr_b16 v[206:207], v10 offset:64000
  s_waitcnt lgkmcnt(6)
  v_mfma_f32_32x32x16_bf16 v[128:143], v[192:195], a[120:123], v[128:143]
  ds_read_b64_tr_b16 v[208:209], v11 offset:0
  v_mfma_f32_32x32x16_bf16 v[144:159], v[192:195], v[232:235], v[144:159]
  ds_read_b64_tr_b16 v[210:211], v11 offset:512
  s_waitcnt lgkmcnt(6)
  v_mfma_f32_32x32x16_bf16 v[160:175], v[196:199], a[120:123], v[160:175]
  ds_read_b64_tr_b16 v[212:213], v12 offset:0
  v_mfma_f32_32x32x16_bf16 v[176:191], v[196:199], v[232:235], v[176:191]
  ds_read_b64_tr_b16 v[214:215], v12 offset:512
  s_waitcnt lgkmcnt(6)
  v_mfma_f32_32x32x16_bf16 v[128:143], v[200:203], a[124:127], v[128:143]
  ds_read_b64_tr_b16 v[192:193], v11 offset:2048
  v_mfma_f32_32x32x16_bf16 v[144:159], v[200:203], v[236:239], v[144:159]
  ds_read_b64_tr_b16 v[194:195], v11 offset:2560
  s_waitcnt lgkmcnt(6)
  v_mfma_f32_32x32x16_bf16 v[160:175], v[204:207], a[124:127], v[160:175]
  ds_read_b64_tr_b16 v[196:197], v12 offset:2048
  v_mfma_f32_32x32x16_bf16 v[176:191], v[204:207], v[236:239], v[176:191]
  ds_read_b64_tr_b16 v[198:199], v12 offset:2560
  s_waitcnt lgkmcnt(6)
  v_mfma_f32_32x32x16_bf16 v[128:143], v[208:211], a[128:131], v[128:143]
  ds_read_b64_tr_b16 v[200:201], v11 offset:4096
  v_mfma_f32_32x32x16_bf16 v[144:159], v[208:211], v[240:243], v[144:159]
  ds_read_b64_tr_b16 v[202:203], v11 offset:4608
  s_waitcnt lgkmcnt(6)
  v_mfma_f32_32x32x16_bf16 v[160:175], v[212:215], a[128:131], v[160:175]
  ds_read_b64_tr_b16 v[204:205], v12 offset:4096
  v_mfma_f32_32x32x16_bf16 v[176:191], v[212:215], v[240:243], v[176:191]
  ds_read_b64_tr_b16 v[206:207], v12 offset:4608
  s_waitcnt lgkmcnt(6)
  v_mfma_f32_32x32x16_bf16 v[128:143], v[192:195], a[132:135], v[128:143]
  ds_read_b64_tr_b16 v[208:209], v11 offset:6144
  v_mfma_f32_32x32x16_bf16 v[144:159], v[192:195], v[244:247], v[144:159]
  ds_read_b64_tr_b16 v[210:211], v11 offset:6656
  s_waitcnt lgkmcnt(6)
  v_mfma_f32_32x32x16_bf16 v[160:175], v[196:199], a[132:135], v[160:175]
  ds_read_b64_tr_b16 v[212:213], v12 offset:6144
  v_mfma_f32_32x32x16_bf16 v[176:191], v[196:199], v[244:247], v[176:191]
  ds_read_b64_tr_b16 v[214:215], v12 offset:6656
  s_waitcnt lgkmcnt(6)
  v_mfma_f32_32x32x16_bf16 v[128:143], v[200:203], a[136:139], v[128:143]
  v_mfma_f32_32x32x16_bf16 v[144:159], v[200:203], v[248:251], v[144:159]
  s_waitcnt lgkmcnt(4)
  v_mfma_f32_32x32x16_bf16 v[160:175], v[204:207], a[136:139], v[160:175]
  v_mfma_f32_32x32x16_bf16 v[176:191], v[204:207], v[248:251], v[176:191]
  s_waitcnt lgkmcnt(2)
  v_mfma_f32_32x32x16_bf16 v[128:143], v[208:211], a[140:143], v[128:143]
  v_mfma_f32_32x32x16_bf16 v[144:159], v[208:211], v[252:255], v[144:159]
  s_waitcnt lgkmcnt(0)
  v_mfma_f32_32x32x16_bf16 v[160:175], v[212:215], a[140:143], v[160:175]
  v_mfma_f32_32x32x16_bf16 v[176:191], v[212:215], v[252:255], v[176:191]
  s_cmp_eq_u32 s26, 2
  s_cbranch_scc1 L_epiG
  s_nop 7
  v_cvt_pk_bf16_f32 v64, v128, v129
  v_cvt_pk_bf16_f32 v65, v130, v131
  v_cvt_pk_bf16_f32 v66, v132, v133
  v_cvt_pk_bf16_f32 v67, v134, v135
  buffer_store_dwordx4 v[64:67], v13, s[8:11], s27 offen offset:0 sc1
  v_cvt_pk_bf16_f32 v68, v136, v137
  v_cvt_pk_bf16_f32 v69, v138, v139
  v_cvt_pk_bf16_f32 v70, v140, v141
  v_cvt_pk_bf16_f32 v71, v142, v143
  buffer_store_dwordx4 v[68:71], v13, s[8:11], s27 offen offset:512 sc1
  v_cvt_pk_bf16_f32 v72, v160, v161
  v_cvt_pk_bf16_f32 v73, v162, v163
  v_cvt_pk_bf16_f32 v74, v164, v165
  v_cvt_pk_bf16_f32 v75, v166, v167
  buffer_store_dwordx4 v[72:75], v13, s[8:11], s27 offen offset:1024 sc1
  v_cvt_pk_bf16_f32 v76, v168, v169
  v_cvt_pk_bf16_f32 v77, v170, v171
  v_cvt_pk_bf16_f32 v78, v172, v173
  v_cvt_pk_bf16_f32 v79, v174, v175
  buffer_store_dwordx4 v[76:79], v13, s[8:11], s27 offen offset:1536 sc1
  s_add_u32 s27, s27, 262144
  v_cvt_pk_bf16_f32 v80, v144, v145
  v_cvt_pk_bf16_f32 v81, v146, v147
  v_cvt_pk_bf16_f32 v82, v148, v149
  v_cvt_pk_bf16_f32 v83, v150, v151
  buffer_store_dwordx4 v[80:83], v13, s[8:11], s27 offen offset:0 sc1
  v_cvt_pk_bf16_f32 v84, v152, v153
  v_cvt_pk_bf16_f32 v85, v154, v155
  v_cvt_pk_bf16_f32 v86, v156, v157
  v_cvt_pk_bf16_f32 v87, v158, v159
  buffer_store_dwordx4 v[84:87], v13, s[8:11], s27 offen offset:512 sc1
  v_cvt_pk_bf16_f32 v88, v176, v177
  v_cvt_pk_bf16_f32 v89, v178, v179
  v_cvt_pk_bf16_f32 v90, v180, v181
  v_cvt_pk_bf16_f32 v91, v182, v183
  buffer_store_dwordx4 v[88:91], v13, s[8:11], s27 offen offset:1024 sc1
  v_cvt_pk_bf16_f32 v92, v184, v185
  v_cvt_pk_bf16_f32 v93, v186, v187
  v_cvt_pk_bf16_f32 v94, v188, v189
  v_cvt_pk_bf16_f32 v95, v190, v191
  buffer_store_dwordx4 v[92:95], v13, s[8:11], s27 offen offset:1536 sc1
  s_and_b32 s30, s27, 2048
  s_lshr_b32 s30, s30, 1
  s_sub_u32 s29, s27, s30
  s_add_u32 s29, s29, 4261150720
  s_cmp_ge_u32 s27, 50331648
  s_cselect_b32 s29, s29, 1879048192
  s_add_u32 s30, s29, 262144
  buffer_store_dwordx4 v[24:27], v15, s[8:11], s29 offen sc1
  buffer_store_dwordx4 v[24:27], v15, s[8:11], s30 offen sc1
  s_waitcnt vmcnt(10)
  s_branch L_epid
L_epiG:
  s_nop 7
  v_mul_f32 v128, v128, v160
  v_mul_f32 v129, v129, v161
  v_mul_f32 v130, v130, v162
  v_mul_f32 v131, v131, v163
  v_mul_f32 v132, v132, v164
  v_mul_f32 v133, v133, v165
  v_mul_f32 v134, v134, v166
  v_mul_f32 v135, v135, v167
  v_mul_f32 v136, v136, v168
  v_mul_f32 v137, v137, v169
  v_mul_f32 v138, v138, v170
  v_mul_f32 v139, v139, v171
  v_mul_f32 v140, v140, v172
  v_mul_f32 v141, v141, v173
  v_mul_f32 v142, v142, v174
  v_mul_f32 v143, v143, v175
  v_cvt_pk_bf16_f32 v64, v128, v129
  v_cvt_pk_bf16_f32 v65, v130, v131
  v_cvt_pk_bf16_f32 v66, v132, v133
  v_cvt_pk_bf16_f32 v67, v134, v135
  v_cvt_pk_bf16_f32 v68, v136, v137
  v_cvt_pk_bf16_f32 v69, v138, v139
  v_cvt_pk_bf16_f32 v70, v140, v141
  v_cvt_pk_bf16_f32 v71, v142, v143
  buffer_store_dwordx4 v[64:67], v15, s[8:11], s27 offen offset:0 sc1
  buffer_store_dwordx4 v[68:71], v15, s[8:11], s27 offen offset:1024 sc1
  v_mul_f32 v144, v144, v176
  v_mul_f32 v145, v145, v177
  v_mul_f32 v146, v146, v178
  v_mul_f32 v147, v147, v179
  v_mul_f32 v148, v148, v180
  v_mul_f32 v149, v149, v181
  v_mul_f32 v150, v150, v182
  v_mul_f32 v151, v151, v183
  v_mul_f32 v152, v152, v184
  v_mul_f32 v153, v153, v185
  v_mul_f32 v154, v154, v186
  v_mul_f32 v155, v155, v187
  v_mul_f32 v156, v156, v188
  v_mul_f32 v157, v157, v189
  v_mul_f32 v158, v158, v190
  v_mul_f32 v159, v159, v191
  v_cvt_pk_bf16_f32 v72, v144, v145
  v_cvt_pk_bf16_f32 v73, v146, v147
  v_cvt_pk_bf16_f32 v74, v148, v149
  v_cvt_pk_bf16_f32 v75, v150, v151
  v_cvt_pk_bf16_f32 v76, v152, v153
  v_cvt_pk_bf16_f32 v77, v154, v155
  v_cvt_pk_bf16_f32 v78, v156, v157
  v_cvt_pk_bf16_f32 v79, v158, v159
  s_add_u32 s27, s27, 294912
  buffer_store_dwordx4 v[72:75], v15, s[8:11], s27 offen offset:0 sc1
  buffer_store_dwordx4 v[76:79], v15, s[8:11], s27 offen offset:1024 sc1
  s_waitcnt vmcnt(4)
  s_branch L_epid
L_bodyV:
  ds_read_b64_tr_b16 v[192:193], v9 offset:0
  ds_read_b64_tr_b16 v[194:195], v9 offset:512
  ds_read_b64_tr_b16 v[196:197], v10 offset:0
  ds_read_b64_tr_b16 v[198:199], v10 offset:512
  ds_read_b64_tr_b16 v[200:201], v9 offset:2048
  ds_read_b64_tr_b16 v[202:203], v9 offset:2560
  ds_read_b64_tr_b16 v[204:205], v10 offset:2048
  ds_read_b64_tr_b16 v[206:207], v10 offset:2560
  s_waitcnt lgkmcnt(6)
  v_mfma_f32_32x32x16_bf16 v[128:143], a[0:3], v[192:195], 0
  ds_read_b64_tr_b16 v[208:209], v9 offset:4096
  s_cmp_eq_u32 s25, s69
  s_cselect_b32 s67, 0, s67
  s_add_u32 s58, s58, s67
  v_mfma_f32_32x32x16_bf16 v[144:159], a[144:147], v[192:195], 0
  ds_read_b64_tr_b16 v[210:211], v9 offset:4608
  s_sub_u32 s29, s58, 336
  s_cselect_b32 s58, s58, s29
  s_mov_b32 s67, s68
  s_waitcnt lgkmcnt(6)
  v_mfma_f32_32x32x16_bf16 v[160:175], a[0:3], v[196:199], 0
  ds_read_b64_tr_b16 v[212:213], v10 offset:4096
  s_mov_b32 s68, 28
  s_sub_u32 s60, 73728, s60
  s_lshl_b32 s29, s22, 10
  v_mfma_f32_32x32x16_bf16 v[176:191], a[144:147], v[196:199], 0
  ds_read_b64_tr_b16 v[214:215], v10 offset:4608
  s_add_u32 s29, s29, s60
  s_mov_b32 m0, s29
  s_lshr_b32 s30, s58, 6
  s_waitcnt lgkmcnt(6)
  v_mfma_f32_32x32x16_bf16 v[128:143], a[4:7], v[200:203], v[128:143]
  ds_read_b64_tr_b16 v[192:193], v9 offset:6144
  s_cmp_eq_u32 s30, 1
  s_cselect_b32 s28, 1, 0
  s_cselect_b64 s[36:37], s[46:47], s[44:45]
  v_mfma_f32_32x32x16_bf16 v[144:159], a[148:151], v[200:203], v[144:159]
  ds_read_b64_tr_b16 v[194:195], v9 offset:6656
  s_cselect_b32 s31, s62, s61
  s_cselect_b32 s32, 12, 11
  s_cmp_eq_u32 s30, 2
  s_waitcnt lgkmcnt(6)
  v_mfma_f32_32x32x16_bf16 v[160:175], a[4:7], v[204:207], v[160:175]
  ds_read_b64_tr_b16 v[196:197], v10 offset:6144
  s_cselect_b64 s[36:37], s[42:43], s[36:37]
  s_cselect_b32 s31, s63, s31
  s_and_b32 s30, s58, 63
  v_mfma_f32_32x32x16_bf16 v[176:191], a[148:151], v[204:207], v[176:191]
  ds_read_b64_tr_b16 v[198:199], v10 offset:6656
  s_lshr_b32 s59, s30, 1
  s_lshl_b32 s59, s59, 13
  s_add_u32 s59, s59, s31
  s_waitcnt lgkmcnt(6)
  v_mfma_f32_32x32x16_bf16 v[128:143], a[8:11], v[208:211], v[128:143]
  ds_read_b64_tr_b16 v[200:201], v9 offset:8192
  s_and_b32 s31, s58, 1
  s_lshl_b32 s31, s31, s32
  s_add_u32 s59, s59, s31
  v_mfma_f32_32x32x16_bf16 v[144:159], a[152:155], v[208:211], v[144:159]
  ds_read_b64_tr_b16 v[202:203], v9 offset:8704
  s_lshl_b32 s30, s30, 7
  s_sub_u32 s31, s58, 192
  s_lshl_b32 s32, s31, 11
  s_waitcnt lgkmcnt(6)
  v_mfma_f32_32x32x16_bf16 v[160:175], a[8:11], v[212:215], v[160:175]
  ds_read_b64_tr_b16 v[204:205], v10 offset:8192
  s_add_u32 s32, s32, s64
  s_lshl_b32 s31, s31, 6
  s_cmp_ge_u32 s58, 192
  v_mfma_f32_32x32x16_bf16 v[176:191], a[152:155], v[212:215], v[176:191]
  ds_read_b64_tr_b16 v[206:207], v10 offset:8704
  s_cselect_b32 s28, 2, s28
  s_cselect_b32 s59, s32, s59
  s_cselect_b32 s30, s31, s30
  s_waitcnt lgkmcnt(6)
  v_mfma_f32_32x32x16_bf16 v[128:143], a[12:15], v[192:195], v[128:143]
  ds_read_b64_tr_b16 v[208:209], v9 offset:10240
  s_cselect_b64 s[38:39], s[50:51], s[36:37]
  s_cselect_b64 s[36:37], s[48:49], s[36:37]
  s_cselect_b32 s31, s65, s66
  v_mfma_f32_32x32x16_bf16 v[144:159], a[156:159], v[192:195], v[144:159]
  ds_read_b64_tr_b16 v[210:211], v9 offset:10752
  s_cselect_b32 s32, 63, 127
  s_lshl_b32 s40, s31, 5
  s_cmp_eq_u32 s28, 1
  s_waitcnt lgkmcnt(6)
  v_mfma_f32_32x32x16_bf16 v[160:175], a[12:15], v[196:199], v[160:175]
  ds_read_b64_tr_b16 v[212:213], v10 offset:10240
  s_cselect_b64 s[56:57], -1, 0
  v_mfma_f32_32x32x16_bf16 v[176:191], a[156:159], v[196:199], v[176:191]
  ds_read_b64_tr_b16 v[214:215], v10 offset:10752
  v_mul_u32_u24 v18, s31, v2
  v_and_b32 v19, s32, v3
  s_waitcnt lgkmcnt(6)
  v_mfma_f32_32x32x16_bf16 v[128:143], a[16:19], v[200:203], v[128:143]
  ds_read_b64_tr_b16 v[192:193], v9 offset:12288
  v_add3_u32 v18, v18, v19, s30
  v_mov_b32 v19, s36
  v_mfma_f32_32x32x16_bf16 v[144:159], a[160:163], v[200:203], v[144:159]
  ds_read_b64_tr_b16 v[194:195], v9 offset:12800
  v_mov_b32 v20, s38
  v_cndmask_b32 v16, v19, v20, s[52:53]
  s_waitcnt lgkmcnt(6)
  v_mfma_f32_32x32x16_bf16 v[160:175], a[16:19], v[204:207], v[160:175]
  ds_read_b64_tr_b16 v[196:197], v10 offset:12288
  v_mov_b32 v19, s37
  v_mov_b32 v20, s39
  v_mfma_f32_32x32x16_bf16 v[176:191], a[160:163], v[204:207], v[176:191]
  ds_read_b64_tr_b16 v[198:199], v10 offset:12800
  v_cndmask_b32 v17, v19, v20, s[52:53]
  v_add_co_u32 v16, vcc, v16, v18
  s_waitcnt lgkmcnt(6)
  v_mfma_f32_32x32x16_bf16 v[128:143], a[20:23], v[208:211], v[128:143]
  ds_read_b64_tr_b16 v[200:201], v9 offset:14336
  v_cndmask_b32 v21, v5, v7, s[56:57]
  v_add_u32 v21, s60, v21
  v_mfma_f32_32x32x16_bf16 v[144:159], a[164:167], v[208:211], v[144:159]
  ds_read_b64_tr_b16 v[202:203], v9 offset:14848
  v_addc_co_u32 v17, vcc, 0, v17, vcc
  s_waitcnt lgkmcnt(6)
  v_mfma_f32_32x32x16_bf16 v[160:175], a[20:23], v[212:215], v[160:175]
  ds_read_b64_tr_b16 v[204:205], v10 offset:14336
  v_mfma_f32_32x32x16_bf16 v[176:191], a[164:167], v[212:215], v[176:191]
  ds_read_b64_tr_b16 v[206:207], v10 offset:14848
  s_waitcnt lgkmcnt(6)
  v_mfma_f32_32x32x16_bf16 v[128:143], a[24:27], v[192:195], v[128:143]
  ds_read_b64_tr_b16 v[208:209], v9 offset:16384
  v_mfma_f32_32x32x16_bf16 v[144:159], a[168:171], v[192:195], v[144:159]
  ds_read_b64_tr_b16 v[210:211], v9 offset:16896
  global_load_lds_dwordx4 v[16:17], off
  s_add_u32 m0, m0, 4096
  v_lshl_add_u64 v[16:17], v[16:17], 0, s[40:41]
  s_waitcnt lgkmcnt(6)
  v_mfma_f32_32x32x16_bf16 v[160:175], a[24:27], v[196:199], v[160:175]
  ds_read_b64_tr_b16 v[212:213], v10 offset:16384
  v_mfma_f32_32x32x16_bf16 v[176:191], a[168:171], v[196:199], v[176:191]
  ds_read_b64_tr_b16 v[214:215], v10 offset:16896
  s_waitcnt lgkmcnt(6)
  v_mfma_f32_32x32x16_bf16 v[128:143], a[28:31], v[200:203], v[128:143]
  ds_read_b64_tr_b16 v[192:193], v9 offset:18432
  v_mfma_f32_32x32x16_bf16 v[144:159], a[172:175], v[200:203], v[144:159]
  ds_read_b64_tr_b16 v[194:195], v9 offset:18944
  global_load_lds_dwordx4 v[16:17], off
  s_add_u32 m0, m0, 4096
  v_lshl_add_u64 v[16:17], v[16:17], 0, s[40:41]
  s_waitcnt lgkmcnt(6)
  v_mfma_f32_32x32x16_bf16 v[160:175], a[28:31], v[204:207], v[160:175]
  ds_read_b64_tr_b16 v[196:197], v10 offset:18432
  v_mfma_f32_32x32x16_bf16 v[176:191], a[172:175], v[204:207], v[176:191]
  ds_read_b64_tr_b16 v[198:199], v10 offset:18944
  s_waitcnt lgkmcnt(6)
  v_mfma_f32_32x32x16_bf16 v[128:143], a[32:35], v[208:211], v[128:143]
  ds_read_b64_tr_b16 v[200:201], v9 offset:20480
  v_mfma_f32_32x32x16_bf16 v[144:159], a[176:179], v[208:211], v[144:159]
  ds_read_b64_tr_b16 v[202:203], v9 offset:20992
  global_load_lds_dwordx4 v[16:17], off
  s_add_u32 m0, m0, 4096
  v_lshl_add_u64 v[16:17], v[16:17], 0, s[40:41]
  s_waitcnt lgkmcnt(6)
  v_mfma_f32_32x32x16_bf16 v[160:175], a[32:35], v[212:215], v[160:175]
  ds_read_b64_tr_b16 v[204:205], v10 offset:20480
  v_mfma_f32_32x32x16_bf16 v[176:191], a[176:179], v[212:215], v[176:191]
  ds_read_b64_tr_b16 v[206:207], v10 offset:20992
  s_waitcnt lgkmcnt(6)
  v_mfma_f32_32x32x16_bf16 v[128:143], a[36:39], v[192:195], v[128:143]
  ds_read_b64_tr_b16 v[208:209], v9 offset:22528
  v_mfma_f32_32x32x16_bf16 v[144:159], a[180:183], v[192:195], v[144:159]
  ds_read_b64_tr_b16 v[210:211], v9 offset:23040
  global_load_lds_dwordx4 v[16:17], off
  s_add_u32 m0, m0, 4096
  v_lshl_add_u64 v[16:17], v[16:17], 0, s[40:41]
  s_waitcnt lgkmcnt(6)
  v_mfma_f32_32x32x16_bf16 v[160:175], a[36:39], v[196:199], v[160:175]
  ds_read_b64_tr_b16 v[212:213], v10 offset:22528
  v_mfma_f32_32x32x16_bf16 v[176:191], a[180:183], v[196:199], v[176:191]
  ds_read_b64_tr_b16 v[214:215], v10 offset:23040
  s_waitcnt lgkmcnt(6)
  v_mfma_f32_32x32x16_bf16 v[128:143], a[40:43], v[200:203], v[128:143]
  ds_read_b64_tr_b16 v[192:193], v9 offset:24576
  v_mfma_f32_32x32x16_bf16 v[144:159], a[184:187], v[200:203], v[144:159]
  ds_read_b64_tr_b16 v[194:195], v9 offset:25088
  global_load_lds_dwordx4 v[16:17], off
  s_add_u32 m0, m0, 4096
  v_lshl_add_u64 v[16:17], v[16:17], 0, s[40:41]
  s_waitcnt lgkmcnt(6)
  v_mfma_f32_32x32x16_bf16 v[160:175], a[40:43], v[204:207], v[160:175]
  ds_read_b64_tr_b16 v[196:197], v10 offset:24576
  v_mfma_f32_32x32x16_bf16 v[176:191], a[184:187], v[204:207], v[176:191]
  ds_read_b64_tr_b16 v[198:199], v10 offset:25088
  s_waitcnt lgkmcnt(6)
  v_mfma_f32_32x32x16_bf16 v[128:143], a[44:47], v[208:211], v[128:143]
  ds_read_b64_tr_b16 v[200:201], v9 offset:26624
  v_mfma_f32_32x32x16_bf16 v[144:159], a[188:191], v[208:211], v[144:159]
  ds_read_b64_tr_b16 v[202:203], v9 offset:27136
  global_load_lds_dwordx4 v[16:17], off
  s_add_u32 m0, m0, 4096
  v_lshl_add_u64 v[16:17], v[16:17], 0, s[40:41]
  s_waitcnt lgkmcnt(6)
  v_mfma_f32_32x32x16_bf16 v[160:175], a[44:47], v[212:215], v[160:175]
  ds_read_b64_tr_b16 v[204:205], v10 offset:26624
  v_mfma_f32_32x32x16_bf16 v[176:191], a[188:191], v[212:215], v[176:191]
  ds_read_b64_tr_b16 v[206:207], v10 offset:27136
  s_waitcnt lgkmcnt(6)
  v_mfma_f32_32x32x16_bf16 v[128:143], a[48:51], v[192:195], v[128:143]
  ds_read_b64_tr_b16 v[208:209], v9 offset:28672
  v_mfma_f32_32x32x16_bf16 v[144:159], a[192:195], v[192:195], v[144:159]
  ds_read_b64_tr_b16 v[210:211], v9 offset:29184
  global_load_lds_dwordx4 v[16:17], off
  s_add_u32 m0, m0, 4096
  v_lshl_add_u64 v[16:17], v[16:17], 0, s[40:41]
  s_waitcnt lgkmcnt(6)
  v_mfma_f32_32x32x16_bf16 v[160:175], a[48:51], v[196:199], v[160:175]
  ds_read_b64_tr_b16 v[212:213], v10 offset:28672
  v_mfma_f32_32x32x16_bf16 v[176:191], a[192:195], v[196:199], v[176:191]
  ds_read_b64_tr_b16 v[214:215], v10 offset:29184
  s_waitcnt lgkmcnt(6)
  v_mfma_f32_32x32x16_bf16 v[128:143], a[52:55], v[200:203], v[128:143]
  ds_read_b64_tr_b16 v[192:193], v9 offset:30720
  v_mfma_f32_32x32x16_bf16 v[144:159], a[196:199], v[200:203], v[144:159]
  ds_read_b64_tr_b16 v[194:195], v9 offset:31232
  global_load_lds_dwordx4 v[16:17], off
  s_add_u32 m0, m0, 4096
  v_lshl_add_u64 v[16:17], v[16:17], 0, s[40:41]
  s_waitcnt lgkmcnt(6)
  v_mfma_f32_32x32x16_bf16 v[160:175], a[52:55], v[204:207], v[160:175]
  ds_read_b64_tr_b16 v[196:197], v10 offset:30720
  v_mfma_f32_32x32x16_bf16 v[176:191], a[196:199], v[204:207], v[176:191]
  ds_read_b64_tr_b16 v[198:199], v10 offset:31232
  s_waitcnt lgkmcnt(6)
  v_mfma_f32_32x32x16_bf16 v[128:143], a[56:59], v[208:211], v[128:143]
  ds_read_b64_tr_b16 v[200:201], v9 offset:32768
  v_mfma_f32_32x32x16_bf16 v[144:159], a[200:203], v[208:211], v[144:159]
  ds_read_b64_tr_b16 v[202:203], v9 offset:33280
  global_load_lds_dwordx4 v[16:17], off
  s_add_u32 m0, m0, 4096
  v_lshl_add_u64 v[16:17], v[16:17], 0, s[40:41]
  s_waitcnt lgkmcnt(6)
  v_mfma_f32_32x32x16_bf16 v[160:175], a[56:59], v[212:215], v[160:175]
  ds_read_b64_tr_b16 v[204:205], v10 offset:32768
  v_mfma_f32_32x32x16_bf16 v[176:191], a[200:203], v[212:215], v[176:191]
  ds_read_b64_tr_b16 v[206:207], v10 offset:33280
  s_waitcnt lgkmcnt(6)
  v_mfma_f32_32x32x16_bf16 v[128:143], a[60:63], v[192:195], v[128:143]
  ds_read_b64_tr_b16 v[208:209], v9 offset:34816
  v_mfma_f32_32x32x16_bf16 v[144:159], a[204:207], v[192:195], v[144:159]
  ds_read_b64_tr_b16 v[210:211], v9 offset:35328
  global_load_lds_dwordx4 v[16:17], off
  s_add_u32 m0, m0, 4096
  v_lshl_add_u64 v[16:17], v[16:17], 0, s[40:41]
  s_waitcnt lgkmcnt(6)
  v_mfma_f32_32x32x16_bf16 v[160:175], a[60:63], v[196:199], v[160:175]
  ds_read_b64_tr_b16 v[212:213], v10 offset:34816
  v_mfma_f32_32x32x16_bf16 v[176:191], a[204:207], v[196:199], v[176:191]
  ds_read_b64_tr_b16 v[214:215], v10 offset:35328
  s_waitcnt lgkmcnt(6)
  v_mfma_f32_32x32x16_bf16 v[128:143], a[64:67], v[200:203], v[128:143]
  ds_read_b64_tr_b16 v[192:193], v9 offset:36864
  v_mfma_f32_32x32x16_bf16 v[144:159], a[208:211], v[200:203], v[144:159]
  ds_read_b64_tr_b16 v[194:195], v9 offset:37376
  global_load_lds_dwordx4 v[16:17], off
  s_add_u32 m0, m0, 4096
  v_lshl_add_u64 v[16:17], v[16:17], 0, s[40:41]
  s_waitcnt lgkmcnt(6)
  v_mfma_f32_32x32x16_bf16 v[160:175], a[64:67], v[204:207], v[160:175]
  ds_read_b64_tr_b16 v[196:197], v10 offset:36864
  v_mfma_f32_32x32x16_bf16 v[176:191], a[208:211], v[204:207], v[176:191]
  ds_read_b64_tr_b16 v[198:199], v10 offset:37376
  s_waitcnt lgkmcnt(6)
  v_mfma_f32_32x32x16_bf16 v[128:143], a[68:71], v[208:211], v[128:143]
  ds_read_b64_tr_b16 v[200:201], v9 offset:38912
  v_mfma_f32_32x32x16_bf16 v[144:159], a[212:215], v[208:211], v[144:159]
  ds_read_b64_tr_b16 v[202:203], v9 offset:39424
  global_load_lds_dwordx4 v[16:17], off
  s_add_u32 m0, m0, 4096
  v_lshl_add_u64 v[16:17], v[16:17], 0, s[40:41]
  s_waitcnt lgkmcnt(6)
  v_mfma_f32_32x32x16_bf16 v[160:175], a[68:71], v[212:215], v[160:175]
  ds_read_b64_tr_b16 v[204:205], v10 offset:38912
  v_mfma_f32_32x32x16_bf16 v[176:191], a[212:215], v[212:215], v[176:191]
  ds_read_b64_tr_b16 v[206:207], v10 offset:39424
  s_waitcnt lgkmcnt(6)
  v_mfma_f32_32x32x16_bf16 v[128:143], a[72:75], v[192:195], v[128:143]
  ds_read_b64_tr_b16 v[208:209], v9 offset:40960
  v_mfma_f32_32x32x16_bf16 v[144:159], a[216:219], v[192:195], v[144:159]
  ds_read_b64_tr_b16 v[210:211], v9 offset:41472
  global_load_lds_dwordx4 v[16:17], off
  s_add_u32 m0, m0, 4096
  v_lshl_add_u64 v[16:17], v[16:17], 0, s[40:41]
  s_waitcnt lgkmcnt(6)
  v_mfma_f32_32x32x16_bf16 v[160:175], a[72:75], v[196:199], v[160:175]
  ds_read_b64_tr_b16 v[212:213], v10 offset:40960
  v_mfma_f32_32x32x16_bf16 v[176:191], a[216:219], v[196:199], v[176:191]
  ds_read_b64_tr_b16 v[214:215], v10 offset:41472
  s_waitcnt lgkmcnt(6)
  v_mfma_f32_32x32x16_bf16 v[128:143], a[76:79], v[200:203], v[128:143]
  ds_read_b64_tr_b16 v[192:193], v9 offset:43008
  v_mfma_f32_32x32x16_bf16 v[144:159], a[220:223], v[200:203], v[144:159]
  ds_read_b64_tr_b16 v[194:195], v9 offset:43520
  global_load_lds_dwordx4 v[16:17], off
  s_add_u32 m0, m0, 4096
  v_lshl_add_u64 v[16:17], v[16:17], 0, s[40:41]
  s_waitcnt lgkmcnt(6)
  v_mfma_f32_32x32x16_bf16 v[160:175], a[76:79], v[204:207], v[160:175]
  ds_read_b64_tr_b16 v[196:197], v10 offset:43008
  v_mfma_f32_32x32x16_bf16 v[176:191], a[220:223], v[204:207], v[176:191]
  ds_read_b64_tr_b16 v[198:199], v10 offset:43520
  s_waitcnt lgkmcnt(6)
  v_mfma_f32_32x32x16_bf16 v[128:143], a[80:83], v[208:211], v[128:143]
  ds_read_b64_tr_b16 v[200:201], v9 offset:45056
  v_mfma_f32_32x32x16_bf16 v[144:159], a[224:227], v[208:211], v[144:159]
  ds_read_b64_tr_b16 v[202:203], v9 offset:45568
  global_load_lds_dwordx4 v[16:17], off
  s_add_u32 m0, m0, 4096
  v_lshl_add_u64 v[16:17], v[16:17], 0, s[40:41]
  s_waitcnt lgkmcnt(6)
  v_mfma_f32_32x32x16_bf16 v[160:175], a[80:83], v[212:215], v[160:175]
  ds_read_b64_tr_b16 v[204:205], v10 offset:45056
  v_mfma_f32_32x32x16_bf16 v[176:191], a[224:227], v[212:215], v[176:191]
  ds_read_b64_tr_b16 v[206:207], v10 offset:45568
  s_waitcnt lgkmcnt(6)
  v_mfma_f32_32x32x16_bf16 v[128:143], a[84:87], v[192:195], v[128:143]
  ds_read_b64_tr_b16 v[208:209], v9 offset:47104
  v_mfma_f32_32x32x16_bf16 v[144:159], a[228:231], v[192:195], v[144:159]
  ds_read_b64_tr_b16 v[210:211], v9 offset:47616
  global_load_lds_dwordx4 v[16:17], off
  s_add_u32 m0, m0, 4096
  v_lshl_add_u64 v[16:17], v[16:17], 0, s[40:41]
  s_waitcnt lgkmcnt(6)
  v_mfma_f32_32x32x16_bf16 v[160:175], a[84:87], v[196:199], v[160:175]
  ds_read_b64_tr_b16 v[212:213], v10 offset:47104
  v_mfma_f32_32x32x16_bf16 v[176:191], a[228:231], v[196:199], v[176:191]
  ds_read_b64_tr_b16 v[214:215], v10 offset:47616
  s_waitcnt lgkmcnt(6)
  v_mfma_f32_32x32x16_bf16 v[128:143], a[88:91], v[200:203], v[128:143]
  ds_read_b64_tr_b16 v[192:193], v9 offset:49152
  v_mfma_f32_32x32x16_bf16 v[144:159], a[232:235], v[200:203], v[144:159]
  ds_read_b64_tr_b16 v[194:195], v9 offset:49664
  global_load_lds_dwordx4 v[16:17], off
  s_add_u32 m0, m0, 4096
  v_lshl_add_u64 v[16:17], v[16:17], 0, s[40:41]
  s_waitcnt lgkmcnt(6)
  v_mfma_f32_32x32x16_bf16 v[160:175], a[88:91], v[204:207], v[160:175]
  ds_read_b64_tr_b16 v[196:197], v10 offset:49152
  v_mfma_f32_32x32x16_bf16 v[176:191], a[232:235], v[204:207], v[176:191]
  ds_read_b64_tr_b16 v[198:199], v10 offset:49664
  s_waitcnt lgkmcnt(6)
  v_mfma_f32_32x32x16_bf16 v[128:143], a[92:95], v[208:211], v[128:143]
  ds_read_b64_tr_b16 v[200:201], v9 offset:51200
  v_mfma_f32_32x32x16_bf16 v[144:159], a[236:239], v[208:211], v[144:159]
  ds_read_b64_tr_b16 v[202:203], v9 offset:51712
  global_load_lds_dwordx4 v[16:17], off
  s_add_u32 m0, m0, 4096
  v_lshl_add_u64 v[16:17], v[16:17], 0, s[40:41]
  s_waitcnt lgkmcnt(6)
  v_mfma_f32_32x32x16_bf16 v[160:175], a[92:95], v[212:215], v[160:175]
  ds_read_b64_tr_b16 v[204:205], v10 offset:51200
  v_mfma_f32_32x32x16_bf16 v[176:191], a[236:239], v[212:215], v[176:191]
  ds_read_b64_tr_b16 v[206:207], v10 offset:51712
  s_waitcnt lgkmcnt(6)
  v_mfma_f32_32x32x16_bf16 v[128:143], a[96:99], v[192:195], v[128:143]
  ds_read_b64_tr_b16 v[208:209], v9 offset:53248
  v_mfma_f32_32x32x16_bf16 v[144:159], a[240:243], v[192:195], v[144:159]
  ds_read_b64_tr_b16 v[210:211], v9 offset:53760
  s_waitcnt lgkmcnt(6)
  v_mfma_f32_32x32x16_bf16 v[160:175], a[96:99], v[196:199], v[160:175]
  ds_read_b64_tr_b16 v[212:213], v10 offset:53248
  v_mfma_f32_32x32x16_bf16 v[176:191], a[240:243], v[196:199], v[176:191]
  ds_read_b64_tr_b16 v[214:215], v10 offset:53760
  s_waitcnt lgkmcnt(6)
  v_mfma_f32_32x32x16_bf16 v[128:143], a[100:103], v[200:203], v[128:143]
  ds_read_b64_tr_b16 v[192:193], v9 offset:55296
  v_mfma_f32_32x32x16_bf16 v[144:159], a[244:247], v[200:203], v[144:159]
  ds_read_b64_tr_b16 v[194:195], v9 offset:55808
  s_waitcnt lgkmcnt(6)
  v_mfma_f32_32x32x16_bf16 v[160:175], a[100:103], v[204:207], v[160:175]
  ds_read_b64_tr_b16 v[196:197], v10 offset:55296
  v_mfma_f32_32x32x16_bf16 v[176:191], a[244:247], v[204:207], v[176:191]
  ds_read_b64_tr_b16 v[198:199], v10 offset:55808
  s_waitcnt lgkmcnt(6)
  v_mfma_f32_32x32x16_bf16 v[128:143], a[104:107], v[208:211], v[128:143]
  ds_read_b64_tr_b16 v[200:201], v9 offset:57344
  v_mfma_f32_32x32x16_bf16 v[144:159], a[248:251], v[208:211], v[144:159]
  ds_read_b64_tr_b16 v[202:203], v9 offset:57856
  s_waitcnt lgkmcnt(6)
  v_mfma_f32_32x32x16_bf16 v[160:175], a[104:107], v[212:215], v[160:175]
  ds_read_b64_tr_b16 v[204:205], v10 offset:57344
  v_mfma_f32_32x32x16_bf16 v[176:191], a[248:251], v[212:215], v[176:191]
  ds_read_b64_tr_b16 v[206:207], v10 offset:57856
  s_waitcnt lgkmcnt(6)
  v_mfma_f32_32x32x16_bf16 v[128:143], a[108:111], v[192:195], v[128:143]
  ds_read_b64_tr_b16 v[208:209], v9 offset:59392
  v_mfma_f32_32x32x16_bf16 v[144:159], a[252:255], v[192:195], v[144:159]
  ds_read_b64_tr_b16 v[210:211], v9 offset:59904
  s_waitcnt lgkmcnt(6)
  v_mfma_f32_32x32x16_bf16 v[160:175], a[108:111], v[196:199], v[160:175]
  ds_read_b64_tr_b16 v[212:213], v10 offset:59392
  v_mfma_f32_32x32x16_bf16 v[176:191], a[252:255], v[196:199], v[176:191]
  ds_read_b64_tr_b16 v[214:215], v10 offset:59904
  s_waitcnt lgkmcnt(6)
  v_mfma_f32_32x32x16_bf16 v[128:143], a[112:115], v[200:203], v[128:143]
  ds_read_b64_tr_b16 v[192:193], v9 offset:61440
  v_mfma_f32_32x32x16_bf16 v[144:159], v[224:227], v[200:203], v[144:159]
  ds_read_b64_tr_b16 v[194:195], v9 offset:61952
  s_waitcnt lgkmcnt(6)
  v_mfma_f32_32x32x16_bf16 v[160:175], a[112:115], v[204:207], v[160:175]
  ds_read_b64_tr_b16 v[196:197], v10 offset:61440
  v_mfma_f32_32x32x16_bf16 v[176:191], v[224:227], v[204:207], v[176:191]
  ds_read_b64_tr_b16 v[198:199], v10 offset:61952
  s_waitcnt lgkmcnt(6)
  v_mfma_f32_32x32x16_bf16 v[128:143], a[116:119], v[208:211], v[128:143]
  ds_read_b64_tr_b16 v[200:201], v9 offset:63488
  v_mfma_f32_32x32x16_bf16 v[144:159], v[228:231], v[208:211], v[144:159]
  ds_read_b64_tr_b16 v[202:203], v9 offset:64000
  s_waitcnt lgkmcnt(6)
  v_mfma_f32_32x32x16_bf16 v[160:175], a[116:119], v[212:215], v[160:175]
  ds_read_b64_tr_b16 v[204:205], v10 offset:63488
  v_mfma_f32_32x32x16_bf16 v[176:191], v[228:231], v[212:215], v[176:191]
  ds_read_b64_tr_b16 v[206:207], v10 offset:64000
  s_waitcnt lgkmcnt(6)
  v_mfma_f32_32x32x16_bf16 v[128:143], a[120:123], v[192:195], v[128:143]
  ds_read_b64_tr_b16 v[208:209], v11 offset:0
  v_mfma_f32_32x32x16_bf16 v[144:159], v[232:235], v[192:195], v[144:159]
  ds_read_b64_tr_b16 v[210:211], v11 offset:512
  s_waitcnt lgkmcnt(6)
  v_mfma_f32_32x32x16_bf16 v[160:175], a[120:123], v[196:199], v[160:175]
  ds_read_b64_tr_b16 v[212:213], v12 offset:0
  v_mfma_f32_32x32x16_bf16 v[176:191], v[232:235], v[196:199], v[176:191]
  ds_read_b64_tr_b16 v[214:215], v12 offset:512
  s_waitcnt lgkmcnt(6)
  v_mfma_f32_32x32x16_bf16 v[128:143], a[124:127], v[200:203], v[128:143]
  ds_read_b64_tr_b16 v[192:193], v11 offset:2048
  v_mfma_f32_32x32x16_bf16 v[144:159], v[236:239], v[200:203], v[144:159]
  ds_read_b64_tr_b16 v[194:195], v11 offset:2560
  s_waitcnt lgkmcnt(6)
  v_mfma_f32_32x32x16_bf16 v[160:175], a[124:127], v[204:207], v[160:175]
  ds_read_b64_tr_b16 v[196:197], v12 offset:2048
  v_mfma_f32_32x32x16_bf16 v[176:191], v[236:239], v[204:207], v[176:191]
  ds_read_b64_tr_b16 v[198:199], v12 offset:2560
  s_waitcnt lgkmcnt(6)
  v_mfma_f32_32x32x16_bf16 v[128:143], a[128:131], v[208:211], v[128:143]
  ds_read_b64_tr_b16 v[200:201], v11 offset:4096
  v_mfma_f32_32x32x16_bf16 v[144:159], v[240:243], v[208:211], v[144:159]
  ds_read_b64_tr_b16 v[202:203], v11 offset:4608
  s_waitcnt lgkmcnt(6)
  v_mfma_f32_32x32x16_bf16 v[160:175], a[128:131], v[212:215], v[160:175]
  ds_read_b64_tr_b16 v[204:205], v12 offset:4096
  v_mfma_f32_32x32x16_bf16 v[176:191], v[240:243], v[212:215], v[176:191]
  ds_read_b64_tr_b16 v[206:207], v12 offset:4608
  s_waitcnt lgkmcnt(6)
  v_mfma_f32_32x32x16_bf16 v[128:143], a[132:135], v[192:195], v[128:143]
  ds_read_b64_tr_b16 v[208:209], v11 offset:6144
  v_mfma_f32_32x32x16_bf16 v[144:159], v[244:247], v[192:195], v[144:159]
  ds_read_b64_tr_b16 v[210:211], v11 offset:6656
  s_waitcnt lgkmcnt(6)
  v_mfma_f32_32x32x16_bf16 v[160:175], a[132:135], v[196:199], v[160:175]
  ds_read_b64_tr_b16 v[212:213], v12 offset:6144
  v_mfma_f32_32x32x16_bf16 v[176:191], v[244:247], v[196:199], v[176:191]
  ds_read_b64_tr_b16 v[214:215], v12 offset:6656
  s_waitcnt lgkmcnt(6)
  v_mfma_f32_32x32x16_bf16 v[128:143], a[136:139], v[200:203], v[128:143]
  v_mfma_f32_32x32x16_bf16 v[144:159], v[248:251], v[200:203], v[144:159]
  s_waitcnt lgkmcnt(4)
  v_mfma_f32_32x32x16_bf16 v[160:175], a[136:139], v[204:207], v[160:175]
  v_mfma_f32_32x32x16_bf16 v[176:191], v[248:251], v[204:207], v[176:191]
  s_waitcnt lgkmcnt(2)
  v_mfma_f32_32x32x16_bf16 v[128:143], a[140:143], v[208:211], v[128:143]
  v_mfma_f32_32x32x16_bf16 v[144:159], v[252:255], v[208:211], v[144:159]
  s_waitcnt lgkmcnt(0)
  v_mfma_f32_32x32x16_bf16 v[160:175], a[140:143], v[212:215], v[160:175]
  v_mfma_f32_32x32x16_bf16 v[176:191], v[252:255], v[212:215], v[176:191]
  v_cvt_pk_bf16_f32 v64, v128, v129
  v_cvt_pk_bf16_f32 v65, v130, v131
  v_cvt_pk_bf16_f32 v66, v136, v137
  v_cvt_pk_bf16_f32 v67, v138, v139
  buffer_store_dwordx4 v[64:67], v14, s[8:11], s27 offen offset:0 sc1
  v_cvt_pk_bf16_f32 v68, v132, v133
  v_cvt_pk_bf16_f32 v69, v134, v135
  v_cvt_pk_bf16_f32 v70, v140, v141
  v_cvt_pk_bf16_f32 v71, v142, v143
  buffer_store_dwordx4 v[68:71], v14, s[8:11], s27 offen offset:512 sc1
  v_cvt_pk_bf16_f32 v72, v160, v161
  v_cvt_pk_bf16_f32 v73, v162, v163
  v_cvt_pk_bf16_f32 v74, v168, v169
  v_cvt_pk_bf16_f32 v75, v170, v171
  buffer_store_dwordx4 v[72:75], v14, s[8:11], s27 offen offset:2048 sc1
  v_cvt_pk_bf16_f32 v76, v164, v165
  v_cvt_pk_bf16_f32 v77, v166, v167
  v_cvt_pk_bf16_f32 v78, v172, v173
  v_cvt_pk_bf16_f32 v79, v174, v175
  buffer_store_dwordx4 v[76:79], v14, s[8:11], s27 offen offset:2560 sc1
  s_add_u32 s27, s27, 262144
  v_cvt_pk_bf16_f32 v80, v144, v145
  v_cvt_pk_bf16_f32 v81, v146, v147
  v_cvt_pk_bf16_f32 v82, v152, v153
  v_cvt_pk_bf16_f32 v83, v154, v155
  buffer_store_dwordx4 v[80:83], v14, s[8:11], s27 offen offset:0 sc1
  v_cvt_pk_bf16_f32 v84, v148, v149
  v_cvt_pk_bf16_f32 v85, v150, v151
  v_cvt_pk_bf16_f32 v86, v156, v157
  v_cvt_pk_bf16_f32 v87, v158, v159
  buffer_store_dwordx4 v[84:87], v14, s[8:11], s27 offen offset:512 sc1
  v_cvt_pk_bf16_f32 v88, v176, v177
  v_cvt_pk_bf16_f32 v89, v178, v179
  v_cvt_pk_bf16_f32 v90, v184, v185
  v_cvt_pk_bf16_f32 v91, v186, v187
  buffer_store_dwordx4 v[88:91], v14, s[8:11], s27 offen offset:2048 sc1
  v_cvt_pk_bf16_f32 v92, v180, v181
  v_cvt_pk_bf16_f32 v93, v182, v183
  v_cvt_pk_bf16_f32 v94, v188, v189
  v_cvt_pk_bf16_f32 v95, v190, v191
  buffer_store_dwordx4 v[92:95], v14, s[8:11], s27 offen offset:2560 sc1
  s_add_u32 s29, s27, 66846720
  s_add_u32 s30, s29, 262144
  buffer_store_dwordx4 v[24:27], v15, s[8:11], s29 offen offset:0 sc1
  buffer_store_dwordx4 v[24:27], v15, s[8:11], s29 offen offset:2048 sc1
  buffer_store_dwordx4 v[24:27], v15, s[8:11], s30 offen offset:0 sc1
  buffer_store_dwordx4 v[24:27], v15, s[8:11], s30 offen offset:2048 sc1
  s_waitcnt vmcnt(12)
L_epid:
  s_cmp_lg_u32 s25, s70
  s_cbranch_scc1 L_nokv
  s_waitcnt vmcnt(0)
  s_barrier
  s_cmp_lg_u32 s22, 0
  s_cbranch_scc1 L_arr1
  s_lshl_b32 s29, s23, 2
  v_mov_b32 v18, 1
  s_mov_b64 exec, 1
  buffer_atomic_add v18, off, s[16:19], s29 offset:64
  s_mov_b64 exec, -1
    L_arr1:
  s_branch L_kvd
    L_nokv:
  s_barrier
    L_kvd:
  s_add_u32 s25, s25, 1
  s_cmp_le_u32 s25, s69
  s_cbranch_scc1 L_g1loop
  s_cmp_lg_u32 s23, s71
  s_cbranch_scc1 L_runB
  s_cmp_lg_u32 s24, 0
  s_cbranch_scc1 L_nogate
  s_load_dwordx2 s[54:55], s[0:1], 88
  s_waitcnt lgkmcnt(0)
  s_mov_b32 s12, s54
  s_and_b32 s13, s55, 0xffff
  s_mov_b32 s14, 1152
  s_mov_b32 s15, 0x20000
  v_lshrrev_b32 v18, 5, v1
  v_lshlrev_b32 v18, 4, v18
  buffer_load_dwordx4 v[64:67], v18, s[12:15], 0 offen offset:0
  buffer_load_dwordx4 v[68:71], v18, s[12:15], 0 offen offset:32
  buffer_load_dwordx4 v[72:75], v18, s[12:15], 0 offen offset:64
  buffer_load_dwordx4 v[76:79], v18, s[12:15], 0 offen offset:96
  buffer_load_dwordx4 v[80:83], v18, s[12:15], 0 offen offset:128
  buffer_load_dwordx4 v[84:87], v18, s[12:15], 0 offen offset:160
  buffer_load_dwordx4 v[88:91], v18, s[12:15], 0 offen offset:192
  buffer_load_dwordx4 v[92:95], v18, s[12:15], 0 offen offset:224
  buffer_load_dwordx4 v[96:99], v18, s[12:15], 0 offen offset:256
  buffer_load_dwordx4 v[100:103], v18, s[12:15], 0 offen offset:288
  buffer_load_dwordx4 v[104:107], v18, s[12:15], 0 offen offset:320
  buffer_load_dwordx4 v[108:111], v18, s[12:15], 0 offen offset:352
  s_waitcnt vmcnt(0)
  v_mfma_f32_32x32x16_bf16 v[128:143], v[64:67], a[0:3], 0
  v_mfma_f32_32x32x16_bf16 v[144:159], v[64:67], a[144:147], 0
  v_mfma_f32_32x32x16_bf16 v[128:143], v[68:71], a[4:7], v[128:143]
  v_mfma_f32_32x32x16_bf16 v[144:159], v[68:71], a[148:151], v[144:159]
  v_mfma_f32_32x32x16_bf16 v[128:143], v[72:75], a[8:11], v[128:143]
  v_mfma_f32_32x32x16_bf16 v[144:159], v[72:75], a[152:155], v[144:159]
  v_mfma_f32_32x32x16_bf16 v[128:143], v[76:79], a[12:15], v[128:143]
  v_mfma_f32_32x32x16_bf16 v[144:159], v[76:79], a[156:159], v[144:159]
  v_mfma_f32_32x32x16_bf16 v[128:143], v[80:83], a[16:19], v[128:143]
  v_mfma_f32_32x32x16_bf16 v[144:159], v[80:83], a[160:163], v[144:159]
  v_mfma_f32_32x32x16_bf16 v[128:143], v[84:87], a[20:23], v[128:143]
  v_mfma_f32_32x32x16_bf16 v[144:159], v[84:87], a[164:167], v[144:159]
  v_mfma_f32_32x32x16_bf16 v[128:143], v[88:91], a[24:27], v[128:143]
  v_mfma_f32_32x32x16_bf16 v[144:159], v[88:91], a[168:171], v[144:159]
  v_mfma_f32_32x32x16_bf16 v[128:143], v[92:95], a[28:31], v[128:143]
  v_mfma_f32_32x32x16_bf16 v[144:159], v[92:95], a[172:175], v[144:159]
  v_mfma_f32_32x32x16_bf16 v[128:143], v[96:99], a[32:35], v[128:143]
  v_mfma_f32_32x32x16_bf16 v[144:159], v[96:99], a[176:179], v[144:159]
  v_mfma_f32_32x32x16_bf16 v[128:143], v[100:103], a[36:39], v[128:143]
  v_mfma_f32_32x32x16_bf16 v[144:159], v[100:103], a[180:183], v[144:159]
  v_mfma_f32_32x32x16_bf16 v[128:143], v[104:107], a[40:43], v[128:143]
  v_mfma_f32_32x32x16_bf16 v[144:159], v[104:107], a[184:187], v[144:159]
  v_mfma_f32_32x32x16_bf16 v[128:143], v[108:111], a[44:47], v[128:143]
  v_mfma_f32_32x32x16_bf16 v[144:159], v[108:111], a[188:191], v[144:159]
  buffer_load_dwordx4 v[64:67], v18, s[12:15], 0 offen offset:384
  buffer_load_dwordx4 v[68:71], v18, s[12:15], 0 offen offset:416
  buffer_load_dwordx4 v[72:75], v18, s[12:15], 0 offen offset:448
  buffer_load_dwordx4 v[76:79], v18, s[12:15], 0 offen offset:480
  buffer_load_dwordx4 v[80:83], v18, s[12:15], 0 offen offset:512
  buffer_load_dwordx4 v[84:87], v18, s[12:15], 0 offen offset:544
  buffer_load_dwordx4 v[88:91], v18, s[12:15], 0 offen offset:576
  buffer_load_dwordx4 v[92:95], v18, s[12:15], 0 offen offset:608
  buffer_load_dwordx4 v[96:99], v18, s[12:15], 0 offen offset:640
  buffer_load_dwordx4 v[100:103], v18, s[12:15], 0 offen offset:672
  buffer_load_dwordx4 v[104:107], v18, s[12:15], 0 offen offset:704
  buffer_load_dwordx4 v[108:111], v18, s[12:15], 0 offen offset:736
  s_waitcnt vmcnt(0)
  v_mfma_f32_32x32x16_bf16 v[128:143], v[64:67], a[48:51], v[128:143]
  v_mfma_f32_32x32x16_bf16 v[144:159], v[64:67], a[192:195], v[144:159]
  v_mfma_f32_32x32x16_bf16 v[128:143], v[68:71], a[52:55], v[128:143]
  v_mfma_f32_32x32x16_bf16 v[144:159], v[68:71], a[196:199], v[144:159]
  v_mfma_f32_32x32x16_bf16 v[128:143], v[72:75], a[56:59], v[128:143]
  v_mfma_f32_32x32x16_bf16 v[144:159], v[72:75], a[200:203], v[144:159]
  v_mfma_f32_32x32x16_bf16 v[128:143], v[76:79], a[60:63], v[128:143]
  v_mfma_f32_32x32x16_bf16 v[144:159], v[76:79], a[204:207], v[144:159]
  v_mfma_f32_32x32x16_bf16 v[128:143], v[80:83], a[64:67], v[128:143]
  v_mfma_f32_32x32x16_bf16 v[144:159], v[80:83], a[208:211], v[144:159]
  v_mfma_f32_32x32x16_bf16 v[128:143], v[84:87], a[68:71], v[128:143]
  v_mfma_f32_32x32x16_bf16 v[144:159], v[84:87], a[212:215], v[144:159]
  v_mfma_f32_32x32x16_bf16 v[128:143], v[88:91], a[72:75], v[128:143]
  v_mfma_f32_32x32x16_bf16 v[144:159], v[88:91], a[216:219], v[144:159]
  v_mfma_f32_32x32x16_bf16 v[128:143], v[92:95], a[76:79], v[128:143]
  v_mfma_f32_32x32x16_bf16 v[144:159], v[92:95], a[220:223], v[144:159]
  v_mfma_f32_32x32x16_bf16 v[128:143], v[96:99], a[80:83], v[128:143]
  v_mfma_f32_32x32x16_bf16 v[144:159], v[96:99], a[224:227], v[144:159]
  v_mfma_f32_32x32x16_bf16 v[128:143], v[100:103], a[84:87], v[128:143]
  v_mfma_f32_32x32x16_bf16 v[144:159], v[100:103], a[228:231], v[144:159]
  v_mfma_f32_32x32x16_bf16 v[128:143], v[104:107], a[88:91], v[128:143]
  v_mfma_f32_32x32x16_bf16 v[144:159], v[104:107], a[232:235], v[144:159]
  v_mfma_f32_32x32x16_bf16 v[128:143], v[108:111], a[92:95], v[128:143]
  v_mfma_f32_32x32x16_bf16 v[144:159], v[108:111], a[236:239], v[144:159]
  buffer_load_dwordx4 v[64:67], v18, s[12:15], 0 offen offset:768
  buffer_load_dwordx4 v[68:71], v18, s[12:15], 0 offen offset:800
  buffer_load_dwordx4 v[72:75], v18, s[12:15], 0 offen offset:832
  buffer_load_dwordx4 v[76:79], v18, s[12:15], 0 offen offset:864
  buffer_load_dwordx4 v[80:83], v18, s[12:15], 0 offen offset:896
  buffer_load_dwordx4 v[84:87], v18, s[12:15], 0 offen offset:928
  buffer_load_dwordx4 v[88:91], v18, s[12:15], 0 offen offset:960
  buffer_load_dwordx4 v[92:95], v18, s[12:15], 0 offen offset:992
  buffer_load_dwordx4 v[96:99], v18, s[12:15], 0 offen offset:1024
  buffer_load_dwordx4 v[100:103], v18, s[12:15], 0 offen offset:1056
  buffer_load_dwordx4 v[104:107], v18, s[12:15], 0 offen offset:1088
  buffer_load_dwordx4 v[108:111], v18, s[12:15], 0 offen offset:1120
  s_waitcnt vmcnt(0)
  v_mfma_f32_32x32x16_bf16 v[128:143], v[64:67], a[96:99], v[128:143]
  v_mfma_f32_32x32x16_bf16 v[144:159], v[64:67], a[240:243], v[144:159]
  v_mfma_f32_32x32x16_bf16 v[128:143], v[68:71], a[100:103], v[128:143]
  v_mfma_f32_32x32x16_bf16 v[144:159], v[68:71], a[244:247], v[144:159]
  v_mfma_f32_32x32x16_bf16 v[128:143], v[72:75], a[104:107], v[128:143]
  v_mfma_f32_32x32x16_bf16 v[144:159], v[72:75], a[248:251], v[144:159]
  v_mfma_f32_32x32x16_bf16 v[128:143], v[76:79], a[108:111], v[128:143]
  v_mfma_f32_32x32x16_bf16 v[144:159], v[76:79], a[252:255], v[144:159]
  v_mfma_f32_32x32x16_bf16 v[128:143], v[80:83], a[112:115], v[128:143]
  v_mfma_f32_32x32x16_bf16 v[144:159], v[80:83], v[224:227], v[144:159]
  v_mfma_f32_32x32x16_bf16 v[128:143], v[84:87], a[116:119], v[128:143]
  v_mfma_f32_32x32x16_bf16 v[144:159], v[84:87], v[228:231], v[144:159]
  v_mfma_f32_32x32x16_bf16 v[128:143], v[88:91], a[120:123], v[128:143]
  v_mfma_f32_32x32x16_bf16 v[144:159], v[88:91], v[232:235], v[144:159]
  v_mfma_f32_32x32x16_bf16 v[128:143], v[92:95], a[124:127], v[128:143]
  v_mfma_f32_32x32x16_bf16 v[144:159], v[92:95], v[236:239], v[144:159]
  v_mfma_f32_32x32x16_bf16 v[128:143], v[96:99], a[128:131], v[128:143]
  v_mfma_f32_32x32x16_bf16 v[144:159], v[96:99], v[240:243], v[144:159]
  v_mfma_f32_32x32x16_bf16 v[128:143], v[100:103], a[132:135], v[128:143]
  v_mfma_f32_32x32x16_bf16 v[144:159], v[100:103], v[244:247], v[144:159]
  v_mfma_f32_32x32x16_bf16 v[128:143], v[104:107], a[136:139], v[128:143]
  v_mfma_f32_32x32x16_bf16 v[144:159], v[104:107], v[248:251], v[144:159]
  v_mfma_f32_32x32x16_bf16 v[128:143], v[108:111], a[140:143], v[128:143]
  v_mfma_f32_32x32x16_bf16 v[144:159], v[108:111], v[252:255], v[144:159]
  v_and_b32 v18, 31, v1
  v_lshlrev_b32 v18, 2, v18
  s_lshl_b32 s29, s35, 7
  s_add_u32 s29, s29, 1441792
  s_mov_b32 s30, 0xbfb8aa3b
  v_mul_f32 v128, s30, v128
  v_exp_f32 v128, v128
  s_nop 0
  v_add_f32 v128, 1.0, v128
  v_rcp_f32 v128, v128
  s_nop 0
  buffer_store_dword v128, v18, s[8:11], s29 offen offset:0 sc1
  v_mul_f32 v144, s30, v144
  v_exp_f32 v144, v144
  s_nop 0
  v_add_f32 v144, 1.0, v144
  v_rcp_f32 v144, v144
  s_nop 0
  buffer_store_dword v144, v18, s[8:11], s29 offen offset:128 sc1
L_nogate:
  s_waitcnt vmcnt(0)
  s_barrier
  s_cmp_lg_u32 s22, 0
  s_cbranch_scc1 L_arr2
  s_lshl_b32 s29, s23, 2
  v_mov_b32 v18, 1
  s_mov_b64 exec, 1
  buffer_atomic_add v18, off, s[16:19], s29 offset:96
  s_mov_b64 exec, -1
    L_arr2:
  s_cmp_ge_u32 s21, 18
  s_cbranch_scc1 L_attn
  s_load_dwordx2 s[54:55], s[0:1], 96
  v_lshrrev_b32 v20, 2, v1
  v_mul_u32_u24 v20, 1152, v20
  v_and_b32 v21, 3, v1
  v_lshl_add_u32 v2, v21, 4, v20
  v_lshlrev_b32 v4, 4, v1
  v_lshrrev_b32 v22, 5, v1
  v_bfe_u32 v23, v1, 2, 2
  v_lshl_add_u32 v23, v22, 3, v23
  v_lshlrev_b32 v23, 6, v23
  v_bfe_u32 v24, v1, 4, 1
  v_lshlrev_b32 v24, 2, v24
  v_and_b32 v25, 1, v1
  v_lshl_add_u32 v24, v25, 1, v24
  v_bfe_u32 v25, v1, 1, 1
  v_add_u32 v24, v24, v25
  v_lshl_add_u32 v23, v24, 3, v23
  s_mul_i32 s29, s22, 24576
  v_add_u32 v3, s29, v23
  s_lshl_b32 s29, s22, 12
  v_add_u32 v5, s29, v4
  s_lshl_b32 s29, s22, 10
  v_add_u32 v6, s29, v4
  v_and_b32 v20, 31, v1
  v_lshlrev_b32 v7, 2, v20
  v_mul_u32_u24 v20, 1152, v20
  v_lshl_add_u32 v20, v22, 4, v20
  s_lshr_b32 s29, s22, 1
  s_lshl_b32 s29, s29, 5
  s_and_b32 s30, s22, 1
  s_lshl_b32 s30, s30, 3
  s_add_u32 s29, s29, s30
  s_lshl_b32 s30, s21, 6
  s_add_u32 s29, s29, s30
  v_add_u32 v8, s29, v20
  s_waitcnt lgkmcnt(0)
  s_mov_b32 s76, s54
  s_and_b32 s77, s55, 0xffff
  s_mov_b32 s78, 2359296
  s_mov_b32 s79, 0x20000
  s_load_dwordx2 s[54:55], s[0:1], 80
  s_waitcnt lgkmcnt(0)
  s_mov_b32 s12, s54
  s_and_b32 s13, s55, 0xffff
  s_mov_b32 s14, 5308416
  s_mov_b32 s15, 0x20000
  s_mul_i32 s29, s22, 1327104
  s_lshl_b32 s30, s21, 6
  s_add_u32 s29, s29, s30
  s_mul_i32 s30, s22, 24576
  s_mov_b32 m0, s30
  s_nop 0
  buffer_load_dwordx4 v2, s[12:15], s29 offen lds
  s_add_u32 m0, m0, 1024
  s_add_u32 s29, s29, 18432
  buffer_load_dwordx4 v2, s[12:15], s29 offen lds
  s_add_u32 m0, m0, 1024
  s_add_u32 s29, s29, 18432
  buffer_load_dwordx4 v2, s[12:15], s29 offen lds
  s_add_u32 m0, m0, 1024
  s_add_u32 s29, s29, 18432
  buffer_load_dwordx4 v2, s[12:15], s29 offen lds
  s_add_u32 m0, m0, 1024
  s_add_u32 s29, s29, 18432
  buffer_load_dwordx4 v2, s[12:15], s29 offen lds
  s_add_u32 m0, m0, 1024
  s_add_u32 s29, s29, 18432
  buffer_load_dwordx4 v2, s[12:15], s29 offen lds
  s_add_u32 m0, m0, 1024
  s_add_u32 s29, s29, 18432
  buffer_load_dwordx4 v2, s[12:15], s29 offen lds
  s_add_u32 m0, m0, 1024
  s_add_u32 s29, s29, 18432
  buffer_load_dwordx4 v2, s[12:15], s29 offen lds
  s_add_u32 m0, m0, 1024
  s_add_u32 s29, s29, 18432
  buffer_load_dwordx4 v2, s[12:15], s29 offen lds
  s_add_u32 m0, m0, 1024
  s_add_u32 s29, s29, 18432
  buffer_load_dwordx4 v2, s[12:15], s29 offen lds
  s_add_u32 m0, m0, 1024
  s_add_u32 s29, s29, 18432
  buffer_load_dwordx4 v2, s[12:15], s29 offen lds
  s_add_u32 m0, m0, 1024
  s_add_u32 s29, s29, 18432
  buffer_load_dwordx4 v2, s[12:15], s29 offen lds
  s_add_u32 m0, m0, 1024
  s_add_u32 s29, s29, 18432
  buffer_load_dwordx4 v2, s[12:15], s29 offen lds
  s_add_u32 m0, m0, 1024
  s_add_u32 s29, s29, 18432
  buffer_load_dwordx4 v2, s[12:15], s29 offen lds
  s_add_u32 m0, m0, 1024
  s_add_u32 s29, s29, 18432
  buffer_load_dwordx4 v2, s[12:15], s29 offen lds
  s_add_u32 m0, m0, 1024
  s_add_u32 s29, s29, 18432
  buffer_load_dwordx4 v2, s[12:15], s29 offen lds
  s_add_u32 m0, m0, 1024
  s_add_u32 s29, s29, 18432
  buffer_load_dwordx4 v2, s[12:15], s29 offen lds
  s_add_u32 m0, m0, 1024
  s_add_u32 s29, s29, 18432
  buffer_load_dwordx4 v2, s[12:15], s29 offen lds
  s_add_u32 m0, m0, 1024
  s_add_u32 s29, s29, 18432
  buffer_load_dwordx4 v2, s[12:15], s29 offen lds
  s_add_u32 m0, m0, 1024
  s_add_u32 s29, s29, 18432
  buffer_load_dwordx4 v2, s[12:15], s29 offen lds
  s_add_u32 m0, m0, 1024
  s_add_u32 s29, s29, 18432
  buffer_load_dwordx4 v2, s[12:15], s29 offen lds
  s_add_u32 m0, m0, 1024
  s_add_u32 s29, s29, 18432
  buffer_load_dwordx4 v2, s[12:15], s29 offen lds
  s_add_u32 m0, m0, 1024
  s_add_u32 s29, s29, 18432
  buffer_load_dwordx4 v2, s[12:15], s29 offen lds
  s_add_u32 m0, m0, 1024
  s_add_u32 s29, s29, 18432
  buffer_load_dwordx4 v2, s[12:15], s29 offen lds
  s_add_u32 m0, m0, 1024
  s_add_u32 s29, s29, 18432
  s_waitcnt vmcnt(0)
  ds_read_b64_tr_b16 a[0:1], v3 offset:0
  ds_read_b64_tr_b16 a[2:3], v3 offset:256
  ds_read_b64_tr_b16 a[4:5], v3 offset:1024
  ds_read_b64_tr_b16 a[6:7], v3 offset:1280
  ds_read_b64_tr_b16 a[8:9], v3 offset:2048
  ds_read_b64_tr_b16 a[10:11], v3 offset:2304
  ds_read_b64_tr_b16 a[12:13], v3 offset:3072
  ds_read_b64_tr_b16 a[14:15], v3 offset:3328
  ds_read_b64_tr_b16 a[16:17], v3 offset:4096
  ds_read_b64_tr_b16 a[18:19], v3 offset:4352
  ds_read_b64_tr_b16 a[20:21], v3 offset:5120
  ds_read_b64_tr_b16 a[22:23], v3 offset:5376
  ds_read_b64_tr_b16 a[24:25], v3 offset:6144
  ds_read_b64_tr_b16 a[26:27], v3 offset:6400
  ds_read_b64_tr_b16 a[28:29], v3 offset:7168
  ds_read_b64_tr_b16 a[30:31], v3 offset:7424
  ds_read_b64_tr_b16 a[32:33], v3 offset:8192
  ds_read_b64_tr_b16 a[34:35], v3 offset:8448
  ds_read_b64_tr_b16 a[36:37], v3 offset:9216
  ds_read_b64_tr_b16 a[38:39], v3 offset:9472
  ds_read_b64_tr_b16 a[40:41], v3 offset:10240
  ds_read_b64_tr_b16 a[42:43], v3 offset:10496
  ds_read_b64_tr_b16 a[44:45], v3 offset:11264
  ds_read_b64_tr_b16 a[46:47], v3 offset:11520
  ds_read_b64_tr_b16 a[48:49], v3 offset:12288
  ds_read_b64_tr_b16 a[50:51], v3 offset:12544
  ds_read_b64_tr_b16 a[52:53], v3 offset:13312
  ds_read_b64_tr_b16 a[54:55], v3 offset:13568
  ds_read_b64_tr_b16 a[56:57], v3 offset:14336
  ds_read_b64_tr_b16 a[58:59], v3 offset:14592
  ds_read_b64_tr_b16 a[60:61], v3 offset:15360
  ds_read_b64_tr_b16 a[62:63], v3 offset:15616
  ds_read_b64_tr_b16 a[64:65], v3 offset:16384
  ds_read_b64_tr_b16 a[66:67], v3 offset:16640
  ds_read_b64_tr_b16 a[68:69], v3 offset:17408
  ds_read_b64_tr_b16 a[70:71], v3 offset:17664
  ds_read_b64_tr_b16 a[72:73], v3 offset:18432
  ds_read_b64_tr_b16 a[74:75], v3 offset:18688
  ds_read_b64_tr_b16 a[76:77], v3 offset:19456
  ds_read_b64_tr_b16 a[78:79], v3 offset:19712
  ds_read_b64_tr_b16 a[80:81], v3 offset:20480
  ds_read_b64_tr_b16 a[82:83], v3 offset:20736
  ds_read_b64_tr_b16 a[84:85], v3 offset:21504
  ds_read_b64_tr_b16 a[86:87], v3 offset:21760
  ds_read_b64_tr_b16 a[88:89], v3 offset:22528
  ds_read_b64_tr_b16 a[90:91], v3 offset:22784
  ds_read_b64_tr_b16 a[92:93], v3 offset:23552
  ds_read_b64_tr_b16 a[94:95], v3 offset:23808
  s_waitcnt lgkmcnt(0)
  s_mov_b32 m0, s30
  s_nop 0
  buffer_load_dwordx4 v2, s[12:15], s29 offen lds
  s_add_u32 m0, m0, 1024
  s_add_u32 s29, s29, 18432
  buffer_load_dwordx4 v2, s[12:15], s29 offen lds
  s_add_u32 m0, m0, 1024
  s_add_u32 s29, s29, 18432
  buffer_load_dwordx4 v2, s[12:15], s29 offen lds
  s_add_u32 m0, m0, 1024
  s_add_u32 s29, s29, 18432
  buffer_load_dwordx4 v2, s[12:15], s29 offen lds
  s_add_u32 m0, m0, 1024
  s_add_u32 s29, s29, 18432
  buffer_load_dwordx4 v2, s[12:15], s29 offen lds
  s_add_u32 m0, m0, 1024
  s_add_u32 s29, s29, 18432
  buffer_load_dwordx4 v2, s[12:15], s29 offen lds
  s_add_u32 m0, m0, 1024
  s_add_u32 s29, s29, 18432
  buffer_load_dwordx4 v2, s[12:15], s29 offen lds
  s_add_u32 m0, m0, 1024
  s_add_u32 s29, s29, 18432
  buffer_load_dwordx4 v2, s[12:15], s29 offen lds
  s_add_u32 m0, m0, 1024
  s_add_u32 s29, s29, 18432
  buffer_load_dwordx4 v2, s[12:15], s29 offen lds
  s_add_u32 m0, m0, 1024
  s_add_u32 s29, s29, 18432
  buffer_load_dwordx4 v2, s[12:15], s29 offen lds
  s_add_u32 m0, m0, 1024
  s_add_u32 s29, s29, 18432
  buffer_load_dwordx4 v2, s[12:15], s29 offen lds
  s_add_u32 m0, m0, 1024
  s_add_u32 s29, s29, 18432
  buffer_load_dwordx4 v2, s[12:15], s29 offen lds
  s_add_u32 m0, m0, 1024
  s_add_u32 s29, s29, 18432
  buffer_load_dwordx4 v2, s[12:15], s29 offen lds
  s_add_u32 m0, m0, 1024
  s_add_u32 s29, s29, 18432
  buffer_load_dwordx4 v2, s[12:15], s29 offen lds
  s_add_u32 m0, m0, 1024
  s_add_u32 s29, s29, 18432
  buffer_load_dwordx4 v2, s[12:15], s29 offen lds
  s_add_u32 m0, m0, 1024
  s_add_u32 s29, s29, 18432
  buffer_load_dwordx4 v2, s[12:15], s29 offen lds
  s_add_u32 m0, m0, 1024
  s_add_u32 s29, s29, 18432
  buffer_load_dwordx4 v2, s[12:15], s29 offen lds
  s_add_u32 m0, m0, 1024
  s_add_u32 s29, s29, 18432
  buffer_load_dwordx4 v2, s[12:15], s29 offen lds
  s_add_u32 m0, m0, 1024
  s_add_u32 s29, s29, 18432
  buffer_load_dwordx4 v2, s[12:15], s29 offen lds
  s_add_u32 m0, m0, 1024
  s_add_u32 s29, s29, 18432
  buffer_load_dwordx4 v2, s[12:15], s29 offen lds
  s_add_u32 m0, m0, 1024
  s_add_u32 s29, s29, 18432
  buffer_load_dwordx4 v2, s[12:15], s29 offen lds
  s_add_u32 m0, m0, 1024
  s_add_u32 s29, s29, 18432
  buffer_load_dwordx4 v2, s[12:15], s29 offen lds
  s_add_u32 m0, m0, 1024
  s_add_u32 s29, s29, 18432
  buffer_load_dwordx4 v2, s[12:15], s29 offen lds
  s_add_u32 m0, m0, 1024
  s_add_u32 s29, s29, 18432
  buffer_load_dwordx4 v2, s[12:15], s29 offen lds
  s_add_u32 m0, m0, 1024
  s_add_u32 s29, s29, 18432
  s_waitcnt vmcnt(0)
  ds_read_b64_tr_b16 a[96:97], v3 offset:0
  ds_read_b64_tr_b16 a[98:99], v3 offset:256
  ds_read_b64_tr_b16 a[100:101], v3 offset:1024
  ds_read_b64_tr_b16 a[102:103], v3 offset:1280
  ds_read_b64_tr_b16 a[104:105], v3 offset:2048
  ds_read_b64_tr_b16 a[106:107], v3 offset:2304
  ds_read_b64_tr_b16 a[108:109], v3 offset:3072
  ds_read_b64_tr_b16 a[110:111], v3 offset:3328
  ds_read_b64_tr_b16 a[112:113], v3 offset:4096
  ds_read_b64_tr_b16 a[114:115], v3 offset:4352
  ds_read_b64_tr_b16 a[116:117], v3 offset:5120
  ds_read_b64_tr_b16 a[118:119], v3 offset:5376
  ds_read_b64_tr_b16 a[120:121], v3 offset:6144
  ds_read_b64_tr_b16 a[122:123], v3 offset:6400
  ds_read_b64_tr_b16 a[124:125], v3 offset:7168
  ds_read_b64_tr_b16 a[126:127], v3 offset:7424
  ds_read_b64_tr_b16 a[128:129], v3 offset:8192
  ds_read_b64_tr_b16 a[130:131], v3 offset:8448
  ds_read_b64_tr_b16 a[132:133], v3 offset:9216
  ds_read_b64_tr_b16 a[134:135], v3 offset:9472
  ds_read_b64_tr_b16 a[136:137], v3 offset:10240
  ds_read_b64_tr_b16 a[138:139], v3 offset:10496
  ds_read_b64_tr_b16 a[140:141], v3 offset:11264
  ds_read_b64_tr_b16 a[142:143], v3 offset:11520
  ds_read_b64_tr_b16 a[144:145], v3 offset:12288
  ds_read_b64_tr_b16 a[146:147], v3 offset:12544
  ds_read_b64_tr_b16 a[148:149], v3 offset:13312
  ds_read_b64_tr_b16 a[150:151], v3 offset:13568
  ds_read_b64_tr_b16 a[152:153], v3 offset:14336
  ds_read_b64_tr_b16 a[154:155], v3 offset:14592
  ds_read_b64_tr_b16 a[156:157], v3 offset:15360
  ds_read_b64_tr_b16 a[158:159], v3 offset:15616
  ds_read_b64_tr_b16 a[160:161], v3 offset:16384
  ds_read_b64_tr_b16 a[162:163], v3 offset:16640
  ds_read_b64_tr_b16 a[164:165], v3 offset:17408
  ds_read_b64_tr_b16 a[166:167], v3 offset:17664
  ds_read_b64_tr_b16 a[168:169], v3 offset:18432
  ds_read_b64_tr_b16 a[170:171], v3 offset:18688
  ds_read_b64_tr_b16 a[172:173], v3 offset:19456
  ds_read_b64_tr_b16 a[174:175], v3 offset:19712
  ds_read_b64_tr_b16 a[176:177], v3 offset:20480
  ds_read_b64_tr_b16 a[178:179], v3 offset:20736
  ds_read_b64_tr_b16 a[180:181], v3 offset:21504
  ds_read_b64_tr_b16 a[182:183], v3 offset:21760
  ds_read_b64_tr_b16 a[184:185], v3 offset:22528
  ds_read_b64_tr_b16 a[186:187], v3 offset:22784
  ds_read_b64_tr_b16 a[188:189], v3 offset:23552
  ds_read_b64_tr_b16 a[190:191], v3 offset:23808
  s_waitcnt lgkmcnt(0)
  s_mov_b32 m0, s30
  s_nop 0
  buffer_load_dwordx4 v2, s[12:15], s29 offen lds
  s_add_u32 m0, m0, 1024
  s_add_u32 s29, s29, 18432
  buffer_load_dwordx4 v2, s[12:15], s29 offen lds
  s_add_u32 m0, m0, 1024
  s_add_u32 s29, s29, 18432
  buffer_load_dwordx4 v2, s[12:15], s29 offen lds
  s_add_u32 m0, m0, 1024
  s_add_u32 s29, s29, 18432
  buffer_load_dwordx4 v2, s[12:15], s29 offen lds
  s_add_u32 m0, m0, 1024
  s_add_u32 s29, s29, 18432
  buffer_load_dwordx4 v2, s[12:15], s29 offen lds
  s_add_u32 m0, m0, 1024
  s_add_u32 s29, s29, 18432
  buffer_load_dwordx4 v2, s[12:15], s29 offen lds
  s_add_u32 m0, m0, 1024
  s_add_u32 s29, s29, 18432
  buffer_load_dwordx4 v2, s[12:15], s29 offen lds
  s_add_u32 m0, m0, 1024
  s_add_u32 s29, s29, 18432
  buffer_load_dwordx4 v2, s[12:15], s29 offen lds
  s_add_u32 m0, m0, 1024
  s_add_u32 s29, s29, 18432
  buffer_load_dwordx4 v2, s[12:15], s29 offen lds
  s_add_u32 m0, m0, 1024
  s_add_u32 s29, s29, 18432
  buffer_load_dwordx4 v2, s[12:15], s29 offen lds
  s_add_u32 m0, m0, 1024
  s_add_u32 s29, s29, 18432
  buffer_load_dwordx4 v2, s[12:15], s29 offen lds
  s_add_u32 m0, m0, 1024
  s_add_u32 s29, s29, 18432
  buffer_load_dwordx4 v2, s[12:15], s29 offen lds
  s_add_u32 m0, m0, 1024
  s_add_u32 s29, s29, 18432
  buffer_load_dwordx4 v2, s[12:15], s29 offen lds
  s_add_u32 m0, m0, 1024
  s_add_u32 s29, s29, 18432
  buffer_load_dwordx4 v2, s[12:15], s29 offen lds
  s_add_u32 m0, m0, 1024
  s_add_u32 s29, s29, 18432
  buffer_load_dwordx4 v2, s[12:15], s29 offen lds
  s_add_u32 m0, m0, 1024
  s_add_u32 s29, s29, 18432
  buffer_load_dwordx4 v2, s[12:15], s29 offen lds
  s_add_u32 m0, m0, 1024
  s_add_u32 s29, s29, 18432
  buffer_load_dwordx4 v2, s[12:15], s29 offen lds
  s_add_u32 m0, m0, 1024
  s_add_u32 s29, s29, 18432
  buffer_load_dwordx4 v2, s[12:15], s29 offen lds
  s_add_u32 m0, m0, 1024
  s_add_u32 s29, s29, 18432
  buffer_load_dwordx4 v2, s[12:15], s29 offen lds
  s_add_u32 m0, m0, 1024
  s_add_u32 s29, s29, 18432
  buffer_load_dwordx4 v2, s[12:15], s29 offen lds
  s_add_u32 m0, m0, 1024
  s_add_u32 s29, s29, 18432
  buffer_load_dwordx4 v2, s[12:15], s29 offen lds
  s_add_u32 m0, m0, 1024
  s_add_u32 s29, s29, 18432
  buffer_load_dwordx4 v2, s[12:15], s29 offen lds
  s_add_u32 m0, m0, 1024
  s_add_u32 s29, s29, 18432
  buffer_load_dwordx4 v2, s[12:15], s29 offen lds
  s_add_u32 m0, m0, 1024
  s_add_u32 s29, s29, 18432
  buffer_load_dwordx4 v2, s[12:15], s29 offen lds
  s_add_u32 m0, m0, 1024
  s_add_u32 s29, s29, 18432
  s_waitcnt vmcnt(0)
  ds_read_b64_tr_b16 a[192:193], v3 offset:0
  ds_read_b64_tr_b16 a[194:195], v3 offset:256
  ds_read_b64_tr_b16 a[196:197], v3 offset:1024
  ds_read_b64_tr_b16 a[198:199], v3 offset:1280
  ds_read_b64_tr_b16 a[200:201], v3 offset:2048
  ds_read_b64_tr_b16 a[202:203], v3 offset:2304
  ds_read_b64_tr_b16 a[204:205], v3 offset:3072
  ds_read_b64_tr_b16 a[206:207], v3 offset:3328
  ds_read_b64_tr_b16 a[208:209], v3 offset:4096
  ds_read_b64_tr_b16 a[210:211], v3 offset:4352
  ds_read_b64_tr_b16 a[212:213], v3 offset:5120
  ds_read_b64_tr_b16 a[214:215], v3 offset:5376
  ds_read_b64_tr_b16 a[216:217], v3 offset:6144
  ds_read_b64_tr_b16 a[218:219], v3 offset:6400
  ds_read_b64_tr_b16 a[220:221], v3 offset:7168
  ds_read_b64_tr_b16 a[222:223], v3 offset:7424
  ds_read_b64_tr_b16 a[224:225], v3 offset:8192
  ds_read_b64_tr_b16 a[226:227], v3 offset:8448
  ds_read_b64_tr_b16 a[228:229], v3 offset:9216
  ds_read_b64_tr_b16 a[230:231], v3 offset:9472
  ds_read_b64_tr_b16 a[232:233], v3 offset:10240
  ds_read_b64_tr_b16 a[234:235], v3 offset:10496
  ds_read_b64_tr_b16 a[236:237], v3 offset:11264
  ds_read_b64_tr_b16 a[238:239], v3 offset:11520
  ds_read_b64_tr_b16 a[240:241], v3 offset:12288
  ds_read_b64_tr_b16 a[242:243], v3 offset:12544
  ds_read_b64_tr_b16 a[244:245], v3 offset:13312
  ds_read_b64_tr_b16 a[246:247], v3 offset:13568
  ds_read_b64_tr_b16 a[248:249], v3 offset:14336
  ds_read_b64_tr_b16 a[250:251], v3 offset:14592
  ds_read_b64_tr_b16 a[252:253], v3 offset:15360
  ds_read_b64_tr_b16 a[254:255], v3 offset:15616
  ds_read_b64_tr_b16 v[224:225], v3 offset:16384
  ds_read_b64_tr_b16 v[226:227], v3 offset:16640
  ds_read_b64_tr_b16 v[228:229], v3 offset:17408
  ds_read_b64_tr_b16 v[230:231], v3 offset:17664
  ds_read_b64_tr_b16 v[232:233], v3 offset:18432
  ds_read_b64_tr_b16 v[234:235], v3 offset:18688
  ds_read_b64_tr_b16 v[236:237], v3 offset:19456
  ds_read_b64_tr_b16 v[238:239], v3 offset:19712
  ds_read_b64_tr_b16 v[240:241], v3 offset:20480
  ds_read_b64_tr_b16 v[242:243], v3 offset:20736
  ds_read_b64_tr_b16 v[244:245], v3 offset:21504
  ds_read_b64_tr_b16 v[246:247], v3 offset:21760
  ds_read_b64_tr_b16 v[248:249], v3 offset:22528
  ds_read_b64_tr_b16 v[250:251], v3 offset:22784
  ds_read_b64_tr_b16 v[252:253], v3 offset:23552
  ds_read_b64_tr_b16 v[254:255], v3 offset:23808
  s_waitcnt lgkmcnt(0)
  s_barrier
  s_mov_b32 s61, s20
  s_mov_b32 s64, 98304
  s_mov_b32 s66, 0
  v_lshlrev_b32 v20, 2, v1
  v_and_b32 v20, 28, v20
  buffer_load_dword v21, v20, s[16:19], 0 offen offset:96 sc1
  s_waitcnt vmcnt(0)
  v_cmp_gt_u32 vcc, 28, v21
  s_nop 1
  s_ff1_i32_b32 s65, vcc_lo
  s_and_b32 s65, s65, 15
  s_lshr_b32 s29, s61, 3
  s_cmp_lt_u32 s29, s65
  s_cbranch_scc1 L_pb_g0_have
  s_add_u32 s65, s29, 1
  s_lshl_b32 s29, s29, 2
  s_mov_b32 s34, 0
    L_pb_g0:
  buffer_load_dword v20, off, s[16:19], s29 offset:96 sc1
  s_add_u32 s34, s34, 1
  s_cmp_gt_u32 s34, 131072
  s_cbranch_scc1 L_abort
  s_waitcnt vmcnt(0)
  v_readfirstlane_b32 s32, v20
  s_nop 0
  s_and_b32 s32, s32, 0xffff
  s_cmp_ge_u32 s32, 28
  s_cbranch_scc1 L_pb_g0_ok
  s_sleep 8
  s_branch L_pb_g0
    L_pb_g0_ok:
L_pb_g0_have:
  s_mul_i32 s63, s61, 294912
  s_mul_i32 s29, s22, 73728
  s_add_u32 s63, s63, s29
  s_add_u32 s63, s63, 100663296
  s_mov_b32 s60, s63
  buffer_load_dwordx4 v[64:67], v4, s[8:11], s60 offen offset:0 sc1
  buffer_load_dwordx4 v[68:71], v4, s[8:11], s60 offen offset:1024 sc1
  buffer_load_dwordx4 v[72:75], v4, s[8:11], s60 offen offset:2048 sc1
  buffer_load_dwordx4 v[76:79], v4, s[8:11], s60 offen offset:3072 sc1
  s_add_u32 s60, s60, 4096
  buffer_load_dwordx4 v[80:83], v4, s[8:11], s60 offen offset:0 sc1
  buffer_load_dwordx4 v[84:87], v4, s[8:11], s60 offen offset:1024 sc1
  buffer_load_dwordx4 v[88:91], v4, s[8:11], s60 offen offset:2048 sc1
  buffer_load_dwordx4 v[92:95], v4, s[8:11], s60 offen offset:3072 sc1
  s_add_u32 s60, s60, 4096
  buffer_load_dwordx4 v[96:99], v4, s[8:11], s60 offen offset:0 sc1
  buffer_load_dwordx4 v[100:103], v4, s[8:11], s60 offen offset:1024 sc1
  buffer_load_dwordx4 v[104:107], v4, s[8:11], s60 offen offset:2048 sc1
  buffer_load_dwordx4 v[108:111], v4, s[8:11], s60 offen offset:3072 sc1
  s_add_u32 s60, s60, 4096
  buffer_load_dwordx4 v[112:115], v4, s[8:11], s60 offen offset:0 sc1
  buffer_load_dwordx4 v[116:119], v4, s[8:11], s60 offen offset:1024 sc1
  buffer_load_dwordx4 v[120:123], v4, s[8:11], s60 offen offset:2048 sc1
  buffer_load_dwordx4 v[124:127], v4, s[8:11], s60 offen offset:3072 sc1
L_pb_loop:
  s_mov_b32 s34, 0
  s_waitcnt vmcnt(15)
  v_mfma_f32_32x32x16_bf16 v[128:143], a[0:3], v[64:67], 0
  s_add_u32 s60, s60, 4096
  buffer_load_dwordx4 v[64:67], v4, s[8:11], s60 offen offset:0 sc1
  s_waitcnt vmcnt(15)
  v_mfma_f32_32x32x16_bf16 v[128:143], a[4:7], v[68:71], v[128:143]
  buffer_load_dwordx4 v[68:71], v4, s[8:11], s60 offen offset:1024 sc1
  s_waitcnt vmcnt(15)
  v_mfma_f32_32x32x16_bf16 v[128:143], a[8:11], v[72:75], v[128:143]
  buffer_load_dwordx4 v[72:75], v4, s[8:11], s60 offen offset:2048 sc1
  s_waitcnt vmcnt(15)
  v_mfma_f32_32x32x16_bf16 v[128:143], a[12:15], v[76:79], v[128:143]
  buffer_load_dwordx4 v[76:79], v4, s[8:11], s60 offen offset:3072 sc1
  s_waitcnt vmcnt(15)
  v_mfma_f32_32x32x16_bf16 v[128:143], a[16:19], v[80:83], v[128:143]
  s_add_u32 s60, s60, 4096
  buffer_load_dwordx4 v[80:83], v4, s[8:11], s60 offen offset:0 sc1
  s_waitcnt vmcnt(15)
  v_mfma_f32_32x32x16_bf16 v[128:143], a[20:23], v[84:87], v[128:143]
  buffer_load_dwordx4 v[84:87], v4, s[8:11], s60 offen offset:1024 sc1
  s_waitcnt vmcnt(15)
  v_mfma_f32_32x32x16_bf16 v[128:143], a[24:27], v[88:91], v[128:143]
  buffer_load_dwordx4 v[88:91], v4, s[8:11], s60 offen offset:2048 sc1
  s_waitcnt vmcnt(15)
  v_mfma_f32_32x32x16_bf16 v[128:143], a[28:31], v[92:95], v[128:143]
  buffer_load_dwordx4 v[92:95], v4, s[8:11], s60 offen offset:3072 sc1
  s_waitcnt vmcnt(15)
  v_mfma_f32_32x32x16_bf16 v[128:143], a[32:35], v[96:99], v[128:143]
  s_add_u32 s60, s60, 4096
  buffer_load_dwordx4 v[96:99], v4, s[8:11], s60 offen offset:0 sc1
  s_waitcnt vmcnt(15)
  v_mfma_f32_32x32x16_bf16 v[128:143], a[36:39], v[100:103], v[128:143]
  buffer_load_dwordx4 v[100:103], v4, s[8:11], s60 offen offset:1024 sc1
  s_waitcnt vmcnt(15)
  v_mfma_f32_32x32x16_bf16 v[128:143], a[40:43], v[104:107], v[128:143]
  buffer_load_dwordx4 v[104:107], v4, s[8:11], s60 offen offset:2048 sc1
  s_waitcnt vmcnt(15)
  v_mfma_f32_32x32x16_bf16 v[128:143], a[44:47], v[108:111], v[128:143]
  buffer_load_dwordx4 v[108:111], v4, s[8:11], s60 offen offset:3072 sc1
  s_waitcnt vmcnt(15)
  v_mfma_f32_32x32x16_bf16 v[128:143], a[48:51], v[112:115], v[128:143]
  s_add_u32 s60, s60, 4096
  buffer_load_dwordx4 v[112:115], v4, s[8:11], s60 offen offset:0 sc1
  s_waitcnt vmcnt(15)
  v_mfma_f32_32x32x16_bf16 v[128:143], a[52:55], v[116:119], v[128:143]
  buffer_load_dwordx4 v[116:119], v4, s[8:11], s60 offen offset:1024 sc1
  s_waitcnt vmcnt(15)
  v_mfma_f32_32x32x16_bf16 v[128:143], a[56:59], v[120:123], v[128:143]
  buffer_load_dwordx4 v[120:123], v4, s[8:11], s60 offen offset:2048 sc1
  s_waitcnt vmcnt(15)
  v_mfma_f32_32x32x16_bf16 v[128:143], a[60:63], v[124:127], v[128:143]
  buffer_load_dwordx4 v[124:127], v4, s[8:11], s60 offen offset:3072 sc1
  s_waitcnt vmcnt(15)
  v_mfma_f32_32x32x16_bf16 v[128:143], a[64:67], v[64:67], v[128:143]
  s_add_u32 s60, s60, 4096
  buffer_load_dwordx4 v[64:67], v4, s[8:11], s60 offen offset:0 sc1
  s_waitcnt vmcnt(15)
  v_mfma_f32_32x32x16_bf16 v[128:143], a[68:71], v[68:71], v[128:143]
  buffer_load_dwordx4 v[68:71], v4, s[8:11], s60 offen offset:1024 sc1
  s_waitcnt vmcnt(15)
  v_mfma_f32_32x32x16_bf16 v[128:143], a[72:75], v[72:75], v[128:143]
  buffer_load_dwordx4 v[72:75], v4, s[8:11], s60 offen offset:2048 sc1
  s_waitcnt vmcnt(15)
  v_mfma_f32_32x32x16_bf16 v[128:143], a[76:79], v[76:79], v[128:143]
  buffer_load_dwordx4 v[76:79], v4, s[8:11], s60 offen offset:3072 sc1
  s_waitcnt vmcnt(15)
  v_mfma_f32_32x32x16_bf16 v[128:143], a[80:83], v[80:83], v[128:143]
  s_add_u32 s60, s60, 4096
  buffer_load_dwordx4 v[80:83], v4, s[8:11], s60 offen offset:0 sc1
  s_waitcnt vmcnt(15)
  v_mfma_f32_32x32x16_bf16 v[128:143], a[84:87], v[84:87], v[128:143]
  buffer_load_dwordx4 v[84:87], v4, s[8:11], s60 offen offset:1024 sc1
  s_waitcnt vmcnt(15)
  v_mfma_f32_32x32x16_bf16 v[128:143], a[88:91], v[88:91], v[128:143]
  buffer_load_dwordx4 v[88:91], v4, s[8:11], s60 offen offset:2048 sc1
  s_waitcnt vmcnt(15)
  v_mfma_f32_32x32x16_bf16 v[128:143], a[92:95], v[92:95], v[128:143]
  buffer_load_dwordx4 v[92:95], v4, s[8:11], s60 offen offset:3072 sc1
  s_waitcnt vmcnt(15)
  v_mfma_f32_32x32x16_bf16 v[128:143], a[96:99], v[96:99], v[128:143]
  s_add_u32 s60, s60, 4096
  buffer_load_dwordx4 v[96:99], v4, s[8:11], s60 offen offset:0 sc1
  s_waitcnt vmcnt(15)
  v_mfma_f32_32x32x16_bf16 v[128:143], a[100:103], v[100:103], v[128:143]
  buffer_load_dwordx4 v[100:103], v4, s[8:11], s60 offen offset:1024 sc1
  s_waitcnt vmcnt(15)
  v_mfma_f32_32x32x16_bf16 v[128:143], a[104:107], v[104:107], v[128:143]
  buffer_load_dwordx4 v[104:107], v4, s[8:11], s60 offen offset:2048 sc1
  s_waitcnt vmcnt(15)
  v_mfma_f32_32x32x16_bf16 v[128:143], a[108:111], v[108:111], v[128:143]
  buffer_load_dwordx4 v[108:111], v4, s[8:11], s60 offen offset:3072 sc1
  s_waitcnt vmcnt(15)
  v_mfma_f32_32x32x16_bf16 v[128:143], a[112:115], v[112:115], v[128:143]
  s_add_u32 s60, s60, 4096
  buffer_load_dwordx4 v[112:115], v4, s[8:11], s60 offen offset:0 sc1
  s_waitcnt vmcnt(15)
  v_mfma_f32_32x32x16_bf16 v[128:143], a[116:119], v[116:119], v[128:143]
  buffer_load_dwordx4 v[116:119], v4, s[8:11], s60 offen offset:1024 sc1
  s_waitcnt vmcnt(15)
  v_mfma_f32_32x32x16_bf16 v[128:143], a[120:123], v[120:123], v[128:143]
  buffer_load_dwordx4 v[120:123], v4, s[8:11], s60 offen offset:2048 sc1
  s_waitcnt vmcnt(15)
  v_mfma_f32_32x32x16_bf16 v[128:143], a[124:127], v[124:127], v[128:143]
  buffer_load_dwordx4 v[124:127], v4, s[8:11], s60 offen offset:3072 sc1
  s_waitcnt vmcnt(15)
  v_mfma_f32_32x32x16_bf16 v[128:143], a[128:131], v[64:67], v[128:143]
  s_add_u32 s60, s60, 4096
  buffer_load_dwordx4 v[64:67], v4, s[8:11], s60 offen offset:0 sc1
  s_waitcnt vmcnt(15)
  v_mfma_f32_32x32x16_bf16 v[128:143], a[132:135], v[68:71], v[128:143]
  buffer_load_dwordx4 v[68:71], v4, s[8:11], s60 offen offset:1024 sc1
  s_waitcnt vmcnt(15)
  v_mfma_f32_32x32x16_bf16 v[128:143], a[136:139], v[72:75], v[128:143]
  buffer_load_dwordx4 v[72:75], v4, s[8:11], s60 offen offset:2048 sc1
  s_waitcnt vmcnt(15)
  v_mfma_f32_32x32x16_bf16 v[128:143], a[140:143], v[76:79], v[128:143]
  buffer_load_dwordx4 v[76:79], v4, s[8:11], s60 offen offset:3072 sc1
  s_waitcnt vmcnt(15)
  v_mfma_f32_32x32x16_bf16 v[128:143], a[144:147], v[80:83], v[128:143]
  s_add_u32 s60, s60, 4096
  buffer_load_dwordx4 v[80:83], v4, s[8:11], s60 offen offset:0 sc1
  s_waitcnt vmcnt(15)
  v_mfma_f32_32x32x16_bf16 v[128:143], a[148:151], v[84:87], v[128:143]
  buffer_load_dwordx4 v[84:87], v4, s[8:11], s60 offen offset:1024 sc1
  s_waitcnt vmcnt(15)
  v_mfma_f32_32x32x16_bf16 v[128:143], a[152:155], v[88:91], v[128:143]
  buffer_load_dwordx4 v[88:91], v4, s[8:11], s60 offen offset:2048 sc1
  s_waitcnt vmcnt(15)
  v_mfma_f32_32x32x16_bf16 v[128:143], a[156:159], v[92:95], v[128:143]
  buffer_load_dwordx4 v[92:95], v4, s[8:11], s60 offen offset:3072 sc1
  s_waitcnt vmcnt(15)
  v_mfma_f32_32x32x16_bf16 v[128:143], a[160:163], v[96:99], v[128:143]
  s_add_u32 s60, s60, 4096
  buffer_load_dwordx4 v[96:99], v4, s[8:11], s60 offen offset:0 sc1
  s_waitcnt vmcnt(15)
  v_mfma_f32_32x32x16_bf16 v[128:143], a[164:167], v[100:103], v[128:143]
  buffer_load_dwordx4 v[100:103], v4, s[8:11], s60 offen offset:1024 sc1
  s_waitcnt vmcnt(15)
  v_mfma_f32_32x32x16_bf16 v[128:143], a[168:171], v[104:107], v[128:143]
  buffer_load_dwordx4 v[104:107], v4, s[8:11], s60 offen offset:2048 sc1
  s_waitcnt vmcnt(15)
  v_mfma_f32_32x32x16_bf16 v[128:143], a[172:175], v[108:111], v[128:143]
  buffer_load_dwordx4 v[108:111], v4, s[8:11], s60 offen offset:3072 sc1
  s_waitcnt vmcnt(15)
  v_mfma_f32_32x32x16_bf16 v[128:143], a[176:179], v[112:115], v[128:143]
  s_add_u32 s60, s60, 4096
  buffer_load_dwordx4 v[112:115], v4, s[8:11], s60 offen offset:0 sc1
  s_waitcnt vmcnt(15)
  v_mfma_f32_32x32x16_bf16 v[128:143], a[180:183], v[116:119], v[128:143]
  buffer_load_dwordx4 v[116:119], v4, s[8:11], s60 offen offset:1024 sc1
  s_waitcnt vmcnt(15)
  v_mfma_f32_32x32x16_bf16 v[128:143], a[184:187], v[120:123], v[128:143]
  buffer_load_dwordx4 v[120:123], v4, s[8:11], s60 offen offset:2048 sc1
  s_waitcnt vmcnt(15)
  v_mfma_f32_32x32x16_bf16 v[128:143], a[188:191], v[124:127], v[128:143]
  buffer_load_dwordx4 v[124:127], v4, s[8:11], s60 offen offset:3072 sc1
  s_waitcnt vmcnt(15)
  v_mfma_f32_32x32x16_bf16 v[128:143], a[192:195], v[64:67], v[128:143]
  s_add_u32 s60, s60, 4096
  buffer_load_dwordx4 v[64:67], v4, s[8:11], s60 offen offset:0 sc1
  s_waitcnt vmcnt(15)
  v_mfma_f32_32x32x16_bf16 v[128:143], a[196:199], v[68:71], v[128:143]
  buffer_load_dwordx4 v[68:71], v4, s[8:11], s60 offen offset:1024 sc1
  s_waitcnt vmcnt(15)
  v_mfma_f32_32x32x16_bf16 v[128:143], a[200:203], v[72:75], v[128:143]
  buffer_load_dwordx4 v[72:75], v4, s[8:11], s60 offen offset:2048 sc1
  s_waitcnt vmcnt(15)
  v_mfma_f32_32x32x16_bf16 v[128:143], a[204:207], v[76:79], v[128:143]
  buffer_load_dwordx4 v[76:79], v4, s[8:11], s60 offen offset:3072 sc1
  s_waitcnt vmcnt(15)
  v_mfma_f32_32x32x16_bf16 v[128:143], a[208:211], v[80:83], v[128:143]
  s_add_u32 s60, s60, 4096
  buffer_load_dwordx4 v[80:83], v4, s[8:11], s60 offen offset:0 sc1
  s_waitcnt vmcnt(15)
  v_mfma_f32_32x32x16_bf16 v[128:143], a[212:215], v[84:87], v[128:143]
  buffer_load_dwordx4 v[84:87], v4, s[8:11], s60 offen offset:1024 sc1
  s_waitcnt vmcnt(15)
  v_mfma_f32_32x32x16_bf16 v[128:143], a[216:219], v[88:91], v[128:143]
  buffer_load_dwordx4 v[88:91], v4, s[8:11], s60 offen offset:2048 sc1
  s_waitcnt vmcnt(15)
  v_mfma_f32_32x32x16_bf16 v[128:143], a[220:223], v[92:95], v[128:143]
  buffer_load_dwordx4 v[92:95], v4, s[8:11], s60 offen offset:3072 sc1
  s_waitcnt vmcnt(15)
  v_mfma_f32_32x32x16_bf16 v[128:143], a[224:227], v[96:99], v[128:143]
  s_waitcnt vmcnt(14)
  v_mfma_f32_32x32x16_bf16 v[128:143], a[228:231], v[100:103], v[128:143]
  s_waitcnt vmcnt(13)
  v_mfma_f32_32x32x16_bf16 v[128:143], a[232:235], v[104:107], v[128:143]
  s_waitcnt vmcnt(12)
  v_mfma_f32_32x32x16_bf16 v[128:143], a[236:239], v[108:111], v[128:143]
  s_waitcnt vmcnt(11)
  v_mfma_f32_32x32x16_bf16 v[128:143], a[240:243], v[112:115], v[128:143]
  s_waitcnt vmcnt(10)
  v_mfma_f32_32x32x16_bf16 v[128:143], a[244:247], v[116:119], v[128:143]
  s_waitcnt vmcnt(9)
  v_mfma_f32_32x32x16_bf16 v[128:143], a[248:251], v[120:123], v[128:143]
  s_waitcnt vmcnt(8)
  v_mfma_f32_32x32x16_bf16 v[128:143], a[252:255], v[124:127], v[128:143]
  s_waitcnt vmcnt(7)
  v_mfma_f32_32x32x16_bf16 v[128:143], v[224:227], v[64:67], v[128:143]
  s_waitcnt vmcnt(6)
  v_mfma_f32_32x32x16_bf16 v[128:143], v[228:231], v[68:71], v[128:143]
  s_waitcnt vmcnt(5)
  v_mfma_f32_32x32x16_bf16 v[128:143], v[232:235], v[72:75], v[128:143]
  s_waitcnt vmcnt(4)
  v_mfma_f32_32x32x16_bf16 v[128:143], v[236:239], v[76:79], v[128:143]
  s_waitcnt vmcnt(3)
  v_mfma_f32_32x32x16_bf16 v[128:143], v[240:243], v[80:83], v[128:143]
  s_waitcnt vmcnt(2)
  v_mfma_f32_32x32x16_bf16 v[128:143], v[244:247], v[84:87], v[128:143]
  s_waitcnt vmcnt(1)
  v_mfma_f32_32x32x16_bf16 v[128:143], v[248:251], v[88:91], v[128:143]
  s_waitcnt vmcnt(0)
  v_mfma_f32_32x32x16_bf16 v[128:143], v[252:255], v[92:95], v[128:143]
  s_add_u32 s61, s61, 7
  s_cmp_ge_u32 s61, 64
  s_cbranch_scc1 L_pb_last
  s_lshr_b32 s29, s61, 3
  s_cmp_lt_u32 s29, s65
  s_cbranch_scc1 L_pb_g1_have
  s_add_u32 s65, s29, 1
  s_lshl_b32 s29, s29, 2
  s_mov_b32 s34, 0
    L_pb_g1:
  buffer_load_dword v20, off, s[16:19], s29 offset:96 sc1
  s_add_u32 s34, s34, 1
  s_cmp_gt_u32 s34, 131072
  s_cbranch_scc1 L_abort
  s_waitcnt vmcnt(0)
  v_readfirstlane_b32 s32, v20
  s_nop 0
  s_and_b32 s32, s32, 0xffff
  s_cmp_ge_u32 s32, 28
  s_cbranch_scc1 L_pb_g1_ok
  s_sleep 8
  s_branch L_pb_g1
    L_pb_g1_ok:
L_pb_g1_have:
  s_mul_i32 s63, s61, 294912
  s_mul_i32 s29, s22, 73728
  s_add_u32 s63, s63, s29
  s_add_u32 s63, s63, 100663296
  s_mov_b32 s60, s63
  buffer_load_dwordx4 v[64:67], v4, s[8:11], s60 offen offset:0 sc1
  buffer_load_dwordx4 v[68:71], v4, s[8:11], s60 offen offset:1024 sc1
  buffer_load_dwordx4 v[72:75], v4, s[8:11], s60 offen offset:2048 sc1
  buffer_load_dwordx4 v[76:79], v4, s[8:11], s60 offen offset:3072 sc1
  s_add_u32 s60, s60, 4096
  buffer_load_dwordx4 v[80:83], v4, s[8:11], s60 offen offset:0 sc1
  buffer_load_dwordx4 v[84:87], v4, s[8:11], s60 offen offset:1024 sc1
  buffer_load_dwordx4 v[88:91], v4, s[8:11], s60 offen offset:2048 sc1
  buffer_load_dwordx4 v[92:95], v4, s[8:11], s60 offen offset:3072 sc1
  s_add_u32 s60, s60, 4096
  buffer_load_dwordx4 v[96:99], v4, s[8:11], s60 offen offset:0 sc1
  buffer_load_dwordx4 v[100:103], v4, s[8:11], s60 offen offset:1024 sc1
  buffer_load_dwordx4 v[104:107], v4, s[8:11], s60 offen offset:2048 sc1
  buffer_load_dwordx4 v[108:111], v4, s[8:11], s60 offen offset:3072 sc1
  s_add_u32 s60, s60, 4096
  buffer_load_dwordx4 v[112:115], v4, s[8:11], s60 offen offset:0 sc1
  buffer_load_dwordx4 v[116:119], v4, s[8:11], s60 offen offset:1024 sc1
  buffer_load_dwordx4 v[120:123], v4, s[8:11], s60 offen offset:2048 sc1
  buffer_load_dwordx4 v[124:127], v4, s[8:11], s60 offen offset:3072 sc1
L_pb_last:
  s_nop 7
  v_add_u32 v20, s66, v5
  v_add_u32 v21, s66, v6
  ds_write_b128 v20, v[128:131] offset:0
  ds_write_b128 v20, v[132:135] offset:1024
  ds_write_b128 v20, v[136:139] offset:2048
  ds_write_b128 v20, v[140:143] offset:3072
  s_waitcnt lgkmcnt(0)
  s_barrier
  ds_read_b128 v[144:147], v21 offset:0
  ds_read_b128 v[148:151], v21 offset:4096
  ds_read_b128 v[152:155], v21 offset:8192
  ds_read_b128 v[156:159], v21 offset:12288
  s_xor_b32 s66, s66, 16384
  s_waitcnt lgkmcnt(0)
  v_add_f32 v144, v144, v148
  v_add_f32 v152, v152, v156
  v_add_f32 v145, v145, v149
  v_add_f32 v153, v153, v157
  v_add_f32 v146, v146, v150
  v_add_f32 v154, v154, v158
  v_add_f32 v147, v147, v151
  v_add_f32 v155, v155, v159
  v_add_f32 v144, v144, v152
  v_add_f32 v145, v145, v153
  v_add_f32 v146, v146, v154
  v_add_f32 v147, v147, v155
  v_add_u32 v20, s64, v6
  ds_write_b128 v20, v[144:147]
  s_add_u32 s64, s64, 4096
  s_cmp_lt_u32 s61, 64
  s_cbranch_scc1 L_pb_loop
  s_waitcnt lgkmcnt(0)
  s_barrier
  s_load_dwordx2 s[54:55], s[0:1], 40
  s_waitcnt lgkmcnt(0)
  s_mov_b32 s12, s54
  s_and_b32 s13, s55, 0xffff
  s_mov_b32 s14, 4718592
  s_mov_b32 s15, 0x20000
  s_mul_i32 s29, s22, 1179648
  s_lshl_b32 s30, s21, 6
  s_add_u32 s29, s29, s30
  s_mul_i32 s30, s22, 24576
  s_mov_b32 m0, s30
  s_nop 0
  buffer_load_dwordx4 v2, s[12:15], s29 offen lds
  s_add_u32 m0, m0, 1024
  s_add_u32 s29, s29, 18432
  buffer_load_dwordx4 v2, s[12:15], s29 offen lds
  s_add_u32 m0, m0, 1024
  s_add_u32 s29, s29, 18432
  buffer_load_dwordx4 v2, s[12:15], s29 offen lds
  s_add_u32 m0, m0, 1024
  s_add_u32 s29, s29, 18432
  buffer_load_dwordx4 v2, s[12:15], s29 offen lds
  s_add_u32 m0, m0, 1024
  s_add_u32 s29, s29, 18432
  buffer_load_dwordx4 v2, s[12:15], s29 offen lds
  s_add_u32 m0, m0, 1024
  s_add_u32 s29, s29, 18432
  buffer_load_dwordx4 v2, s[12:15], s29 offen lds
  s_add_u32 m0, m0, 1024
  s_add_u32 s29, s29, 18432
  buffer_load_dwordx4 v2, s[12:15], s29 offen lds
  s_add_u32 m0, m0, 1024
  s_add_u32 s29, s29, 18432
  buffer_load_dwordx4 v2, s[12:15], s29 offen lds
  s_add_u32 m0, m0, 1024
  s_add_u32 s29, s29, 18432
  buffer_load_dwordx4 v2, s[12:15], s29 offen lds
  s_add_u32 m0, m0, 1024
  s_add_u32 s29, s29, 18432
  buffer_load_dwordx4 v2, s[12:15], s29 offen lds
  s_add_u32 m0, m0, 1024
  s_add_u32 s29, s29, 18432
  buffer_load_dwordx4 v2, s[12:15], s29 offen lds
  s_add_u32 m0, m0, 1024
  s_add_u32 s29, s29, 18432
  buffer_load_dwordx4 v2, s[12:15], s29 offen lds
  s_add_u32 m0, m0, 1024
  s_add_u32 s29, s29, 18432
  buffer_load_dwordx4 v2, s[12:15], s29 offen lds
  s_add_u32 m0, m0, 1024
  s_add_u32 s29, s29, 18432
  buffer_load_dwordx4 v2, s[12:15], s29 offen lds
  s_add_u32 m0, m0, 1024
  s_add_u32 s29, s29, 18432
  buffer_load_dwordx4 v2, s[12:15], s29 offen lds
  s_add_u32 m0, m0, 1024
  s_add_u32 s29, s29, 18432
  buffer_load_dwordx4 v2, s[12:15], s29 offen lds
  s_add_u32 m0, m0, 1024
  s_add_u32 s29, s29, 18432
  buffer_load_dwordx4 v2, s[12:15], s29 offen lds
  s_add_u32 m0, m0, 1024
  s_add_u32 s29, s29, 18432
  buffer_load_dwordx4 v2, s[12:15], s29 offen lds
  s_add_u32 m0, m0, 1024
  s_add_u32 s29, s29, 18432
  buffer_load_dwordx4 v2, s[12:15], s29 offen lds
  s_add_u32 m0, m0, 1024
  s_add_u32 s29, s29, 18432
  buffer_load_dwordx4 v2, s[12:15], s29 offen lds
  s_add_u32 m0, m0, 1024
  s_add_u32 s29, s29, 18432
  buffer_load_dwordx4 v2, s[12:15], s29 offen lds
  s_add_u32 m0, m0, 1024
  s_add_u32 s29, s29, 18432
  buffer_load_dwordx4 v2, s[12:15], s29 offen lds
  s_add_u32 m0, m0, 1024
  s_add_u32 s29, s29, 18432
  buffer_load_dwordx4 v2, s[12:15], s29 offen lds
  s_add_u32 m0, m0, 1024
  s_add_u32 s29, s29, 18432
  buffer_load_dwordx4 v2, s[12:15], s29 offen lds
  s_add_u32 m0, m0, 1024
  s_add_u32 s29, s29, 18432
  s_waitcnt vmcnt(0)
  ds_read_b64_tr_b16 a[0:1], v3 offset:0
  ds_read_b64_tr_b16 a[2:3], v3 offset:256
  ds_read_b64_tr_b16 a[4:5], v3 offset:1024
  ds_read_b64_tr_b16 a[6:7], v3 offset:1280
  ds_read_b64_tr_b16 a[8:9], v3 offset:2048
  ds_read_b64_tr_b16 a[10:11], v3 offset:2304
  ds_read_b64_tr_b16 a[12:13], v3 offset:3072
  ds_read_b64_tr_b16 a[14:15], v3 offset:3328
  ds_read_b64_tr_b16 a[16:17], v3 offset:4096
  ds_read_b64_tr_b16 a[18:19], v3 offset:4352
  ds_read_b64_tr_b16 a[20:21], v3 offset:5120
  ds_read_b64_tr_b16 a[22:23], v3 offset:5376
  ds_read_b64_tr_b16 a[24:25], v3 offset:6144
  ds_read_b64_tr_b16 a[26:27], v3 offset:6400
  ds_read_b64_tr_b16 a[28:29], v3 offset:7168
  ds_read_b64_tr_b16 a[30:31], v3 offset:7424
  ds_read_b64_tr_b16 a[32:33], v3 offset:8192
  ds_read_b64_tr_b16 a[34:35], v3 offset:8448
  ds_read_b64_tr_b16 a[36:37], v3 offset:9216
  ds_read_b64_tr_b16 a[38:39], v3 offset:9472
  ds_read_b64_tr_b16 a[40:41], v3 offset:10240
  ds_read_b64_tr_b16 a[42:43], v3 offset:10496
  ds_read_b64_tr_b16 a[44:45], v3 offset:11264
  ds_read_b64_tr_b16 a[46:47], v3 offset:11520
  ds_read_b64_tr_b16 a[48:49], v3 offset:12288
  ds_read_b64_tr_b16 a[50:51], v3 offset:12544
  ds_read_b64_tr_b16 a[52:53], v3 offset:13312
  ds_read_b64_tr_b16 a[54:55], v3 offset:13568
  ds_read_b64_tr_b16 a[56:57], v3 offset:14336
  ds_read_b64_tr_b16 a[58:59], v3 offset:14592
  ds_read_b64_tr_b16 a[60:61], v3 offset:15360
  ds_read_b64_tr_b16 a[62:63], v3 offset:15616
  ds_read_b64_tr_b16 a[64:65], v3 offset:16384
  ds_read_b64_tr_b16 a[66:67], v3 offset:16640
  ds_read_b64_tr_b16 a[68:69], v3 offset:17408
  ds_read_b64_tr_b16 a[70:71], v3 offset:17664
  ds_read_b64_tr_b16 a[72:73], v3 offset:18432
  ds_read_b64_tr_b16 a[74:75], v3 offset:18688
  ds_read_b64_tr_b16 a[76:77], v3 offset:19456
  ds_read_b64_tr_b16 a[78:79], v3 offset:19712
  ds_read_b64_tr_b16 a[80:81], v3 offset:20480
  ds_read_b64_tr_b16 a[82:83], v3 offset:20736
  ds_read_b64_tr_b16 a[84:85], v3 offset:21504
  ds_read_b64_tr_b16 a[86:87], v3 offset:21760
  ds_read_b64_tr_b16 a[88:89], v3 offset:22528
  ds_read_b64_tr_b16 a[90:91], v3 offset:22784
  ds_read_b64_tr_b16 a[92:93], v3 offset:23552
  ds_read_b64_tr_b16 a[94:95], v3 offset:23808
  s_waitcnt lgkmcnt(0)
  s_mov_b32 m0, s30
  s_nop 0
  buffer_load_dwordx4 v2, s[12:15], s29 offen lds
  s_add_u32 m0, m0, 1024
  s_add_u32 s29, s29, 18432
  buffer_load_dwordx4 v2, s[12:15], s29 offen lds
  s_add_u32 m0, m0, 1024
  s_add_u32 s29, s29, 18432
  buffer_load_dwordx4 v2, s[12:15], s29 offen lds
  s_add_u32 m0, m0, 1024
  s_add_u32 s29, s29, 18432
  buffer_load_dwordx4 v2, s[12:15], s29 offen lds
  s_add_u32 m0, m0, 1024
  s_add_u32 s29, s29, 18432
  buffer_load_dwordx4 v2, s[12:15], s29 offen lds
  s_add_u32 m0, m0, 1024
  s_add_u32 s29, s29, 18432
  buffer_load_dwordx4 v2, s[12:15], s29 offen lds
  s_add_u32 m0, m0, 1024
  s_add_u32 s29, s29, 18432
  buffer_load_dwordx4 v2, s[12:15], s29 offen lds
  s_add_u32 m0, m0, 1024
  s_add_u32 s29, s29, 18432
  buffer_load_dwordx4 v2, s[12:15], s29 offen lds
  s_add_u32 m0, m0, 1024
  s_add_u32 s29, s29, 18432
  buffer_load_dwordx4 v2, s[12:15], s29 offen lds
  s_add_u32 m0, m0, 1024
  s_add_u32 s29, s29, 18432
  buffer_load_dwordx4 v2, s[12:15], s29 offen lds
  s_add_u32 m0, m0, 1024
  s_add_u32 s29, s29, 18432
  buffer_load_dwordx4 v2, s[12:15], s29 offen lds
  s_add_u32 m0, m0, 1024
  s_add_u32 s29, s29, 18432
  buffer_load_dwordx4 v2, s[12:15], s29 offen lds
  s_add_u32 m0, m0, 1024
  s_add_u32 s29, s29, 18432
  buffer_load_dwordx4 v2, s[12:15], s29 offen lds
  s_add_u32 m0, m0, 1024
  s_add_u32 s29, s29, 18432
  buffer_load_dwordx4 v2, s[12:15], s29 offen lds
  s_add_u32 m0, m0, 1024
  s_add_u32 s29, s29, 18432
  buffer_load_dwordx4 v2, s[12:15], s29 offen lds
  s_add_u32 m0, m0, 1024
  s_add_u32 s29, s29, 18432
  buffer_load_dwordx4 v2, s[12:15], s29 offen lds
  s_add_u32 m0, m0, 1024
  s_add_u32 s29, s29, 18432
  buffer_load_dwordx4 v2, s[12:15], s29 offen lds
  s_add_u32 m0, m0, 1024
  s_add_u32 s29, s29, 18432
  buffer_load_dwordx4 v2, s[12:15], s29 offen lds
  s_add_u32 m0, m0, 1024
  s_add_u32 s29, s29, 18432
  buffer_load_dwordx4 v2, s[12:15], s29 offen lds
  s_add_u32 m0, m0, 1024
  s_add_u32 s29, s29, 18432
  buffer_load_dwordx4 v2, s[12:15], s29 offen lds
  s_add_u32 m0, m0, 1024
  s_add_u32 s29, s29, 18432
  buffer_load_dwordx4 v2, s[12:15], s29 offen lds
  s_add_u32 m0, m0, 1024
  s_add_u32 s29, s29, 18432
  buffer_load_dwordx4 v2, s[12:15], s29 offen lds
  s_add_u32 m0, m0, 1024
  s_add_u32 s29, s29, 18432
  buffer_load_dwordx4 v2, s[12:15], s29 offen lds
  s_add_u32 m0, m0, 1024
  s_add_u32 s29, s29, 18432
  buffer_load_dwordx4 v2, s[12:15], s29 offen lds
  s_add_u32 m0, m0, 1024
  s_add_u32 s29, s29, 18432
  s_waitcnt vmcnt(0)
  ds_read_b64_tr_b16 a[96:97], v3 offset:0
  ds_read_b64_tr_b16 a[98:99], v3 offset:256
  ds_read_b64_tr_b16 a[100:101], v3 offset:1024
  ds_read_b64_tr_b16 a[102:103], v3 offset:1280
  ds_read_b64_tr_b16 a[104:105], v3 offset:2048
  ds_read_b64_tr_b16 a[106:107], v3 offset:2304
  ds_read_b64_tr_b16 a[108:109], v3 offset:3072
  ds_read_b64_tr_b16 a[110:111], v3 offset:3328
  ds_read_b64_tr_b16 a[112:113], v3 offset:4096
  ds_read_b64_tr_b16 a[114:115], v3 offset:4352
  ds_read_b64_tr_b16 a[116:117], v3 offset:5120
  ds_read_b64_tr_b16 a[118:119], v3 offset:5376
  ds_read_b64_tr_b16 a[120:121], v3 offset:6144
  ds_read_b64_tr_b16 a[122:123], v3 offset:6400
  ds_read_b64_tr_b16 a[124:125], v3 offset:7168
  ds_read_b64_tr_b16 a[126:127], v3 offset:7424
  ds_read_b64_tr_b16 a[128:129], v3 offset:8192
  ds_read_b64_tr_b16 a[130:131], v3 offset:8448
  ds_read_b64_tr_b16 a[132:133], v3 offset:9216
  ds_read_b64_tr_b16 a[134:135], v3 offset:9472
  ds_read_b64_tr_b16 a[136:137], v3 offset:10240
  ds_read_b64_tr_b16 a[138:139], v3 offset:10496
  ds_read_b64_tr_b16 a[140:141], v3 offset:11264
  ds_read_b64_tr_b16 a[142:143], v3 offset:11520
  ds_read_b64_tr_b16 a[144:145], v3 offset:12288
  ds_read_b64_tr_b16 a[146:147], v3 offset:12544
  ds_read_b64_tr_b16 a[148:149], v3 offset:13312
  ds_read_b64_tr_b16 a[150:151], v3 offset:13568
  ds_read_b64_tr_b16 a[152:153], v3 offset:14336
  ds_read_b64_tr_b16 a[154:155], v3 offset:14592
  ds_read_b64_tr_b16 a[156:157], v3 offset:15360
  ds_read_b64_tr_b16 a[158:159], v3 offset:15616
  ds_read_b64_tr_b16 a[160:161], v3 offset:16384
  ds_read_b64_tr_b16 a[162:163], v3 offset:16640
  ds_read_b64_tr_b16 a[164:165], v3 offset:17408
  ds_read_b64_tr_b16 a[166:167], v3 offset:17664
  ds_read_b64_tr_b16 a[168:169], v3 offset:18432
  ds_read_b64_tr_b16 a[170:171], v3 offset:18688
  ds_read_b64_tr_b16 a[172:173], v3 offset:19456
  ds_read_b64_tr_b16 a[174:175], v3 offset:19712
  ds_read_b64_tr_b16 a[176:177], v3 offset:20480
  ds_read_b64_tr_b16 a[178:179], v3 offset:20736
  ds_read_b64_tr_b16 a[180:181], v3 offset:21504
  ds_read_b64_tr_b16 a[182:183], v3 offset:21760
  ds_read_b64_tr_b16 a[184:185], v3 offset:22528
  ds_read_b64_tr_b16 a[186:187], v3 offset:22784
  ds_read_b64_tr_b16 a[188:189], v3 offset:23552
  ds_read_b64_tr_b16 a[190:191], v3 offset:23808
  s_waitcnt lgkmcnt(0)
  s_mov_b32 m0, s30
  s_nop 0
  buffer_load_dwordx4 v2, s[12:15], s29 offen lds
  s_add_u32 m0, m0, 1024
  s_add_u32 s29, s29, 18432
  buffer_load_dwordx4 v2, s[12:15], s29 offen lds
  s_add_u32 m0, m0, 1024
  s_add_u32 s29, s29, 18432
  buffer_load_dwordx4 v2, s[12:15], s29 offen lds
  s_add_u32 m0, m0, 1024
  s_add_u32 s29, s29, 18432
  buffer_load_dwordx4 v2, s[12:15], s29 offen lds
  s_add_u32 m0, m0, 1024
  s_add_u32 s29, s29, 18432
  buffer_load_dwordx4 v2, s[12:15], s29 offen lds
  s_add_u32 m0, m0, 1024
  s_add_u32 s29, s29, 18432
  buffer_load_dwordx4 v2, s[12:15], s29 offen lds
  s_add_u32 m0, m0, 1024
  s_add_u32 s29, s29, 18432
  buffer_load_dwordx4 v2, s[12:15], s29 offen lds
  s_add_u32 m0, m0, 1024
  s_add_u32 s29, s29, 18432
  buffer_load_dwordx4 v2, s[12:15], s29 offen lds
  s_add_u32 m0, m0, 1024
  s_add_u32 s29, s29, 18432
  buffer_load_dwordx4 v2, s[12:15], s29 offen lds
  s_add_u32 m0, m0, 1024
  s_add_u32 s29, s29, 18432
  buffer_load_dwordx4 v2, s[12:15], s29 offen lds
  s_add_u32 m0, m0, 1024
  s_add_u32 s29, s29, 18432
  buffer_load_dwordx4 v2, s[12:15], s29 offen lds
  s_add_u32 m0, m0, 1024
  s_add_u32 s29, s29, 18432
  buffer_load_dwordx4 v2, s[12:15], s29 offen lds
  s_add_u32 m0, m0, 1024
  s_add_u32 s29, s29, 18432
  buffer_load_dwordx4 v2, s[12:15], s29 offen lds
  s_add_u32 m0, m0, 1024
  s_add_u32 s29, s29, 18432
  buffer_load_dwordx4 v2, s[12:15], s29 offen lds
  s_add_u32 m0, m0, 1024
  s_add_u32 s29, s29, 18432
  buffer_load_dwordx4 v2, s[12:15], s29 offen lds
  s_add_u32 m0, m0, 1024
  s_add_u32 s29, s29, 18432
  buffer_load_dwordx4 v2, s[12:15], s29 offen lds
  s_add_u32 m0, m0, 1024
  s_add_u32 s29, s29, 18432
  s_waitcnt vmcnt(0)
  ds_read_b64_tr_b16 a[192:193], v3 offset:0
  ds_read_b64_tr_b16 a[194:195], v3 offset:256
  ds_read_b64_tr_b16 a[196:197], v3 offset:1024
  ds_read_b64_tr_b16 a[198:199], v3 offset:1280
  ds_read_b64_tr_b16 a[200:201], v3 offset:2048
  ds_read_b64_tr_b16 a[202:203], v3 offset:2304
  ds_read_b64_tr_b16 a[204:205], v3 offset:3072
  ds_read_b64_tr_b16 a[206:207], v3 offset:3328
  ds_read_b64_tr_b16 a[208:209], v3 offset:4096
  ds_read_b64_tr_b16 a[210:211], v3 offset:4352
  ds_read_b64_tr_b16 a[212:213], v3 offset:5120
  ds_read_b64_tr_b16 a[214:215], v3 offset:5376
  ds_read_b64_tr_b16 a[216:217], v3 offset:6144
  ds_read_b64_tr_b16 a[218:219], v3 offset:6400
  ds_read_b64_tr_b16 a[220:221], v3 offset:7168
  ds_read_b64_tr_b16 a[222:223], v3 offset:7424
  ds_read_b64_tr_b16 a[224:225], v3 offset:8192
  ds_read_b64_tr_b16 a[226:227], v3 offset:8448
  ds_read_b64_tr_b16 a[228:229], v3 offset:9216
  ds_read_b64_tr_b16 a[230:231], v3 offset:9472
  ds_read_b64_tr_b16 a[232:233], v3 offset:10240
  ds_read_b64_tr_b16 a[234:235], v3 offset:10496
  ds_read_b64_tr_b16 a[236:237], v3 offset:11264
  ds_read_b64_tr_b16 a[238:239], v3 offset:11520
  ds_read_b64_tr_b16 a[240:241], v3 offset:12288
  ds_read_b64_tr_b16 a[242:243], v3 offset:12544
  ds_read_b64_tr_b16 a[244:245], v3 offset:13312
  ds_read_b64_tr_b16 a[246:247], v3 offset:13568
  ds_read_b64_tr_b16 a[248:249], v3 offset:14336
  ds_read_b64_tr_b16 a[250:251], v3 offset:14592
  ds_read_b64_tr_b16 a[252:253], v3 offset:15360
  ds_read_b64_tr_b16 a[254:255], v3 offset:15616
  s_waitcnt lgkmcnt(0)
  s_barrier
  s_mov_b32 s61, s20
  s_mov_b32 s64, 98304
  s_lshl_b32 s29, s61, 7
  s_add_u32 s30, s29, 1441792
  s_add_u32 s29, s29, 1384448
  s_lshl_b32 s31, s22, 10
  s_add_u32 s31, s31, 1376256
  buffer_load_dword v28, off, s[8:11], s29 sc1
  buffer_load_dword v29, off, s[8:11], s31 sc1
  buffer_load_dword v32, v7, s[8:11], s30 offen sc1
L_pa_loop:
  v_add_u32 v20, s64, v6
  ds_read_b128 v[24:27], v20
  s_mov_b32 s34, 0
  s_branch L_pa_chk
    L_pa_again:
  s_sleep 16
  s_lshl_b32 s29, s61, 7
  s_add_u32 s30, s29, 1441792
  s_add_u32 s29, s29, 1384448
  s_lshl_b32 s31, s22, 10
  s_add_u32 s31, s31, 1376256
  buffer_load_dword v28, off, s[8:11], s29 sc1
  buffer_load_dword v29, off, s[8:11], s31 sc1
  buffer_load_dword v32, v7, s[8:11], s30 offen sc1
  s_add_u32 s34, s34, 1
  s_cmp_gt_u32 s34, 131072
  s_cbranch_scc1 L_abort
L_pa_chk:
  s_waitcnt vmcnt(0)
  v_readfirstlane_b32 s29, v28
  v_readfirstlane_b32 s30, v29
  s_cmp_lt_u32 s29, 64
  s_cbranch_scc1 L_pa_again
  s_cmp_le_u32 s30, s61
  s_cbranch_scc1 L_pa_again
  v_mov_b32 v30, v32
  s_lshl_b32 s63, s61, 18
  s_lshl_b32 s29, s22, 16
  s_add_u32 s63, s63, s29
  s_add_u32 s63, s63, 83886080
  s_mov_b32 s60, s63
  s_mov_b32 s34, 0
L_pa_g:
  buffer_load_dwordx4 v[64:67], v4, s[8:11], s60 offen offset:0 sc1
  buffer_load_dwordx4 v[68:71], v4, s[8:11], s60 offen offset:1024 sc1
  buffer_load_dwordx4 v[72:75], v4, s[8:11], s60 offen offset:2048 sc1
  buffer_load_dwordx4 v[76:79], v4, s[8:11], s60 offen offset:3072 sc1
  s_add_u32 s34, s34, 1
  s_cmp_gt_u32 s34, 131072
  s_cbranch_scc1 L_abort
  s_waitcnt vmcnt(3)
  v_and_b32 v31, 1, v64
  v_cmp_ne_u32 vcc, 1, v31
  s_cbranch_vccnz L_pa_g
  s_add_u32 s60, s60, 4096
  buffer_load_dwordx4 v[80:83], v4, s[8:11], s60 offen offset:0 sc1
  buffer_load_dwordx4 v[84:87], v4, s[8:11], s60 offen offset:1024 sc1
  buffer_load_dwordx4 v[88:91], v4, s[8:11], s60 offen offset:2048 sc1
  buffer_load_dwordx4 v[92:95], v4, s[8:11], s60 offen offset:3072 sc1
  s_add_u32 s60, s60, 4096
  buffer_load_dwordx4 v[96:99], v4, s[8:11], s60 offen offset:0 sc1
  buffer_load_dwordx4 v[100:103], v4, s[8:11], s60 offen offset:1024 sc1
  buffer_load_dwordx4 v[104:107], v4, s[8:11], s60 offen offset:2048 sc1
  buffer_load_dwordx4 v[108:111], v4, s[8:11], s60 offen offset:3072 sc1
  s_add_u32 s60, s60, 4096
  buffer_load_dwordx4 v[112:115], v4, s[8:11], s60 offen offset:0 sc1
  buffer_load_dwordx4 v[116:119], v4, s[8:11], s60 offen offset:1024 sc1
  buffer_load_dwordx4 v[120:123], v4, s[8:11], s60 offen offset:2048 sc1
  buffer_load_dwordx4 v[124:127], v4, s[8:11], s60 offen offset:3072 sc1
  s_mov_b32 s34, 0
  s_waitcnt vmcnt(15)
  v_and_b32 v31, 1, v64
  v_cmp_ne_u32 vcc, 1, v31
  s_cbranch_vccnz L_pa_f0
L_pa_c0:
  v_mfma_f32_32x32x16_bf16 v[128:143], a[0:3], v[64:67], 0
  s_add_u32 s60, s60, 4096
  buffer_load_dwordx4 v[64:67], v4, s[8:11], s60 offen offset:0 sc1
  s_waitcnt vmcnt(15)
  v_and_b32 v31, 1, v68
  v_cmp_ne_u32 vcc, 1, v31
  s_cbranch_vccnz L_pa_f1
L_pa_c1:
  v_mfma_f32_32x32x16_bf16 v[128:143], a[4:7], v[68:71], v[128:143]
  buffer_load_dwordx4 v[68:71], v4, s[8:11], s60 offen offset:1024 sc1
  s_waitcnt vmcnt(15)
  v_and_b32 v31, 1, v72
  v_cmp_ne_u32 vcc, 1, v31
  s_cbranch_vccnz L_pa_f2
L_pa_c2:
  v_mfma_f32_32x32x16_bf16 v[128:143], a[8:11], v[72:75], v[128:143]
  buffer_load_dwordx4 v[72:75], v4, s[8:11], s60 offen offset:2048 sc1
  s_waitcnt vmcnt(15)
  v_and_b32 v31, 1, v76
  v_cmp_ne_u32 vcc, 1, v31
  s_cbranch_vccnz L_pa_f3
L_pa_c3:
  v_mfma_f32_32x32x16_bf16 v[128:143], a[12:15], v[76:79], v[128:143]
  buffer_load_dwordx4 v[76:79], v4, s[8:11], s60 offen offset:3072 sc1
  s_waitcnt vmcnt(15)
  v_and_b32 v31, 1, v80
  v_cmp_ne_u32 vcc, 1, v31
  s_cbranch_vccnz L_pa_f4
L_pa_c4:
  v_mfma_f32_32x32x16_bf16 v[128:143], a[16:19], v[80:83], v[128:143]
  s_add_u32 s60, s60, 4096
  buffer_load_dwordx4 v[80:83], v4, s[8:11], s60 offen offset:0 sc1
  s_waitcnt vmcnt(15)
  v_and_b32 v31, 1, v84
  v_cmp_ne_u32 vcc, 1, v31
  s_cbranch_vccnz L_pa_f5
L_pa_c5:
  v_mfma_f32_32x32x16_bf16 v[128:143], a[20:23], v[84:87], v[128:143]
  buffer_load_dwordx4 v[84:87], v4, s[8:11], s60 offen offset:1024 sc1
  s_waitcnt vmcnt(15)
  v_and_b32 v31, 1, v88
  v_cmp_ne_u32 vcc, 1, v31
  s_cbranch_vccnz L_pa_f6
L_pa_c6:
  v_mfma_f32_32x32x16_bf16 v[128:143], a[24:27], v[88:91], v[128:143]
  buffer_load_dwordx4 v[88:91], v4, s[8:11], s60 offen offset:2048 sc1
  s_waitcnt vmcnt(15)
  v_and_b32 v31, 1, v92
  v_cmp_ne_u32 vcc, 1, v31
  s_cbranch_vccnz L_pa_f7
L_pa_c7:
  v_mfma_f32_32x32x16_bf16 v[128:143], a[28:31], v[92:95], v[128:143]
  buffer_load_dwordx4 v[92:95], v4, s[8:11], s60 offen offset:3072 sc1
  s_waitcnt vmcnt(15)
  v_and_b32 v31, 1, v96
  v_cmp_ne_u32 vcc, 1, v31
  s_cbranch_vccnz L_pa_f8
L_pa_c8:
  v_mfma_f32_32x32x16_bf16 v[128:143], a[32:35], v[96:99], v[128:143]
  s_add_u32 s60, s60, 4096
  buffer_load_dwordx4 v[96:99], v4, s[8:11], s60 offen offset:0 sc1
  s_waitcnt vmcnt(15)
  v_and_b32 v31, 1, v100
  v_cmp_ne_u32 vcc, 1, v31
  s_cbranch_vccnz L_pa_f9
L_pa_c9:
  v_mfma_f32_32x32x16_bf16 v[128:143], a[36:39], v[100:103], v[128:143]
  buffer_load_dwordx4 v[100:103], v4, s[8:11], s60 offen offset:1024 sc1
  s_waitcnt vmcnt(15)
  v_and_b32 v31, 1, v104
  v_cmp_ne_u32 vcc, 1, v31
  s_cbranch_vccnz L_pa_f10
L_pa_c10:
  v_mfma_f32_32x32x16_bf16 v[128:143], a[40:43], v[104:107], v[128:143]
  buffer_load_dwordx4 v[104:107], v4, s[8:11], s60 offen offset:2048 sc1
  s_waitcnt vmcnt(15)
  v_and_b32 v31, 1, v108
  v_cmp_ne_u32 vcc, 1, v31
  s_cbranch_vccnz L_pa_f11
L_pa_c11:
  v_mfma_f32_32x32x16_bf16 v[128:143], a[44:47], v[108:111], v[128:143]
  buffer_load_dwordx4 v[108:111], v4, s[8:11], s60 offen offset:3072 sc1
  s_waitcnt vmcnt(15)
  v_and_b32 v31, 1, v112
  v_cmp_ne_u32 vcc, 1, v31
  s_cbranch_vccnz L_pa_f12
L_pa_c12:
  v_mfma_f32_32x32x16_bf16 v[128:143], a[48:51], v[112:115], v[128:143]
  s_add_u32 s60, s60, 4096
  buffer_load_dwordx4 v[112:115], v4, s[8:11], s60 offen offset:0 sc1
  s_waitcnt vmcnt(15)
  v_and_b32 v31, 1, v116
  v_cmp_ne_u32 vcc, 1, v31
  s_cbranch_vccnz L_pa_f13
L_pa_c13:
  v_mfma_f32_32x32x16_bf16 v[128:143], a[52:55], v[116:119], v[128:143]
  buffer_load_dwordx4 v[116:119], v4, s[8:11], s60 offen offset:1024 sc1
  s_waitcnt vmcnt(15)
  v_and_b32 v31, 1, v120
  v_cmp_ne_u32 vcc, 1, v31
  s_cbranch_vccnz L_pa_f14
L_pa_c14:
  v_mfma_f32_32x32x16_bf16 v[128:143], a[56:59], v[120:123], v[128:143]
  buffer_load_dwordx4 v[120:123], v4, s[8:11], s60 offen offset:2048 sc1
  s_waitcnt vmcnt(15)
  v_and_b32 v31, 1, v124
  v_cmp_ne_u32 vcc, 1, v31
  s_cbranch_vccnz L_pa_f15
L_pa_c15:
  v_mfma_f32_32x32x16_bf16 v[128:143], a[60:63], v[124:127], v[128:143]
  buffer_load_dwordx4 v[124:127], v4, s[8:11], s60 offen offset:3072 sc1
  s_waitcnt vmcnt(15)
  v_and_b32 v31, 1, v64
  v_cmp_ne_u32 vcc, 1, v31
  s_cbranch_vccnz L_pa_f16
L_pa_c16:
  v_mfma_f32_32x32x16_bf16 v[128:143], a[64:67], v[64:67], v[128:143]
  s_add_u32 s60, s60, 4096
  buffer_load_dwordx4 v[64:67], v4, s[8:11], s60 offen offset:0 sc1
  s_waitcnt vmcnt(15)
  v_and_b32 v31, 1, v68
  v_cmp_ne_u32 vcc, 1, v31
  s_cbranch_vccnz L_pa_f17
L_pa_c17:
  v_mfma_f32_32x32x16_bf16 v[128:143], a[68:71], v[68:71], v[128:143]
  buffer_load_dwordx4 v[68:71], v4, s[8:11], s60 offen offset:1024 sc1
  s_waitcnt vmcnt(15)
  v_and_b32 v31, 1, v72
  v_cmp_ne_u32 vcc, 1, v31
  s_cbranch_vccnz L_pa_f18
L_pa_c18:
  v_mfma_f32_32x32x16_bf16 v[128:143], a[72:75], v[72:75], v[128:143]
  buffer_load_dwordx4 v[72:75], v4, s[8:11], s60 offen offset:2048 sc1
  s_waitcnt vmcnt(15)
  v_and_b32 v31, 1, v76
  v_cmp_ne_u32 vcc, 1, v31
  s_cbranch_vccnz L_pa_f19
L_pa_c19:
  v_mfma_f32_32x32x16_bf16 v[128:143], a[76:79], v[76:79], v[128:143]
  buffer_load_dwordx4 v[76:79], v4, s[8:11], s60 offen offset:3072 sc1
  s_waitcnt vmcnt(15)
  v_and_b32 v31, 1, v80
  v_cmp_ne_u32 vcc, 1, v31
  s_cbranch_vccnz L_pa_f20
L_pa_c20:
  v_mfma_f32_32x32x16_bf16 v[128:143], a[80:83], v[80:83], v[128:143]
  s_add_u32 s60, s60, 4096
  buffer_load_dwordx4 v[80:83], v4, s[8:11], s60 offen offset:0 sc1
  s_waitcnt vmcnt(15)
  v_and_b32 v31, 1, v84
  v_cmp_ne_u32 vcc, 1, v31
  s_cbranch_vccnz L_pa_f21
L_pa_c21:
  v_mfma_f32_32x32x16_bf16 v[128:143], a[84:87], v[84:87], v[128:143]
  buffer_load_dwordx4 v[84:87], v4, s[8:11], s60 offen offset:1024 sc1
  s_waitcnt vmcnt(15)
  v_and_b32 v31, 1, v88
  v_cmp_ne_u32 vcc, 1, v31
  s_cbranch_vccnz L_pa_f22
L_pa_c22:
  v_mfma_f32_32x32x16_bf16 v[128:143], a[88:91], v[88:91], v[128:143]
  buffer_load_dwordx4 v[88:91], v4, s[8:11], s60 offen offset:2048 sc1
  s_waitcnt vmcnt(15)
  v_and_b32 v31, 1, v92
  v_cmp_ne_u32 vcc, 1, v31
  s_cbranch_vccnz L_pa_f23
L_pa_c23:
  v_mfma_f32_32x32x16_bf16 v[128:143], a[92:95], v[92:95], v[128:143]
  buffer_load_dwordx4 v[92:95], v4, s[8:11], s60 offen offset:3072 sc1
  s_waitcnt vmcnt(15)
  v_and_b32 v31, 1, v96
  v_cmp_ne_u32 vcc, 1, v31
  s_cbranch_vccnz L_pa_f24
L_pa_c24:
  v_mfma_f32_32x32x16_bf16 v[128:143], a[96:99], v[96:99], v[128:143]
  s_add_u32 s60, s60, 4096
  buffer_load_dwordx4 v[96:99], v4, s[8:11], s60 offen offset:0 sc1
  s_waitcnt vmcnt(15)
  v_and_b32 v31, 1, v100
  v_cmp_ne_u32 vcc, 1, v31
  s_cbranch_vccnz L_pa_f25
L_pa_c25:
  v_mfma_f32_32x32x16_bf16 v[128:143], a[100:103], v[100:103], v[128:143]
  buffer_load_dwordx4 v[100:103], v4, s[8:11], s60 offen offset:1024 sc1
  s_waitcnt vmcnt(15)
  v_and_b32 v31, 1, v104
  v_cmp_ne_u32 vcc, 1, v31
  s_cbranch_vccnz L_pa_f26
L_pa_c26:
  v_mfma_f32_32x32x16_bf16 v[128:143], a[104:107], v[104:107], v[128:143]
  buffer_load_dwordx4 v[104:107], v4, s[8:11], s60 offen offset:2048 sc1
  s_waitcnt vmcnt(15)
  v_and_b32 v31, 1, v108
  v_cmp_ne_u32 vcc, 1, v31
  s_cbranch_vccnz L_pa_f27
L_pa_c27:
  v_mfma_f32_32x32x16_bf16 v[128:143], a[108:111], v[108:111], v[128:143]
  buffer_load_dwordx4 v[108:111], v4, s[8:11], s60 offen offset:3072 sc1
  s_waitcnt vmcnt(15)
  v_and_b32 v31, 1, v112
  v_cmp_ne_u32 vcc, 1, v31
  s_cbranch_vccnz L_pa_f28
L_pa_c28:
  v_mfma_f32_32x32x16_bf16 v[128:143], a[112:115], v[112:115], v[128:143]
  s_add_u32 s60, s60, 4096
  buffer_load_dwordx4 v[112:115], v4, s[8:11], s60 offen offset:0 sc1
  s_waitcnt vmcnt(15)
  v_and_b32 v31, 1, v116
  v_cmp_ne_u32 vcc, 1, v31
  s_cbranch_vccnz L_pa_f29
L_pa_c29:
  v_mfma_f32_32x32x16_bf16 v[128:143], a[116:119], v[116:119], v[128:143]
  buffer_load_dwordx4 v[116:119], v4, s[8:11], s60 offen offset:1024 sc1
  s_waitcnt vmcnt(15)
  v_and_b32 v31, 1, v120
  v_cmp_ne_u32 vcc, 1, v31
  s_cbranch_vccnz L_pa_f30
L_pa_c30:
  v_mfma_f32_32x32x16_bf16 v[128:143], a[120:123], v[120:123], v[128:143]
  buffer_load_dwordx4 v[120:123], v4, s[8:11], s60 offen offset:2048 sc1
  s_waitcnt vmcnt(15)
  v_and_b32 v31, 1, v124
  v_cmp_ne_u32 vcc, 1, v31
  s_cbranch_vccnz L_pa_f31
L_pa_c31:
  v_mfma_f32_32x32x16_bf16 v[128:143], a[124:127], v[124:127], v[128:143]
  buffer_load_dwordx4 v[124:127], v4, s[8:11], s60 offen offset:3072 sc1
  s_waitcnt vmcnt(15)
  v_and_b32 v31, 1, v64
  v_cmp_ne_u32 vcc, 1, v31
  s_cbranch_vccnz L_pa_f32
L_pa_c32:
  v_mfma_f32_32x32x16_bf16 v[128:143], a[128:131], v[64:67], v[128:143]
  s_add_u32 s60, s60, 4096
  buffer_load_dwordx4 v[64:67], v4, s[8:11], s60 offen offset:0 sc1
  s_waitcnt vmcnt(15)
  v_and_b32 v31, 1, v68
  v_cmp_ne_u32 vcc, 1, v31
  s_cbranch_vccnz L_pa_f33
L_pa_c33:
  v_mfma_f32_32x32x16_bf16 v[128:143], a[132:135], v[68:71], v[128:143]
  buffer_load_dwordx4 v[68:71], v4, s[8:11], s60 offen offset:1024 sc1
  s_waitcnt vmcnt(15)
  v_and_b32 v31, 1, v72
  v_cmp_ne_u32 vcc, 1, v31
  s_cbranch_vccnz L_pa_f34
L_pa_c34:
  v_mfma_f32_32x32x16_bf16 v[128:143], a[136:139], v[72:75], v[128:143]
  buffer_load_dwordx4 v[72:75], v4, s[8:11], s60 offen offset:2048 sc1
  s_waitcnt vmcnt(15)
  v_and_b32 v31, 1, v76
  v_cmp_ne_u32 vcc, 1, v31
  s_cbranch_vccnz L_pa_f35
L_pa_c35:
  v_mfma_f32_32x32x16_bf16 v[128:143], a[140:143], v[76:79], v[128:143]
  buffer_load_dwordx4 v[76:79], v4, s[8:11], s60 offen offset:3072 sc1
  s_waitcnt vmcnt(15)
  v_and_b32 v31, 1, v80
  v_cmp_ne_u32 vcc, 1, v31
  s_cbranch_vccnz L_pa_f36
L_pa_c36:
  v_mfma_f32_32x32x16_bf16 v[128:143], a[144:147], v[80:83], v[128:143]
  s_add_u32 s60, s60, 4096
  buffer_load_dwordx4 v[80:83], v4, s[8:11], s60 offen offset:0 sc1
  s_waitcnt vmcnt(15)
  v_and_b32 v31, 1, v84
  v_cmp_ne_u32 vcc, 1, v31
  s_cbranch_vccnz L_pa_f37
L_pa_c37:
  v_mfma_f32_32x32x16_bf16 v[128:143], a[148:151], v[84:87], v[128:143]
  buffer_load_dwordx4 v[84:87], v4, s[8:11], s60 offen offset:1024 sc1
  s_waitcnt vmcnt(15)
  v_and_b32 v31, 1, v88
  v_cmp_ne_u32 vcc, 1, v31
  s_cbranch_vccnz L_pa_f38
L_pa_c38:
  v_mfma_f32_32x32x16_bf16 v[128:143], a[152:155], v[88:91], v[128:143]
  buffer_load_dwordx4 v[88:91], v4, s[8:11], s60 offen offset:2048 sc1
  s_waitcnt vmcnt(15)
  v_and_b32 v31, 1, v92
  v_cmp_ne_u32 vcc, 1, v31
  s_cbranch_vccnz L_pa_f39
L_pa_c39:
  v_mfma_f32_32x32x16_bf16 v[128:143], a[156:159], v[92:95], v[128:143]
  buffer_load_dwordx4 v[92:95], v4, s[8:11], s60 offen offset:3072 sc1
  s_waitcnt vmcnt(15)
  v_and_b32 v31, 1, v96
  v_cmp_ne_u32 vcc, 1, v31
  s_cbranch_vccnz L_pa_f40
L_pa_c40:
  v_mfma_f32_32x32x16_bf16 v[128:143], a[160:163], v[96:99], v[128:143]
  s_add_u32 s60, s60, 4096
  buffer_load_dwordx4 v[96:99], v4, s[8:11], s60 offen offset:0 sc1
  s_waitcnt vmcnt(15)
  v_and_b32 v31, 1, v100
  v_cmp_ne_u32 vcc, 1, v31
  s_cbranch_vccnz L_pa_f41
L_pa_c41:
  v_mfma_f32_32x32x16_bf16 v[128:143], a[164:167], v[100:103], v[128:143]
  buffer_load_dwordx4 v[100:103], v4, s[8:11], s60 offen offset:1024 sc1
  s_waitcnt vmcnt(15)
  v_and_b32 v31, 1, v104
  v_cmp_ne_u32 vcc, 1, v31
  s_cbranch_vccnz L_pa_f42
L_pa_c42:
  v_mfma_f32_32x32x16_bf16 v[128:143], a[168:171], v[104:107], v[128:143]
  buffer_load_dwordx4 v[104:107], v4, s[8:11], s60 offen offset:2048 sc1
  s_waitcnt vmcnt(15)
  v_and_b32 v31, 1, v108
  v_cmp_ne_u32 vcc, 1, v31
  s_cbranch_vccnz L_pa_f43
L_pa_c43:
  v_mfma_f32_32x32x16_bf16 v[128:143], a[172:175], v[108:111], v[128:143]
  buffer_load_dwordx4 v[108:111], v4, s[8:11], s60 offen offset:3072 sc1
  s_waitcnt vmcnt(15)
  v_and_b32 v31, 1, v112
  v_cmp_ne_u32 vcc, 1, v31
  s_cbranch_vccnz L_pa_f44
L_pa_c44:
  v_mfma_f32_32x32x16_bf16 v[128:143], a[176:179], v[112:115], v[128:143]
  s_add_u32 s60, s60, 4096
  buffer_load_dwordx4 v[112:115], v4, s[8:11], s60 offen offset:0 sc1
  s_waitcnt vmcnt(15)
  v_and_b32 v31, 1, v116
  v_cmp_ne_u32 vcc, 1, v31
  s_cbranch_vccnz L_pa_f45
L_pa_c45:
  v_mfma_f32_32x32x16_bf16 v[128:143], a[180:183], v[116:119], v[128:143]
  buffer_load_dwordx4 v[116:119], v4, s[8:11], s60 offen offset:1024 sc1
  s_waitcnt vmcnt(15)
  v_and_b32 v31, 1, v120
  v_cmp_ne_u32 vcc, 1, v31
  s_cbranch_vccnz L_pa_f46
L_pa_c46:
  v_mfma_f32_32x32x16_bf16 v[128:143], a[184:187], v[120:123], v[128:143]
  buffer_load_dwordx4 v[120:123], v4, s[8:11], s60 offen offset:2048 sc1
  s_waitcnt vmcnt(15)
  v_and_b32 v31, 1, v124
  v_cmp_ne_u32 vcc, 1, v31
  s_cbranch_vccnz L_pa_f47
L_pa_c47:
  v_mfma_f32_32x32x16_bf16 v[128:143], a[188:191], v[124:127], v[128:143]
  buffer_load_dwordx4 v[124:127], v4, s[8:11], s60 offen offset:3072 sc1
  s_waitcnt vmcnt(15)
  v_and_b32 v31, 1, v64
  v_cmp_ne_u32 vcc, 1, v31
  s_cbranch_vccnz L_pa_f48
L_pa_c48:
  v_mfma_f32_32x32x16_bf16 v[128:143], a[192:195], v[64:67], v[128:143]
  s_waitcnt vmcnt(14)
  v_and_b32 v31, 1, v68
  v_cmp_ne_u32 vcc, 1, v31
  s_cbranch_vccnz L_pa_f49
L_pa_c49:
  v_mfma_f32_32x32x16_bf16 v[128:143], a[196:199], v[68:71], v[128:143]
  s_waitcnt vmcnt(13)
  v_and_b32 v31, 1, v72
  v_cmp_ne_u32 vcc, 1, v31
  s_cbranch_vccnz L_pa_f50
L_pa_c50:
  v_mfma_f32_32x32x16_bf16 v[128:143], a[200:203], v[72:75], v[128:143]
  s_waitcnt vmcnt(12)
  v_and_b32 v31, 1, v76
  v_cmp_ne_u32 vcc, 1, v31
  s_cbranch_vccnz L_pa_f51
L_pa_c51:
  v_mfma_f32_32x32x16_bf16 v[128:143], a[204:207], v[76:79], v[128:143]
  s_waitcnt vmcnt(11)
  v_and_b32 v31, 1, v80
  v_cmp_ne_u32 vcc, 1, v31
  s_cbranch_vccnz L_pa_f52
L_pa_c52:
  v_mfma_f32_32x32x16_bf16 v[128:143], a[208:211], v[80:83], v[128:143]
  s_waitcnt vmcnt(10)
  v_and_b32 v31, 1, v84
  v_cmp_ne_u32 vcc, 1, v31
  s_cbranch_vccnz L_pa_f53
L_pa_c53:
  v_mfma_f32_32x32x16_bf16 v[128:143], a[212:215], v[84:87], v[128:143]
  s_waitcnt vmcnt(9)
  v_and_b32 v31, 1, v88
  v_cmp_ne_u32 vcc, 1, v31
  s_cbranch_vccnz L_pa_f54
L_pa_c54:
  v_mfma_f32_32x32x16_bf16 v[128:143], a[216:219], v[88:91], v[128:143]
  s_waitcnt vmcnt(8)
  v_and_b32 v31, 1, v92
  v_cmp_ne_u32 vcc, 1, v31
  s_cbranch_vccnz L_pa_f55
L_pa_c55:
  v_mfma_f32_32x32x16_bf16 v[128:143], a[220:223], v[92:95], v[128:143]
  s_waitcnt vmcnt(7)
  v_and_b32 v31, 1, v96
  v_cmp_ne_u32 vcc, 1, v31
  s_cbranch_vccnz L_pa_f56
L_pa_c56:
  v_mfma_f32_32x32x16_bf16 v[128:143], a[224:227], v[96:99], v[128:143]
  s_waitcnt vmcnt(6)
  v_and_b32 v31, 1, v100
  v_cmp_ne_u32 vcc, 1, v31
  s_cbranch_vccnz L_pa_f57
L_pa_c57:
  v_mfma_f32_32x32x16_bf16 v[128:143], a[228:231], v[100:103], v[128:143]
  s_waitcnt vmcnt(5)
  v_and_b32 v31, 1, v104
  v_cmp_ne_u32 vcc, 1, v31
  s_cbranch_vccnz L_pa_f58
L_pa_c58:
  v_mfma_f32_32x32x16_bf16 v[128:143], a[232:235], v[104:107], v[128:143]
  s_waitcnt vmcnt(4)
  v_and_b32 v31, 1, v108
  v_cmp_ne_u32 vcc, 1, v31
  s_cbranch_vccnz L_pa_f59
L_pa_c59:
  v_mfma_f32_32x32x16_bf16 v[128:143], a[236:239], v[108:111], v[128:143]
  s_waitcnt vmcnt(3)
  v_and_b32 v31, 1, v112
  v_cmp_ne_u32 vcc, 1, v31
  s_cbranch_vccnz L_pa_f60
L_pa_c60:
  v_mfma_f32_32x32x16_bf16 v[128:143], a[240:243], v[112:115], v[128:143]
  s_waitcnt vmcnt(2)
  v_and_b32 v31, 1, v116
  v_cmp_ne_u32 vcc, 1, v31
  s_cbranch_vccnz L_pa_f61
L_pa_c61:
  v_mfma_f32_32x32x16_bf16 v[128:143], a[244:247], v[116:119], v[128:143]
  s_waitcnt vmcnt(1)
  v_and_b32 v31, 1, v120
  v_cmp_ne_u32 vcc, 1, v31
  s_cbranch_vccnz L_pa_f62
L_pa_c62:
  v_mfma_f32_32x32x16_bf16 v[128:143], a[248:251], v[120:123], v[128:143]
  s_waitcnt vmcnt(0)
  v_and_b32 v31, 1, v124
  v_cmp_ne_u32 vcc, 1, v31
  s_cbranch_vccnz L_pa_f63
L_pa_c63:
  v_mfma_f32_32x32x16_bf16 v[128:143], a[252:255], v[124:127], v[128:143]
  s_mul_i32 s62, s61, 36864
  s_add_u32 s61, s61, 7
  s_cmp_ge_u32 s61, 64
  s_cbranch_scc1 L_pa_last
  s_lshl_b32 s29, s61, 7
  s_add_u32 s30, s29, 1441792
  s_add_u32 s29, s29, 1384448
  s_lshl_b32 s31, s22, 10
  s_add_u32 s31, s31, 1376256
  buffer_load_dword v28, off, s[8:11], s29 sc1
  buffer_load_dword v29, off, s[8:11], s31 sc1
  buffer_load_dword v32, v7, s[8:11], s30 offen sc1
L_pa_last:
  s_nop 7
  v_add_u32 v20, s66, v5
  v_add_u32 v21, s66, v6
  ds_write_b128 v20, v[128:131] offset:0
  ds_write_b128 v20, v[132:135] offset:1024
  ds_write_b128 v20, v[136:139] offset:2048
  ds_write_b128 v20, v[140:143] offset:3072
  s_waitcnt lgkmcnt(0)
  s_barrier
  ds_read_b128 v[144:147], v21 offset:0
  ds_read_b128 v[148:151], v21 offset:4096
  ds_read_b128 v[152:155], v21 offset:8192
  ds_read_b128 v[156:159], v21 offset:12288
  s_xor_b32 s66, s66, 16384
  s_waitcnt lgkmcnt(0)
  v_add_f32 v144, v144, v148
  v_add_f32 v152, v152, v156
  v_add_f32 v145, v145, v149
  v_add_f32 v153, v153, v157
  v_add_f32 v146, v146, v150
  v_add_f32 v154, v154, v158
  v_add_f32 v147, v147, v151
  v_add_f32 v155, v155, v159
  v_add_f32 v144, v144, v152
  v_add_f32 v145, v145, v153
  v_add_f32 v146, v146, v154
  v_add_f32 v147, v147, v155
  v_sub_f32 v144, v144, v24
  v_sub_f32 v145, v145, v25
  v_sub_f32 v146, v146, v26
  v_sub_f32 v147, v147, v27
  v_fma_f32 v144, v144, v30, v24
  v_fma_f32 v145, v145, v30, v25
  v_fma_f32 v146, v146, v30, v26
  v_fma_f32 v147, v147, v30, v27
  v_cvt_pk_bf16_f32 v144, v144, v145
  v_cvt_pk_bf16_f32 v145, v146, v147
  buffer_store_dwordx2 v[144:145], v8, s[76:79], s62 offen
  s_add_u32 s64, s64, 4096
  s_cmp_lt_u32 s61, 64
  s_cbranch_scc1 L_pa_loop
  s_waitcnt vmcnt(0)
  s_waitcnt vmcnt(0)
  s_endpgm
L_pa_f0:
  s_add_u32 s29, s63, 0
  buffer_load_dwordx4 v[64:67], v4, s[8:11], s29 offen offset:0 sc1
  buffer_load_dwordx4 v[68:71], v4, s[8:11], s29 offen offset:1024 sc1
  buffer_load_dwordx4 v[72:75], v4, s[8:11], s29 offen offset:2048 sc1
  buffer_load_dwordx4 v[76:79], v4, s[8:11], s29 offen offset:3072 sc1
  s_add_u32 s29, s29, 4096
  buffer_load_dwordx4 v[80:83], v4, s[8:11], s29 offen offset:0 sc1
  buffer_load_dwordx4 v[84:87], v4, s[8:11], s29 offen offset:1024 sc1
  buffer_load_dwordx4 v[88:91], v4, s[8:11], s29 offen offset:2048 sc1
  buffer_load_dwordx4 v[92:95], v4, s[8:11], s29 offen offset:3072 sc1
  s_add_u32 s29, s29, 4096
  buffer_load_dwordx4 v[96:99], v4, s[8:11], s29 offen offset:0 sc1
  buffer_load_dwordx4 v[100:103], v4, s[8:11], s29 offen offset:1024 sc1
  buffer_load_dwordx4 v[104:107], v4, s[8:11], s29 offen offset:2048 sc1
  buffer_load_dwordx4 v[108:111], v4, s[8:11], s29 offen offset:3072 sc1
  s_add_u32 s29, s29, 4096
  buffer_load_dwordx4 v[112:115], v4, s[8:11], s29 offen offset:0 sc1
  buffer_load_dwordx4 v[116:119], v4, s[8:11], s29 offen offset:1024 sc1
  buffer_load_dwordx4 v[120:123], v4, s[8:11], s29 offen offset:2048 sc1
  buffer_load_dwordx4 v[124:127], v4, s[8:11], s29 offen offset:3072 sc1
  s_add_u32 s34, s34, 1
  s_cmp_gt_u32 s34, 131072
  s_cbranch_scc1 L_abort
  s_waitcnt vmcnt(15)
  v_and_b32 v31, 1, v64
  v_cmp_ne_u32 vcc, 1, v31
  s_cbranch_vccnz L_pa_f0
  s_branch L_pa_c0
L_pa_f1:
  s_add_u32 s29, s63, 1024
  buffer_load_dwordx4 v[68:71], v4, s[8:11], s29 offen offset:0 sc1
  buffer_load_dwordx4 v[72:75], v4, s[8:11], s29 offen offset:1024 sc1
  buffer_load_dwordx4 v[76:79], v4, s[8:11], s29 offen offset:2048 sc1
  buffer_load_dwordx4 v[80:83], v4, s[8:11], s29 offen offset:3072 sc1
  s_add_u32 s34, s34, 1
  s_cmp_gt_u32 s34, 131072
  s_cbranch_scc1 L_abort
  s_waitcnt vmcnt(3)
  v_and_b32 v31, 1, v68
  v_cmp_ne_u32 vcc, 1, v31
  s_cbranch_vccnz L_pa_f1
  s_branch L_pa_c1
L_pa_f2:
  s_add_u32 s29, s63, 2048
  buffer_load_dwordx4 v[72:75], v4, s[8:11], s29 offen offset:0 sc1
  buffer_load_dwordx4 v[76:79], v4, s[8:11], s29 offen offset:1024 sc1
  buffer_load_dwordx4 v[80:83], v4, s[8:11], s29 offen offset:2048 sc1
  buffer_load_dwordx4 v[84:87], v4, s[8:11], s29 offen offset:3072 sc1
  s_add_u32 s34, s34, 1
  s_cmp_gt_u32 s34, 131072
  s_cbranch_scc1 L_abort
  s_waitcnt vmcnt(3)
  v_and_b32 v31, 1, v72
  v_cmp_ne_u32 vcc, 1, v31
  s_cbranch_vccnz L_pa_f2
  s_branch L_pa_c2
L_pa_f3:
  s_add_u32 s29, s63, 3072
  buffer_load_dwordx4 v[76:79], v4, s[8:11], s29 offen offset:0 sc1
  buffer_load_dwordx4 v[80:83], v4, s[8:11], s29 offen offset:1024 sc1
  buffer_load_dwordx4 v[84:87], v4, s[8:11], s29 offen offset:2048 sc1
  buffer_load_dwordx4 v[88:91], v4, s[8:11], s29 offen offset:3072 sc1
  s_add_u32 s34, s34, 1
  s_cmp_gt_u32 s34, 131072
  s_cbranch_scc1 L_abort
  s_waitcnt vmcnt(3)
  v_and_b32 v31, 1, v76
  v_cmp_ne_u32 vcc, 1, v31
  s_cbranch_vccnz L_pa_f3
  s_branch L_pa_c3
L_pa_f4:
  s_add_u32 s29, s63, 4096
  buffer_load_dwordx4 v[80:83], v4, s[8:11], s29 offen offset:0 sc1
  buffer_load_dwordx4 v[84:87], v4, s[8:11], s29 offen offset:1024 sc1
  buffer_load_dwordx4 v[88:91], v4, s[8:11], s29 offen offset:2048 sc1
  buffer_load_dwordx4 v[92:95], v4, s[8:11], s29 offen offset:3072 sc1
  s_add_u32 s34, s34, 1
  s_cmp_gt_u32 s34, 131072
  s_cbranch_scc1 L_abort
  s_waitcnt vmcnt(3)
  v_and_b32 v31, 1, v80
  v_cmp_ne_u32 vcc, 1, v31
  s_cbranch_vccnz L_pa_f4
  s_branch L_pa_c4
L_pa_f5:
  s_add_u32 s29, s63, 5120
  buffer_load_dwordx4 v[84:87], v4, s[8:11], s29 offen offset:0 sc1
  buffer_load_dwordx4 v[88:91], v4, s[8:11], s29 offen offset:1024 sc1
  buffer_load_dwordx4 v[92:95], v4, s[8:11], s29 offen offset:2048 sc1
  buffer_load_dwordx4 v[96:99], v4, s[8:11], s29 offen offset:3072 sc1
  s_add_u32 s34, s34, 1
  s_cmp_gt_u32 s34, 131072
  s_cbranch_scc1 L_abort
  s_waitcnt vmcnt(3)
  v_and_b32 v31, 1, v84
  v_cmp_ne_u32 vcc, 1, v31
  s_cbranch_vccnz L_pa_f5
  s_branch L_pa_c5
L_pa_f6:
  s_add_u32 s29, s63, 6144
  buffer_load_dwordx4 v[88:91], v4, s[8:11], s29 offen offset:0 sc1
  buffer_load_dwordx4 v[92:95], v4, s[8:11], s29 offen offset:1024 sc1
  buffer_load_dwordx4 v[96:99], v4, s[8:11], s29 offen offset:2048 sc1
  buffer_load_dwordx4 v[100:103], v4, s[8:11], s29 offen offset:3072 sc1
  s_add_u32 s34, s34, 1
  s_cmp_gt_u32 s34, 131072
  s_cbranch_scc1 L_abort
  s_waitcnt vmcnt(3)
  v_and_b32 v31, 1, v88
  v_cmp_ne_u32 vcc, 1, v31
  s_cbranch_vccnz L_pa_f6
  s_branch L_pa_c6
L_pa_f7:
  s_add_u32 s29, s63, 7168
  buffer_load_dwordx4 v[92:95], v4, s[8:11], s29 offen offset:0 sc1
  buffer_load_dwordx4 v[96:99], v4, s[8:11], s29 offen offset:1024 sc1
  buffer_load_dwordx4 v[100:103], v4, s[8:11], s29 offen offset:2048 sc1
  buffer_load_dwordx4 v[104:107], v4, s[8:11], s29 offen offset:3072 sc1
  s_add_u32 s34, s34, 1
  s_cmp_gt_u32 s34, 131072
  s_cbranch_scc1 L_abort
  s_waitcnt vmcnt(3)
  v_and_b32 v31, 1, v92
  v_cmp_ne_u32 vcc, 1, v31
  s_cbranch_vccnz L_pa_f7
  s_branch L_pa_c7
L_pa_f8:
  s_add_u32 s29, s63, 8192
  buffer_load_dwordx4 v[96:99], v4, s[8:11], s29 offen offset:0 sc1
  buffer_load_dwordx4 v[100:103], v4, s[8:11], s29 offen offset:1024 sc1
  buffer_load_dwordx4 v[104:107], v4, s[8:11], s29 offen offset:2048 sc1
  buffer_load_dwordx4 v[108:111], v4, s[8:11], s29 offen offset:3072 sc1
  s_add_u32 s29, s29, 4096
  buffer_load_dwordx4 v[112:115], v4, s[8:11], s29 offen offset:0 sc1
  buffer_load_dwordx4 v[116:119], v4, s[8:11], s29 offen offset:1024 sc1
  buffer_load_dwordx4 v[120:123], v4, s[8:11], s29 offen offset:2048 sc1
  buffer_load_dwordx4 v[124:127], v4, s[8:11], s29 offen offset:3072 sc1
  s_add_u32 s29, s29, 4096
  buffer_load_dwordx4 v[64:67], v4, s[8:11], s29 offen offset:0 sc1
  buffer_load_dwordx4 v[68:71], v4, s[8:11], s29 offen offset:1024 sc1
  buffer_load_dwordx4 v[72:75], v4, s[8:11], s29 offen offset:2048 sc1
  buffer_load_dwordx4 v[76:79], v4, s[8:11], s29 offen offset:3072 sc1
  s_add_u32 s29, s29, 4096
  buffer_load_dwordx4 v[80:83], v4, s[8:11], s29 offen offset:0 sc1
  buffer_load_dwordx4 v[84:87], v4, s[8:11], s29 offen offset:1024 sc1
  buffer_load_dwordx4 v[88:91], v4, s[8:11], s29 offen offset:2048 sc1
  buffer_load_dwordx4 v[92:95], v4, s[8:11], s29 offen offset:3072 sc1
  s_add_u32 s34, s34, 1
  s_cmp_gt_u32 s34, 131072
  s_cbranch_scc1 L_abort
  s_waitcnt vmcnt(15)
  v_and_b32 v31, 1, v96
  v_cmp_ne_u32 vcc, 1, v31
  s_cbranch_vccnz L_pa_f8
  s_branch L_pa_c8
L_pa_f9:
  s_add_u32 s29, s63, 9216
  buffer_load_dwordx4 v[100:103], v4, s[8:11], s29 offen offset:0 sc1
  buffer_load_dwordx4 v[104:107], v4, s[8:11], s29 offen offset:1024 sc1
  buffer_load_dwordx4 v[108:111], v4, s[8:11], s29 offen offset:2048 sc1
  buffer_load_dwordx4 v[112:115], v4, s[8:11], s29 offen offset:3072 sc1
  s_add_u32 s34, s34, 1
  s_cmp_gt_u32 s34, 131072
  s_cbranch_scc1 L_abort
  s_waitcnt vmcnt(3)
  v_and_b32 v31, 1, v100
  v_cmp_ne_u32 vcc, 1, v31
  s_cbranch_vccnz L_pa_f9
  s_branch L_pa_c9
L_pa_f10:
  s_add_u32 s29, s63, 10240
  buffer_load_dwordx4 v[104:107], v4, s[8:11], s29 offen offset:0 sc1
  buffer_load_dwordx4 v[108:111], v4, s[8:11], s29 offen offset:1024 sc1
  buffer_load_dwordx4 v[112:115], v4, s[8:11], s29 offen offset:2048 sc1
  buffer_load_dwordx4 v[116:119], v4, s[8:11], s29 offen offset:3072 sc1
  s_add_u32 s34, s34, 1
  s_cmp_gt_u32 s34, 131072
  s_cbranch_scc1 L_abort
  s_waitcnt vmcnt(3)
  v_and_b32 v31, 1, v104
  v_cmp_ne_u32 vcc, 1, v31
  s_cbranch_vccnz L_pa_f10
  s_branch L_pa_c10
L_pa_f11:
  s_add_u32 s29, s63, 11264
  buffer_load_dwordx4 v[108:111], v4, s[8:11], s29 offen offset:0 sc1
  buffer_load_dwordx4 v[112:115], v4, s[8:11], s29 offen offset:1024 sc1
  buffer_load_dwordx4 v[116:119], v4, s[8:11], s29 offen offset:2048 sc1
  buffer_load_dwordx4 v[120:123], v4, s[8:11], s29 offen offset:3072 sc1
  s_add_u32 s34, s34, 1
  s_cmp_gt_u32 s34, 131072
  s_cbranch_scc1 L_abort
  s_waitcnt vmcnt(3)
  v_and_b32 v31, 1, v108
  v_cmp_ne_u32 vcc, 1, v31
  s_cbranch_vccnz L_pa_f11
  s_branch L_pa_c11
L_pa_f12:
  s_add_u32 s29, s63, 12288
  buffer_load_dwordx4 v[112:115], v4, s[8:11], s29 offen offset:0 sc1
  buffer_load_dwordx4 v[116:119], v4, s[8:11], s29 offen offset:1024 sc1
  buffer_load_dwordx4 v[120:123], v4, s[8:11], s29 offen offset:2048 sc1
  buffer_load_dwordx4 v[124:127], v4, s[8:11], s29 offen offset:3072 sc1
  s_add_u32 s34, s34, 1
  s_cmp_gt_u32 s34, 131072
  s_cbranch_scc1 L_abort
  s_waitcnt vmcnt(3)
  v_and_b32 v31, 1, v112
  v_cmp_ne_u32 vcc, 1, v31
  s_cbranch_vccnz L_pa_f12
  s_branch L_pa_c12
L_pa_f13:
  s_add_u32 s29, s63, 13312
  buffer_load_dwordx4 v[116:119], v4, s[8:11], s29 offen offset:0 sc1
  buffer_load_dwordx4 v[120:123], v4, s[8:11], s29 offen offset:1024 sc1
  buffer_load_dwordx4 v[124:127], v4, s[8:11], s29 offen offset:2048 sc1
  buffer_load_dwordx4 v[64:67], v4, s[8:11], s29 offen offset:3072 sc1
  s_add_u32 s34, s34, 1
  s_cmp_gt_u32 s34, 131072
  s_cbranch_scc1 L_abort
  s_waitcnt vmcnt(3)
  v_and_b32 v31, 1, v116
  v_cmp_ne_u32 vcc, 1, v31
  s_cbranch_vccnz L_pa_f13
  s_branch L_pa_c13
L_pa_f14:
  s_add_u32 s29, s63, 14336
  buffer_load_dwordx4 v[120:123], v4, s[8:11], s29 offen offset:0 sc1
  buffer_load_dwordx4 v[124:127], v4, s[8:11], s29 offen offset:1024 sc1
  buffer_load_dwordx4 v[64:67], v4, s[8:11], s29 offen offset:2048 sc1
  buffer_load_dwordx4 v[68:71], v4, s[8:11], s29 offen offset:3072 sc1
  s_add_u32 s34, s34, 1
  s_cmp_gt_u32 s34, 131072
  s_cbranch_scc1 L_abort
  s_waitcnt vmcnt(3)
  v_and_b32 v31, 1, v120
  v_cmp_ne_u32 vcc, 1, v31
  s_cbranch_vccnz L_pa_f14
  s_branch L_pa_c14
L_pa_f15:
  s_add_u32 s29, s63, 15360
  buffer_load_dwordx4 v[124:127], v4, s[8:11], s29 offen offset:0 sc1
  buffer_load_dwordx4 v[64:67], v4, s[8:11], s29 offen offset:1024 sc1
  buffer_load_dwordx4 v[68:71], v4, s[8:11], s29 offen offset:2048 sc1
  buffer_load_dwordx4 v[72:75], v4, s[8:11], s29 offen offset:3072 sc1
  s_add_u32 s34, s34, 1
  s_cmp_gt_u32 s34, 131072
  s_cbranch_scc1 L_abort
  s_waitcnt vmcnt(3)
  v_and_b32 v31, 1, v124
  v_cmp_ne_u32 vcc, 1, v31
  s_cbranch_vccnz L_pa_f15
  s_branch L_pa_c15
L_pa_f16:
  s_add_u32 s29, s63, 16384
  buffer_load_dwordx4 v[64:67], v4, s[8:11], s29 offen offset:0 sc1
  buffer_load_dwordx4 v[68:71], v4, s[8:11], s29 offen offset:1024 sc1
  buffer_load_dwordx4 v[72:75], v4, s[8:11], s29 offen offset:2048 sc1
  buffer_load_dwordx4 v[76:79], v4, s[8:11], s29 offen offset:3072 sc1
  s_add_u32 s29, s29, 4096
  buffer_load_dwordx4 v[80:83], v4, s[8:11], s29 offen offset:0 sc1
  buffer_load_dwordx4 v[84:87], v4, s[8:11], s29 offen offset:1024 sc1
  buffer_load_dwordx4 v[88:91], v4, s[8:11], s29 offen offset:2048 sc1
  buffer_load_dwordx4 v[92:95], v4, s[8:11], s29 offen offset:3072 sc1
  s_add_u32 s29, s29, 4096
  buffer_load_dwordx4 v[96:99], v4, s[8:11], s29 offen offset:0 sc1
  buffer_load_dwordx4 v[100:103], v4, s[8:11], s29 offen offset:1024 sc1
  buffer_load_dwordx4 v[104:107], v4, s[8:11], s29 offen offset:2048 sc1
  buffer_load_dwordx4 v[108:111], v4, s[8:11], s29 offen offset:3072 sc1
  s_add_u32 s29, s29, 4096
  buffer_load_dwordx4 v[112:115], v4, s[8:11], s29 offen offset:0 sc1
  buffer_load_dwordx4 v[116:119], v4, s[8:11], s29 offen offset:1024 sc1
  buffer_load_dwordx4 v[120:123], v4, s[8:11], s29 offen offset:2048 sc1
  buffer_load_dwordx4 v[124:127], v4, s[8:11], s29 offen offset:3072 sc1
  s_add_u32 s34, s34, 1
  s_cmp_gt_u32 s34, 131072
  s_cbranch_scc1 L_abort
  s_waitcnt vmcnt(15)
  v_and_b32 v31, 1, v64
  v_cmp_ne_u32 vcc, 1, v31
  s_cbranch_vccnz L_pa_f16
  s_branch L_pa_c16
L_pa_f17:
  s_add_u32 s29, s63, 17408
  buffer_load_dwordx4 v[68:71], v4, s[8:11], s29 offen offset:0 sc1
  buffer_load_dwordx4 v[72:75], v4, s[8:11], s29 offen offset:1024 sc1
  buffer_load_dwordx4 v[76:79], v4, s[8:11], s29 offen offset:2048 sc1
  buffer_load_dwordx4 v[80:83], v4, s[8:11], s29 offen offset:3072 sc1
  s_add_u32 s34, s34, 1
  s_cmp_gt_u32 s34, 131072
  s_cbranch_scc1 L_abort
  s_waitcnt vmcnt(3)
  v_and_b32 v31, 1, v68
  v_cmp_ne_u32 vcc, 1, v31
  s_cbranch_vccnz L_pa_f17
  s_branch L_pa_c17
L_pa_f18:
  s_add_u32 s29, s63, 18432
  buffer_load_dwordx4 v[72:75], v4, s[8:11], s29 offen offset:0 sc1
  buffer_load_dwordx4 v[76:79], v4, s[8:11], s29 offen offset:1024 sc1
  buffer_load_dwordx4 v[80:83], v4, s[8:11], s29 offen offset:2048 sc1
  buffer_load_dwordx4 v[84:87], v4, s[8:11], s29 offen offset:3072 sc1
  s_add_u32 s34, s34, 1
  s_cmp_gt_u32 s34, 131072
  s_cbranch_scc1 L_abort
  s_waitcnt vmcnt(3)
  v_and_b32 v31, 1, v72
  v_cmp_ne_u32 vcc, 1, v31
  s_cbranch_vccnz L_pa_f18
  s_branch L_pa_c18
L_pa_f19:
  s_add_u32 s29, s63, 19456
  buffer_load_dwordx4 v[76:79], v4, s[8:11], s29 offen offset:0 sc1
  buffer_load_dwordx4 v[80:83], v4, s[8:11], s29 offen offset:1024 sc1
  buffer_load_dwordx4 v[84:87], v4, s[8:11], s29 offen offset:2048 sc1
  buffer_load_dwordx4 v[88:91], v4, s[8:11], s29 offen offset:3072 sc1
  s_add_u32 s34, s34, 1
  s_cmp_gt_u32 s34, 131072
  s_cbranch_scc1 L_abort
  s_waitcnt vmcnt(3)
  v_and_b32 v31, 1, v76
  v_cmp_ne_u32 vcc, 1, v31
  s_cbranch_vccnz L_pa_f19
  s_branch L_pa_c19
L_pa_f20:
  s_add_u32 s29, s63, 20480
  buffer_load_dwordx4 v[80:83], v4, s[8:11], s29 offen offset:0 sc1
  buffer_load_dwordx4 v[84:87], v4, s[8:11], s29 offen offset:1024 sc1
  buffer_load_dwordx4 v[88:91], v4, s[8:11], s29 offen offset:2048 sc1
  buffer_load_dwordx4 v[92:95], v4, s[8:11], s29 offen offset:3072 sc1
  s_add_u32 s34, s34, 1
  s_cmp_gt_u32 s34, 131072
  s_cbranch_scc1 L_abort
  s_waitcnt vmcnt(3)
  v_and_b32 v31, 1, v80
  v_cmp_ne_u32 vcc, 1, v31
  s_cbranch_vccnz L_pa_f20
  s_branch L_pa_c20
L_pa_f21:
  s_add_u32 s29, s63, 21504
  buffer_load_dwordx4 v[84:87], v4, s[8:11], s29 offen offset:0 sc1
  buffer_load_dwordx4 v[88:91], v4, s[8:11], s29 offen offset:1024 sc1
  buffer_load_dwordx4 v[92:95], v4, s[8:11], s29 offen offset:2048 sc1
  buffer_load_dwordx4 v[96:99], v4, s[8:11], s29 offen offset:3072 sc1
  s_add_u32 s34, s34, 1
  s_cmp_gt_u32 s34, 131072
  s_cbranch_scc1 L_abort
  s_waitcnt vmcnt(3)
  v_and_b32 v31, 1, v84
  v_cmp_ne_u32 vcc, 1, v31
  s_cbranch_vccnz L_pa_f21
  s_branch L_pa_c21
L_pa_f22:
  s_add_u32 s29, s63, 22528
  buffer_load_dwordx4 v[88:91], v4, s[8:11], s29 offen offset:0 sc1
  buffer_load_dwordx4 v[92:95], v4, s[8:11], s29 offen offset:1024 sc1
  buffer_load_dwordx4 v[96:99], v4, s[8:11], s29 offen offset:2048 sc1
  buffer_load_dwordx4 v[100:103], v4, s[8:11], s29 offen offset:3072 sc1
  s_add_u32 s34, s34, 1
  s_cmp_gt_u32 s34, 131072
  s_cbranch_scc1 L_abort
  s_waitcnt vmcnt(3)
  v_and_b32 v31, 1, v88
  v_cmp_ne_u32 vcc, 1, v31
  s_cbranch_vccnz L_pa_f22
  s_branch L_pa_c22
L_pa_f23:
  s_add_u32 s29, s63, 23552
  buffer_load_dwordx4 v[92:95], v4, s[8:11], s29 offen offset:0 sc1
  buffer_load_dwordx4 v[96:99], v4, s[8:11], s29 offen offset:1024 sc1
  buffer_load_dwordx4 v[100:103], v4, s[8:11], s29 offen offset:2048 sc1
  buffer_load_dwordx4 v[104:107], v4, s[8:11], s29 offen offset:3072 sc1
  s_add_u32 s34, s34, 1
  s_cmp_gt_u32 s34, 131072
  s_cbranch_scc1 L_abort
  s_waitcnt vmcnt(3)
  v_and_b32 v31, 1, v92
  v_cmp_ne_u32 vcc, 1, v31
  s_cbranch_vccnz L_pa_f23
  s_branch L_pa_c23
L_pa_f24:
  s_add_u32 s29, s63, 24576
  buffer_load_dwordx4 v[96:99], v4, s[8:11], s29 offen offset:0 sc1
  buffer_load_dwordx4 v[100:103], v4, s[8:11], s29 offen offset:1024 sc1
  buffer_load_dwordx4 v[104:107], v4, s[8:11], s29 offen offset:2048 sc1
  buffer_load_dwordx4 v[108:111], v4, s[8:11], s29 offen offset:3072 sc1
  s_add_u32 s29, s29, 4096
  buffer_load_dwordx4 v[112:115], v4, s[8:11], s29 offen offset:0 sc1
  buffer_load_dwordx4 v[116:119], v4, s[8:11], s29 offen offset:1024 sc1
  buffer_load_dwordx4 v[120:123], v4, s[8:11], s29 offen offset:2048 sc1
  buffer_load_dwordx4 v[124:127], v4, s[8:11], s29 offen offset:3072 sc1
  s_add_u32 s29, s29, 4096
  buffer_load_dwordx4 v[64:67], v4, s[8:11], s29 offen offset:0 sc1
  buffer_load_dwordx4 v[68:71], v4, s[8:11], s29 offen offset:1024 sc1
  buffer_load_dwordx4 v[72:75], v4, s[8:11], s29 offen offset:2048 sc1
  buffer_load_dwordx4 v[76:79], v4, s[8:11], s29 offen offset:3072 sc1
  s_add_u32 s29, s29, 4096
  buffer_load_dwordx4 v[80:83], v4, s[8:11], s29 offen offset:0 sc1
  buffer_load_dwordx4 v[84:87], v4, s[8:11], s29 offen offset:1024 sc1
  buffer_load_dwordx4 v[88:91], v4, s[8:11], s29 offen offset:2048 sc1
  buffer_load_dwordx4 v[92:95], v4, s[8:11], s29 offen offset:3072 sc1
  s_add_u32 s34, s34, 1
  s_cmp_gt_u32 s34, 131072
  s_cbranch_scc1 L_abort
  s_waitcnt vmcnt(15)
  v_and_b32 v31, 1, v96
  v_cmp_ne_u32 vcc, 1, v31
  s_cbranch_vccnz L_pa_f24
  s_branch L_pa_c24
L_pa_f25:
  s_add_u32 s29, s63, 25600
  buffer_load_dwordx4 v[100:103], v4, s[8:11], s29 offen offset:0 sc1
  buffer_load_dwordx4 v[104:107], v4, s[8:11], s29 offen offset:1024 sc1
  buffer_load_dwordx4 v[108:111], v4, s[8:11], s29 offen offset:2048 sc1
  buffer_load_dwordx4 v[112:115], v4, s[8:11], s29 offen offset:3072 sc1
  s_add_u32 s34, s34, 1
  s_cmp_gt_u32 s34, 131072
  s_cbranch_scc1 L_abort
  s_waitcnt vmcnt(3)
  v_and_b32 v31, 1, v100
  v_cmp_ne_u32 vcc, 1, v31
  s_cbranch_vccnz L_pa_f25
  s_branch L_pa_c25
L_pa_f26:
  s_add_u32 s29, s63, 26624
  buffer_load_dwordx4 v[104:107], v4, s[8:11], s29 offen offset:0 sc1
  buffer_load_dwordx4 v[108:111], v4, s[8:11], s29 offen offset:1024 sc1
  buffer_load_dwordx4 v[112:115], v4, s[8:11], s29 offen offset:2048 sc1
  buffer_load_dwordx4 v[116:119], v4, s[8:11], s29 offen offset:3072 sc1
  s_add_u32 s34, s34, 1
  s_cmp_gt_u32 s34, 131072
  s_cbranch_scc1 L_abort
  s_waitcnt vmcnt(3)
  v_and_b32 v31, 1, v104
  v_cmp_ne_u32 vcc, 1, v31
  s_cbranch_vccnz L_pa_f26
  s_branch L_pa_c26
L_pa_f27:
  s_add_u32 s29, s63, 27648
  buffer_load_dwordx4 v[108:111], v4, s[8:11], s29 offen offset:0 sc1
  buffer_load_dwordx4 v[112:115], v4, s[8:11], s29 offen offset:1024 sc1
  buffer_load_dwordx4 v[116:119], v4, s[8:11], s29 offen offset:2048 sc1
  buffer_load_dwordx4 v[120:123], v4, s[8:11], s29 offen offset:3072 sc1
  s_add_u32 s34, s34, 1
  s_cmp_gt_u32 s34, 131072
  s_cbranch_scc1 L_abort
  s_waitcnt vmcnt(3)
  v_and_b32 v31, 1, v108
  v_cmp_ne_u32 vcc, 1, v31
  s_cbranch_vccnz L_pa_f27
  s_branch L_pa_c27
L_pa_f28:
  s_add_u32 s29, s63, 28672
  buffer_load_dwordx4 v[112:115], v4, s[8:11], s29 offen offset:0 sc1
  buffer_load_dwordx4 v[116:119], v4, s[8:11], s29 offen offset:1024 sc1
  buffer_load_dwordx4 v[120:123], v4, s[8:11], s29 offen offset:2048 sc1
  buffer_load_dwordx4 v[124:127], v4, s[8:11], s29 offen offset:3072 sc1
  s_add_u32 s34, s34, 1
  s_cmp_gt_u32 s34, 131072
  s_cbranch_scc1 L_abort
  s_waitcnt vmcnt(3)
  v_and_b32 v31, 1, v112
  v_cmp_ne_u32 vcc, 1, v31
  s_cbranch_vccnz L_pa_f28
  s_branch L_pa_c28
L_pa_f29:
  s_add_u32 s29, s63, 29696
  buffer_load_dwordx4 v[116:119], v4, s[8:11], s29 offen offset:0 sc1
  buffer_load_dwordx4 v[120:123], v4, s[8:11], s29 offen offset:1024 sc1
  buffer_load_dwordx4 v[124:127], v4, s[8:11], s29 offen offset:2048 sc1
  buffer_load_dwordx4 v[64:67], v4, s[8:11], s29 offen offset:3072 sc1
  s_add_u32 s34, s34, 1
  s_cmp_gt_u32 s34, 131072
  s_cbranch_scc1 L_abort
  s_waitcnt vmcnt(3)
  v_and_b32 v31, 1, v116
  v_cmp_ne_u32 vcc, 1, v31
  s_cbranch_vccnz L_pa_f29
  s_branch L_pa_c29
L_pa_f30:
  s_add_u32 s29, s63, 30720
  buffer_load_dwordx4 v[120:123], v4, s[8:11], s29 offen offset:0 sc1
  buffer_load_dwordx4 v[124:127], v4, s[8:11], s29 offen offset:1024 sc1
  buffer_load_dwordx4 v[64:67], v4, s[8:11], s29 offen offset:2048 sc1
  buffer_load_dwordx4 v[68:71], v4, s[8:11], s29 offen offset:3072 sc1
  s_add_u32 s34, s34, 1
  s_cmp_gt_u32 s34, 131072
  s_cbranch_scc1 L_abort
  s_waitcnt vmcnt(3)
  v_and_b32 v31, 1, v120
  v_cmp_ne_u32 vcc, 1, v31
  s_cbranch_vccnz L_pa_f30
  s_branch L_pa_c30
L_pa_f31:
  s_add_u32 s29, s63, 31744
  buffer_load_dwordx4 v[124:127], v4, s[8:11], s29 offen offset:0 sc1
  buffer_load_dwordx4 v[64:67], v4, s[8:11], s29 offen offset:1024 sc1
  buffer_load_dwordx4 v[68:71], v4, s[8:11], s29 offen offset:2048 sc1
  buffer_load_dwordx4 v[72:75], v4, s[8:11], s29 offen offset:3072 sc1
  s_add_u32 s34, s34, 1
  s_cmp_gt_u32 s34, 131072
  s_cbranch_scc1 L_abort
  s_waitcnt vmcnt(3)
  v_and_b32 v31, 1, v124
  v_cmp_ne_u32 vcc, 1, v31
  s_cbranch_vccnz L_pa_f31
  s_branch L_pa_c31
L_pa_f32:
  s_add_u32 s29, s63, 32768
  buffer_load_dwordx4 v[64:67], v4, s[8:11], s29 offen offset:0 sc1
  buffer_load_dwordx4 v[68:71], v4, s[8:11], s29 offen offset:1024 sc1
  buffer_load_dwordx4 v[72:75], v4, s[8:11], s29 offen offset:2048 sc1
  buffer_load_dwordx4 v[76:79], v4, s[8:11], s29 offen offset:3072 sc1
  s_add_u32 s29, s29, 4096
  buffer_load_dwordx4 v[80:83], v4, s[8:11], s29 offen offset:0 sc1
  buffer_load_dwordx4 v[84:87], v4, s[8:11], s29 offen offset:1024 sc1
  buffer_load_dwordx4 v[88:91], v4, s[8:11], s29 offen offset:2048 sc1
  buffer_load_dwordx4 v[92:95], v4, s[8:11], s29 offen offset:3072 sc1
  s_add_u32 s29, s29, 4096
  buffer_load_dwordx4 v[96:99], v4, s[8:11], s29 offen offset:0 sc1
  buffer_load_dwordx4 v[100:103], v4, s[8:11], s29 offen offset:1024 sc1
  buffer_load_dwordx4 v[104:107], v4, s[8:11], s29 offen offset:2048 sc1
  buffer_load_dwordx4 v[108:111], v4, s[8:11], s29 offen offset:3072 sc1
  s_add_u32 s29, s29, 4096
  buffer_load_dwordx4 v[112:115], v4, s[8:11], s29 offen offset:0 sc1
  buffer_load_dwordx4 v[116:119], v4, s[8:11], s29 offen offset:1024 sc1
  buffer_load_dwordx4 v[120:123], v4, s[8:11], s29 offen offset:2048 sc1
  buffer_load_dwordx4 v[124:127], v4, s[8:11], s29 offen offset:3072 sc1
  s_add_u32 s34, s34, 1
  s_cmp_gt_u32 s34, 131072
  s_cbranch_scc1 L_abort
  s_waitcnt vmcnt(15)
  v_and_b32 v31, 1, v64
  v_cmp_ne_u32 vcc, 1, v31
  s_cbranch_vccnz L_pa_f32
  s_branch L_pa_c32
L_pa_f33:
  s_add_u32 s29, s63, 33792
  buffer_load_dwordx4 v[68:71], v4, s[8:11], s29 offen offset:0 sc1
  buffer_load_dwordx4 v[72:75], v4, s[8:11], s29 offen offset:1024 sc1
  buffer_load_dwordx4 v[76:79], v4, s[8:11], s29 offen offset:2048 sc1
  buffer_load_dwordx4 v[80:83], v4, s[8:11], s29 offen offset:3072 sc1
  s_add_u32 s34, s34, 1
  s_cmp_gt_u32 s34, 131072
  s_cbranch_scc1 L_abort
  s_waitcnt vmcnt(3)
  v_and_b32 v31, 1, v68
  v_cmp_ne_u32 vcc, 1, v31
  s_cbranch_vccnz L_pa_f33
  s_branch L_pa_c33
L_pa_f34:
  s_add_u32 s29, s63, 34816
  buffer_load_dwordx4 v[72:75], v4, s[8:11], s29 offen offset:0 sc1
  buffer_load_dwordx4 v[76:79], v4, s[8:11], s29 offen offset:1024 sc1
  buffer_load_dwordx4 v[80:83], v4, s[8:11], s29 offen offset:2048 sc1
  buffer_load_dwordx4 v[84:87], v4, s[8:11], s29 offen offset:3072 sc1
  s_add_u32 s34, s34, 1
  s_cmp_gt_u32 s34, 131072
  s_cbranch_scc1 L_abort
  s_waitcnt vmcnt(3)
  v_and_b32 v31, 1, v72
  v_cmp_ne_u32 vcc, 1, v31
  s_cbranch_vccnz L_pa_f34
  s_branch L_pa_c34
L_pa_f35:
  s_add_u32 s29, s63, 35840
  buffer_load_dwordx4 v[76:79], v4, s[8:11], s29 offen offset:0 sc1
  buffer_load_dwordx4 v[80:83], v4, s[8:11], s29 offen offset:1024 sc1
  buffer_load_dwordx4 v[84:87], v4, s[8:11], s29 offen offset:2048 sc1
  buffer_load_dwordx4 v[88:91], v4, s[8:11], s29 offen offset:3072 sc1
  s_add_u32 s34, s34, 1
  s_cmp_gt_u32 s34, 131072
  s_cbranch_scc1 L_abort
  s_waitcnt vmcnt(3)
  v_and_b32 v31, 1, v76
  v_cmp_ne_u32 vcc, 1, v31
  s_cbranch_vccnz L_pa_f35
  s_branch L_pa_c35
L_pa_f36:
  s_add_u32 s29, s63, 36864
  buffer_load_dwordx4 v[80:83], v4, s[8:11], s29 offen offset:0 sc1
  buffer_load_dwordx4 v[84:87], v4, s[8:11], s29 offen offset:1024 sc1
  buffer_load_dwordx4 v[88:91], v4, s[8:11], s29 offen offset:2048 sc1
  buffer_load_dwordx4 v[92:95], v4, s[8:11], s29 offen offset:3072 sc1
  s_add_u32 s34, s34, 1
  s_cmp_gt_u32 s34, 131072
  s_cbranch_scc1 L_abort
  s_waitcnt vmcnt(3)
  v_and_b32 v31, 1, v80
  v_cmp_ne_u32 vcc, 1, v31
  s_cbranch_vccnz L_pa_f36
  s_branch L_pa_c36
L_pa_f37:
  s_add_u32 s29, s63, 37888
  buffer_load_dwordx4 v[84:87], v4, s[8:11], s29 offen offset:0 sc1
  buffer_load_dwordx4 v[88:91], v4, s[8:11], s29 offen offset:1024 sc1
  buffer_load_dwordx4 v[92:95], v4, s[8:11], s29 offen offset:2048 sc1
  buffer_load_dwordx4 v[96:99], v4, s[8:11], s29 offen offset:3072 sc1
  s_add_u32 s34, s34, 1
  s_cmp_gt_u32 s34, 131072
  s_cbranch_scc1 L_abort
  s_waitcnt vmcnt(3)
  v_and_b32 v31, 1, v84
  v_cmp_ne_u32 vcc, 1, v31
  s_cbranch_vccnz L_pa_f37
  s_branch L_pa_c37
L_pa_f38:
  s_add_u32 s29, s63, 38912
  buffer_load_dwordx4 v[88:91], v4, s[8:11], s29 offen offset:0 sc1
  buffer_load_dwordx4 v[92:95], v4, s[8:11], s29 offen offset:1024 sc1
  buffer_load_dwordx4 v[96:99], v4, s[8:11], s29 offen offset:2048 sc1
  buffer_load_dwordx4 v[100:103], v4, s[8:11], s29 offen offset:3072 sc1
  s_add_u32 s34, s34, 1
  s_cmp_gt_u32 s34, 131072
  s_cbranch_scc1 L_abort
  s_waitcnt vmcnt(3)
  v_and_b32 v31, 1, v88
  v_cmp_ne_u32 vcc, 1, v31
  s_cbranch_vccnz L_pa_f38
  s_branch L_pa_c38
L_pa_f39:
  s_add_u32 s29, s63, 39936
  buffer_load_dwordx4 v[92:95], v4, s[8:11], s29 offen offset:0 sc1
  buffer_load_dwordx4 v[96:99], v4, s[8:11], s29 offen offset:1024 sc1
  buffer_load_dwordx4 v[100:103], v4, s[8:11], s29 offen offset:2048 sc1
  buffer_load_dwordx4 v[104:107], v4, s[8:11], s29 offen offset:3072 sc1
  s_add_u32 s34, s34, 1
  s_cmp_gt_u32 s34, 131072
  s_cbranch_scc1 L_abort
  s_waitcnt vmcnt(3)
  v_and_b32 v31, 1, v92
  v_cmp_ne_u32 vcc, 1, v31
  s_cbranch_vccnz L_pa_f39
  s_branch L_pa_c39
L_pa_f40:
  s_add_u32 s29, s63, 40960
  buffer_load_dwordx4 v[96:99], v4, s[8:11], s29 offen offset:0 sc1
  buffer_load_dwordx4 v[100:103], v4, s[8:11], s29 offen offset:1024 sc1
  buffer_load_dwordx4 v[104:107], v4, s[8:11], s29 offen offset:2048 sc1
  buffer_load_dwordx4 v[108:111], v4, s[8:11], s29 offen offset:3072 sc1
  s_add_u32 s29, s29, 4096
  buffer_load_dwordx4 v[112:115], v4, s[8:11], s29 offen offset:0 sc1
  buffer_load_dwordx4 v[116:119], v4, s[8:11], s29 offen offset:1024 sc1
  buffer_load_dwordx4 v[120:123], v4, s[8:11], s29 offen offset:2048 sc1
  buffer_load_dwordx4 v[124:127], v4, s[8:11], s29 offen offset:3072 sc1
  s_add_u32 s29, s29, 4096
  buffer_load_dwordx4 v[64:67], v4, s[8:11], s29 offen offset:0 sc1
  buffer_load_dwordx4 v[68:71], v4, s[8:11], s29 offen offset:1024 sc1
  buffer_load_dwordx4 v[72:75], v4, s[8:11], s29 offen offset:2048 sc1
  buffer_load_dwordx4 v[76:79], v4, s[8:11], s29 offen offset:3072 sc1
  s_add_u32 s29, s29, 4096
  buffer_load_dwordx4 v[80:83], v4, s[8:11], s29 offen offset:0 sc1
  buffer_load_dwordx4 v[84:87], v4, s[8:11], s29 offen offset:1024 sc1
  buffer_load_dwordx4 v[88:91], v4, s[8:11], s29 offen offset:2048 sc1
  buffer_load_dwordx4 v[92:95], v4, s[8:11], s29 offen offset:3072 sc1
  s_add_u32 s34, s34, 1
  s_cmp_gt_u32 s34, 131072
  s_cbranch_scc1 L_abort
  s_waitcnt vmcnt(15)
  v_and_b32 v31, 1, v96
  v_cmp_ne_u32 vcc, 1, v31
  s_cbranch_vccnz L_pa_f40
  s_branch L_pa_c40
L_pa_f41:
  s_add_u32 s29, s63, 41984
  buffer_load_dwordx4 v[100:103], v4, s[8:11], s29 offen offset:0 sc1
  buffer_load_dwordx4 v[104:107], v4, s[8:11], s29 offen offset:1024 sc1
  buffer_load_dwordx4 v[108:111], v4, s[8:11], s29 offen offset:2048 sc1
  buffer_load_dwordx4 v[112:115], v4, s[8:11], s29 offen offset:3072 sc1
  s_add_u32 s34, s34, 1
  s_cmp_gt_u32 s34, 131072
  s_cbranch_scc1 L_abort
  s_waitcnt vmcnt(3)
  v_and_b32 v31, 1, v100
  v_cmp_ne_u32 vcc, 1, v31
  s_cbranch_vccnz L_pa_f41
  s_branch L_pa_c41
L_pa_f42:
  s_add_u32 s29, s63, 43008
  buffer_load_dwordx4 v[104:107], v4, s[8:11], s29 offen offset:0 sc1
  buffer_load_dwordx4 v[108:111], v4, s[8:11], s29 offen offset:1024 sc1
  buffer_load_dwordx4 v[112:115], v4, s[8:11], s29 offen offset:2048 sc1
  buffer_load_dwordx4 v[116:119], v4, s[8:11], s29 offen offset:3072 sc1
  s_add_u32 s34, s34, 1
  s_cmp_gt_u32 s34, 131072
  s_cbranch_scc1 L_abort
  s_waitcnt vmcnt(3)
  v_and_b32 v31, 1, v104
  v_cmp_ne_u32 vcc, 1, v31
  s_cbranch_vccnz L_pa_f42
  s_branch L_pa_c42
L_pa_f43:
  s_add_u32 s29, s63, 44032
  buffer_load_dwordx4 v[108:111], v4, s[8:11], s29 offen offset:0 sc1
  buffer_load_dwordx4 v[112:115], v4, s[8:11], s29 offen offset:1024 sc1
  buffer_load_dwordx4 v[116:119], v4, s[8:11], s29 offen offset:2048 sc1
  buffer_load_dwordx4 v[120:123], v4, s[8:11], s29 offen offset:3072 sc1
  s_add_u32 s34, s34, 1
  s_cmp_gt_u32 s34, 131072
  s_cbranch_scc1 L_abort
  s_waitcnt vmcnt(3)
  v_and_b32 v31, 1, v108
  v_cmp_ne_u32 vcc, 1, v31
  s_cbranch_vccnz L_pa_f43
  s_branch L_pa_c43
L_pa_f44:
  s_add_u32 s29, s63, 45056
  buffer_load_dwordx4 v[112:115], v4, s[8:11], s29 offen offset:0 sc1
  buffer_load_dwordx4 v[116:119], v4, s[8:11], s29 offen offset:1024 sc1
  buffer_load_dwordx4 v[120:123], v4, s[8:11], s29 offen offset:2048 sc1
  buffer_load_dwordx4 v[124:127], v4, s[8:11], s29 offen offset:3072 sc1
  s_add_u32 s34, s34, 1
  s_cmp_gt_u32 s34, 131072
  s_cbranch_scc1 L_abort
  s_waitcnt vmcnt(3)
  v_and_b32 v31, 1, v112
  v_cmp_ne_u32 vcc, 1, v31
  s_cbranch_vccnz L_pa_f44
  s_branch L_pa_c44
L_pa_f45:
  s_add_u32 s29, s63, 46080
  buffer_load_dwordx4 v[116:119], v4, s[8:11], s29 offen offset:0 sc1
  buffer_load_dwordx4 v[120:123], v4, s[8:11], s29 offen offset:1024 sc1
  buffer_load_dwordx4 v[124:127], v4, s[8:11], s29 offen offset:2048 sc1
  buffer_load_dwordx4 v[64:67], v4, s[8:11], s29 offen offset:3072 sc1
  s_add_u32 s34, s34, 1
  s_cmp_gt_u32 s34, 131072
  s_cbranch_scc1 L_abort
  s_waitcnt vmcnt(3)
  v_and_b32 v31, 1, v116
  v_cmp_ne_u32 vcc, 1, v31
  s_cbranch_vccnz L_pa_f45
  s_branch L_pa_c45
L_pa_f46:
  s_add_u32 s29, s63, 47104
  buffer_load_dwordx4 v[120:123], v4, s[8:11], s29 offen offset:0 sc1
  buffer_load_dwordx4 v[124:127], v4, s[8:11], s29 offen offset:1024 sc1
  buffer_load_dwordx4 v[64:67], v4, s[8:11], s29 offen offset:2048 sc1
  buffer_load_dwordx4 v[68:71], v4, s[8:11], s29 offen offset:3072 sc1
  s_add_u32 s34, s34, 1
  s_cmp_gt_u32 s34, 131072
  s_cbranch_scc1 L_abort
  s_waitcnt vmcnt(3)
  v_and_b32 v31, 1, v120
  v_cmp_ne_u32 vcc, 1, v31
  s_cbranch_vccnz L_pa_f46
  s_branch L_pa_c46
L_pa_f47:
  s_add_u32 s29, s63, 48128
  buffer_load_dwordx4 v[124:127], v4, s[8:11], s29 offen offset:0 sc1
  buffer_load_dwordx4 v[64:67], v4, s[8:11], s29 offen offset:1024 sc1
  buffer_load_dwordx4 v[68:71], v4, s[8:11], s29 offen offset:2048 sc1
  buffer_load_dwordx4 v[72:75], v4, s[8:11], s29 offen offset:3072 sc1
  s_add_u32 s34, s34, 1
  s_cmp_gt_u32 s34, 131072
  s_cbranch_scc1 L_abort
  s_waitcnt vmcnt(3)
  v_and_b32 v31, 1, v124
  v_cmp_ne_u32 vcc, 1, v31
  s_cbranch_vccnz L_pa_f47
  s_branch L_pa_c47
L_pa_f48:
  s_add_u32 s29, s63, 49152
  buffer_load_dwordx4 v[64:67], v4, s[8:11], s29 offen offset:0 sc1
  buffer_load_dwordx4 v[68:71], v4, s[8:11], s29 offen offset:1024 sc1
  buffer_load_dwordx4 v[72:75], v4, s[8:11], s29 offen offset:2048 sc1
  buffer_load_dwordx4 v[76:79], v4, s[8:11], s29 offen offset:3072 sc1
  s_add_u32 s29, s29, 4096
  buffer_load_dwordx4 v[80:83], v4, s[8:11], s29 offen offset:0 sc1
  buffer_load_dwordx4 v[84:87], v4, s[8:11], s29 offen offset:1024 sc1
  buffer_load_dwordx4 v[88:91], v4, s[8:11], s29 offen offset:2048 sc1
  buffer_load_dwordx4 v[92:95], v4, s[8:11], s29 offen offset:3072 sc1
  s_add_u32 s29, s29, 4096
  buffer_load_dwordx4 v[96:99], v4, s[8:11], s29 offen offset:0 sc1
  buffer_load_dwordx4 v[100:103], v4, s[8:11], s29 offen offset:1024 sc1
  buffer_load_dwordx4 v[104:107], v4, s[8:11], s29 offen offset:2048 sc1
  buffer_load_dwordx4 v[108:111], v4, s[8:11], s29 offen offset:3072 sc1
  s_add_u32 s29, s29, 4096
  buffer_load_dwordx4 v[112:115], v4, s[8:11], s29 offen offset:0 sc1
  buffer_load_dwordx4 v[116:119], v4, s[8:11], s29 offen offset:1024 sc1
  buffer_load_dwordx4 v[120:123], v4, s[8:11], s29 offen offset:2048 sc1
  buffer_load_dwordx4 v[124:127], v4, s[8:11], s29 offen offset:3072 sc1
  s_add_u32 s34, s34, 1
  s_cmp_gt_u32 s34, 131072
  s_cbranch_scc1 L_abort
  s_waitcnt vmcnt(15)
  v_and_b32 v31, 1, v64
  v_cmp_ne_u32 vcc, 1, v31
  s_cbranch_vccnz L_pa_f48
  s_branch L_pa_c48
L_pa_f49:
  s_add_u32 s29, s63, 50176
  buffer_load_dwordx4 v[68:71], v4, s[8:11], s29 offen offset:0 sc1
  buffer_load_dwordx4 v[72:75], v4, s[8:11], s29 offen offset:1024 sc1
  buffer_load_dwordx4 v[76:79], v4, s[8:11], s29 offen offset:2048 sc1
  buffer_load_dwordx4 v[80:83], v4, s[8:11], s29 offen offset:3072 sc1
  s_add_u32 s34, s34, 1
  s_cmp_gt_u32 s34, 131072
  s_cbranch_scc1 L_abort
  s_waitcnt vmcnt(3)
  v_and_b32 v31, 1, v68
  v_cmp_ne_u32 vcc, 1, v31
  s_cbranch_vccnz L_pa_f49
  s_branch L_pa_c49
L_pa_f50:
  s_add_u32 s29, s63, 51200
  buffer_load_dwordx4 v[72:75], v4, s[8:11], s29 offen offset:0 sc1
  buffer_load_dwordx4 v[76:79], v4, s[8:11], s29 offen offset:1024 sc1
  buffer_load_dwordx4 v[80:83], v4, s[8:11], s29 offen offset:2048 sc1
  buffer_load_dwordx4 v[84:87], v4, s[8:11], s29 offen offset:3072 sc1
  s_add_u32 s34, s34, 1
  s_cmp_gt_u32 s34, 131072
  s_cbranch_scc1 L_abort
  s_waitcnt vmcnt(3)
  v_and_b32 v31, 1, v72
  v_cmp_ne_u32 vcc, 1, v31
  s_cbranch_vccnz L_pa_f50
  s_branch L_pa_c50
L_pa_f51:
  s_add_u32 s29, s63, 52224
  buffer_load_dwordx4 v[76:79], v4, s[8:11], s29 offen offset:0 sc1
  buffer_load_dwordx4 v[80:83], v4, s[8:11], s29 offen offset:1024 sc1
  buffer_load_dwordx4 v[84:87], v4, s[8:11], s29 offen offset:2048 sc1
  buffer_load_dwordx4 v[88:91], v4, s[8:11], s29 offen offset:3072 sc1
  s_add_u32 s34, s34, 1
  s_cmp_gt_u32 s34, 131072
  s_cbranch_scc1 L_abort
  s_waitcnt vmcnt(3)
  v_and_b32 v31, 1, v76
  v_cmp_ne_u32 vcc, 1, v31
  s_cbranch_vccnz L_pa_f51
  s_branch L_pa_c51
L_pa_f52:
  s_add_u32 s29, s63, 53248
  buffer_load_dwordx4 v[80:83], v4, s[8:11], s29 offen offset:0 sc1
  buffer_load_dwordx4 v[84:87], v4, s[8:11], s29 offen offset:1024 sc1
  buffer_load_dwordx4 v[88:91], v4, s[8:11], s29 offen offset:2048 sc1
  buffer_load_dwordx4 v[92:95], v4, s[8:11], s29 offen offset:3072 sc1
  s_add_u32 s34, s34, 1
  s_cmp_gt_u32 s34, 131072
  s_cbranch_scc1 L_abort
  s_waitcnt vmcnt(3)
  v_and_b32 v31, 1, v80
  v_cmp_ne_u32 vcc, 1, v31
  s_cbranch_vccnz L_pa_f52
  s_branch L_pa_c52
L_pa_f53:
  s_add_u32 s29, s63, 54272
  buffer_load_dwordx4 v[84:87], v4, s[8:11], s29 offen offset:0 sc1
  buffer_load_dwordx4 v[88:91], v4, s[8:11], s29 offen offset:1024 sc1
  buffer_load_dwordx4 v[92:95], v4, s[8:11], s29 offen offset:2048 sc1
  buffer_load_dwordx4 v[96:99], v4, s[8:11], s29 offen offset:3072 sc1
  s_add_u32 s34, s34, 1
  s_cmp_gt_u32 s34, 131072
  s_cbranch_scc1 L_abort
  s_waitcnt vmcnt(3)
  v_and_b32 v31, 1, v84
  v_cmp_ne_u32 vcc, 1, v31
  s_cbranch_vccnz L_pa_f53
  s_branch L_pa_c53
L_pa_f54:
  s_add_u32 s29, s63, 55296
  buffer_load_dwordx4 v[88:91], v4, s[8:11], s29 offen offset:0 sc1
  buffer_load_dwordx4 v[92:95], v4, s[8:11], s29 offen offset:1024 sc1
  buffer_load_dwordx4 v[96:99], v4, s[8:11], s29 offen offset:2048 sc1
  buffer_load_dwordx4 v[100:103], v4, s[8:11], s29 offen offset:3072 sc1
  s_add_u32 s34, s34, 1
  s_cmp_gt_u32 s34, 131072
  s_cbranch_scc1 L_abort
  s_waitcnt vmcnt(3)
  v_and_b32 v31, 1, v88
  v_cmp_ne_u32 vcc, 1, v31
  s_cbranch_vccnz L_pa_f54
  s_branch L_pa_c54
L_pa_f55:
  s_add_u32 s29, s63, 56320
  buffer_load_dwordx4 v[92:95], v4, s[8:11], s29 offen offset:0 sc1
  buffer_load_dwordx4 v[96:99], v4, s[8:11], s29 offen offset:1024 sc1
  buffer_load_dwordx4 v[100:103], v4, s[8:11], s29 offen offset:2048 sc1
  buffer_load_dwordx4 v[104:107], v4, s[8:11], s29 offen offset:3072 sc1
  s_add_u32 s34, s34, 1
  s_cmp_gt_u32 s34, 131072
  s_cbranch_scc1 L_abort
  s_waitcnt vmcnt(3)
  v_and_b32 v31, 1, v92
  v_cmp_ne_u32 vcc, 1, v31
  s_cbranch_vccnz L_pa_f55
  s_branch L_pa_c55
L_pa_f56:
  s_add_u32 s29, s63, 57344
  buffer_load_dwordx4 v[96:99], v4, s[8:11], s29 offen offset:0 sc1
  buffer_load_dwordx4 v[100:103], v4, s[8:11], s29 offen offset:1024 sc1
  buffer_load_dwordx4 v[104:107], v4, s[8:11], s29 offen offset:2048 sc1
  buffer_load_dwordx4 v[108:111], v4, s[8:11], s29 offen offset:3072 sc1
  s_add_u32 s29, s29, 4096
  buffer_load_dwordx4 v[112:115], v4, s[8:11], s29 offen offset:0 sc1
  buffer_load_dwordx4 v[116:119], v4, s[8:11], s29 offen offset:1024 sc1
  buffer_load_dwordx4 v[120:123], v4, s[8:11], s29 offen offset:2048 sc1
  buffer_load_dwordx4 v[124:127], v4, s[8:11], s29 offen offset:3072 sc1
  s_add_u32 s34, s34, 1
  s_cmp_gt_u32 s34, 131072
  s_cbranch_scc1 L_abort
  s_waitcnt vmcnt(7)
  v_and_b32 v31, 1, v96
  v_cmp_ne_u32 vcc, 1, v31
  s_cbranch_vccnz L_pa_f56
  s_branch L_pa_c56
L_pa_f57:
  s_add_u32 s29, s63, 58368
  buffer_load_dwordx4 v[100:103], v4, s[8:11], s29 offen offset:0 sc1
  buffer_load_dwordx4 v[104:107], v4, s[8:11], s29 offen offset:1024 sc1
  buffer_load_dwordx4 v[108:111], v4, s[8:11], s29 offen offset:2048 sc1
  buffer_load_dwordx4 v[112:115], v4, s[8:11], s29 offen offset:3072 sc1
  s_add_u32 s34, s34, 1
  s_cmp_gt_u32 s34, 131072
  s_cbranch_scc1 L_abort
  s_waitcnt vmcnt(3)
  v_and_b32 v31, 1, v100
  v_cmp_ne_u32 vcc, 1, v31
  s_cbranch_vccnz L_pa_f57
  s_branch L_pa_c57
L_pa_f58:
  s_add_u32 s29, s63, 59392
  buffer_load_dwordx4 v[104:107], v4, s[8:11], s29 offen offset:0 sc1
  buffer_load_dwordx4 v[108:111], v4, s[8:11], s29 offen offset:1024 sc1
  buffer_load_dwordx4 v[112:115], v4, s[8:11], s29 offen offset:2048 sc1
  buffer_load_dwordx4 v[116:119], v4, s[8:11], s29 offen offset:3072 sc1
  s_add_u32 s34, s34, 1
  s_cmp_gt_u32 s34, 131072
  s_cbranch_scc1 L_abort
  s_waitcnt vmcnt(3)
  v_and_b32 v31, 1, v104
  v_cmp_ne_u32 vcc, 1, v31
  s_cbranch_vccnz L_pa_f58
  s_branch L_pa_c58
L_pa_f59:
  s_add_u32 s29, s63, 60416
  buffer_load_dwordx4 v[108:111], v4, s[8:11], s29 offen offset:0 sc1
  buffer_load_dwordx4 v[112:115], v4, s[8:11], s29 offen offset:1024 sc1
  buffer_load_dwordx4 v[116:119], v4, s[8:11], s29 offen offset:2048 sc1
  buffer_load_dwordx4 v[120:123], v4, s[8:11], s29 offen offset:3072 sc1
  s_add_u32 s34, s34, 1
  s_cmp_gt_u32 s34, 131072
  s_cbranch_scc1 L_abort
  s_waitcnt vmcnt(3)
  v_and_b32 v31, 1, v108
  v_cmp_ne_u32 vcc, 1, v31
  s_cbranch_vccnz L_pa_f59
  s_branch L_pa_c59
L_pa_f60:
  s_add_u32 s29, s63, 61440
  buffer_load_dwordx4 v[112:115], v4, s[8:11], s29 offen offset:0 sc1
  buffer_load_dwordx4 v[116:119], v4, s[8:11], s29 offen offset:1024 sc1
  buffer_load_dwordx4 v[120:123], v4, s[8:11], s29 offen offset:2048 sc1
  buffer_load_dwordx4 v[124:127], v4, s[8:11], s29 offen offset:3072 sc1
  s_add_u32 s34, s34, 1
  s_cmp_gt_u32 s34, 131072
  s_cbranch_scc1 L_abort
  s_waitcnt vmcnt(3)
  v_and_b32 v31, 1, v112
  v_cmp_ne_u32 vcc, 1, v31
  s_cbranch_vccnz L_pa_f60
  s_branch L_pa_c60
L_pa_f61:
  s_add_u32 s29, s63, 62464
  buffer_load_dwordx4 v[116:119], v4, s[8:11], s29 offen offset:0 sc1
  buffer_load_dwordx4 v[120:123], v4, s[8:11], s29 offen offset:1024 sc1
  buffer_load_dwordx4 v[124:127], v4, s[8:11], s29 offen offset:2048 sc1
  s_add_u32 s34, s34, 1
  s_cmp_gt_u32 s34, 131072
  s_cbranch_scc1 L_abort
  s_waitcnt vmcnt(2)
  v_and_b32 v31, 1, v116
  v_cmp_ne_u32 vcc, 1, v31
  s_cbranch_vccnz L_pa_f61
  s_branch L_pa_c61
L_pa_f62:
  s_add_u32 s29, s63, 63488
  buffer_load_dwordx4 v[120:123], v4, s[8:11], s29 offen offset:0 sc1
  buffer_load_dwordx4 v[124:127], v4, s[8:11], s29 offen offset:1024 sc1
  s_add_u32 s34, s34, 1
  s_cmp_gt_u32 s34, 131072
  s_cbranch_scc1 L_abort
  s_waitcnt vmcnt(1)
  v_and_b32 v31, 1, v120
  v_cmp_ne_u32 vcc, 1, v31
  s_cbranch_vccnz L_pa_f62
  s_branch L_pa_c62
L_pa_f63:
  s_add_u32 s29, s63, 64512
  buffer_load_dwordx4 v[124:127], v4, s[8:11], s29 offen offset:0 sc1
  s_add_u32 s34, s34, 1
  s_cmp_gt_u32 s34, 131072
  s_cbranch_scc1 L_abort
  s_waitcnt vmcnt(0)
  v_and_b32 v31, 1, v124
  v_cmp_ne_u32 vcc, 1, v31
  s_cbranch_vccnz L_pa_f63
  s_branch L_pa_c63
L_attn:
  s_sub_u32 s60, s21, 18
  s_mul_i32 s29, s20, 14
  s_add_u32 s60, s60, s29
  s_lshl_b32 s60, s60, 2
  s_add_u32 s60, s60, s22
  v_lshlrev_b32 v2, 4, v1
  v_and_b32 v20, 15, v1
  v_lshrrev_b32 v21, 4, v1
  v_lshrrev_b32 v22, 2, v20
  v_and_b32 v23, 1, v20
  v_lshlrev_b32 v22, 7, v22
  v_lshl_add_u32 v22, v23, 10, v22
  v_lshl_add_u32 v3, v21, 4, v22
  v_lshlrev_b32 v22, 9, v21
  v_lshl_add_u32 v4, v20, 4, v22
  v_mov_b32 v5, 0xff800000
  v_lshlrev_b32 v22, 2, v21
  s_mov_b32 s65, 0x3e0293ee
  v_add_u32 v23, 0, v22
  v_cmp_le_u32 s[68:69], v23, v20
  v_add_u32 v23, 1, v22
  v_cmp_le_u32 s[70:71], v23, v20
  v_add_u32 v23, 2, v22
  v_cmp_le_u32 s[72:73], v23, v20
  v_add_u32 v23, 3, v22
  v_cmp_le_u32 s[74:75], v23, v20
  v_mov_b32 v216, 0x3f803f80
  v_mov_b32 v217, 0x3f803f80
  v_mov_b32 v218, 0x3f803f80
  v_mov_b32 v219, 0x3f803f80
  v_mov_b32 v220, 0x3f803f80
  v_mov_b32 v221, 0
  v_mov_b64 v[24:25], 0
  v_mov_b64 v[26:27], 0
  s_mov_b32 s34, 0
    L_at_arm:
  buffer_load_dword v20, off, s[16:19], 0 offset:60 sc1
  s_add_u32 s34, s34, 1
  s_cmp_gt_u32 s34, 131072
  s_cbranch_scc1 L_abort
  s_waitcnt vmcnt(0)
  v_readfirstlane_b32 s32, v20
  s_nop 0
  s_and_b32 s32, s32, 0xffff
  s_cmp_ge_u32 s32, 32
  s_cbranch_scc1 L_at_arm_ok
  s_sleep 2
  s_branch L_at_arm
    L_at_arm_ok:
  s_mov_b32 s34, 0
    L_at_kv0:
  buffer_load_dword v20, off, s[16:19], 0 offset:64 sc1
  s_add_u32 s34, s34, 1
  s_cmp_gt_u32 s34, 131072
  s_cbranch_scc1 L_abort
  s_waitcnt vmcnt(0)
  v_readfirstlane_b32 s32, v20
  s_nop 0
  s_and_b32 s32, s32, 0xffff
  s_cmp_ge_u32 s32, 84
  s_cbranch_scc1 L_at_kv0_ok
  s_sleep 2
  s_branch L_at_kv0
    L_at_kv0_ok:
L_at_loop:
  s_lshr_b32 s61, s60, 6
  s_bfe_u32 s62, s60, 0x50001
  s_lshr_b32 s29, s61, 3
  s_lshl_b32 s29, s29, 2
  s_mov_b32 s34, 0
    L_at_g1:
  buffer_load_dword v20, off, s[16:19], s29 offset:96 sc1
  s_add_u32 s34, s34, 1
  s_cmp_gt_u32 s34, 131072
  s_cbranch_scc1 L_abort
  s_waitcnt vmcnt(0)
  v_readfirstlane_b32 s32, v20
  s_nop 0
  s_and_b32 s32, s32, 0xffff
  s_cmp_ge_u32 s32, 28
  s_cbranch_scc1 L_at_g1_ok
  s_sleep 8
  s_branch L_at_g1
    L_at_g1_ok:
  s_lshr_b32 s63, s60, 1
  s_lshl_b32 s63, s63, 13
  s_and_b32 s31, s60, 1
  s_lshl_b32 s30, s31, 12
  s_add_u32 s29, s63, s30
  s_add_u32 s29, s29, 33554432
  buffer_load_dwordx4 v[32:35], v2, s[8:11], s29 offen offset:0 sc1
  buffer_load_dwordx4 v[36:39], v2, s[8:11], s29 offen offset:1024 sc1
  buffer_load_dwordx4 v[40:43], v2, s[8:11], s29 offen offset:2048 sc1
  buffer_load_dwordx4 v[44:47], v2, s[8:11], s29 offen offset:3072 sc1
  s_add_u32 s29, s63, 50331648
  buffer_load_dwordx4 v[64:67], v2, s[8:11], s29 offen offset:0 sc1
  buffer_load_dwordx4 v[68:71], v2, s[8:11], s29 offen offset:1024 sc1
  buffer_load_dwordx4 v[72:75], v2, s[8:11], s29 offen offset:2048 sc1
  buffer_load_dwordx4 v[76:79], v2, s[8:11], s29 offen offset:3072 sc1
  s_add_u32 s29, s63, 50335744
  buffer_load_dwordx4 v[80:83], v2, s[8:11], s29 offen offset:0 sc1
  buffer_load_dwordx4 v[84:87], v2, s[8:11], s29 offen offset:1024 sc1
  buffer_load_dwordx4 v[88:91], v2, s[8:11], s29 offen offset:2048 sc1
  buffer_load_dwordx4 v[92:95], v2, s[8:11], s29 offen offset:3072 sc1
  s_add_u32 s29, s63, 67108864
  buffer_load_dwordx4 v[96:99], v2, s[8:11], s29 offen offset:0 sc1
  buffer_load_dwordx4 v[100:103], v2, s[8:11], s29 offen offset:1024 sc1
  buffer_load_dwordx4 v[104:107], v2, s[8:11], s29 offen offset:2048 sc1
  buffer_load_dwordx4 v[108:111], v2, s[8:11], s29 offen offset:3072 sc1
  s_add_u32 s29, s63, 67112960
  buffer_load_dwordx4 v[112:115], v2, s[8:11], s29 offen offset:0 sc1
  buffer_load_dwordx4 v[116:119], v2, s[8:11], s29 offen offset:1024 sc1
  buffer_load_dwordx4 v[120:123], v2, s[8:11], s29 offen offset:2048 sc1
  buffer_load_dwordx4 v[124:127], v2, s[8:11], s29 offen offset:3072 sc1
  s_lshl_b32 s30, s31, 8
  s_add_u32 s67, s63, s30
  s_add_u32 s67, s67, 83886080
  s_add_u32 s64, s67, 4096
  buffer_store_dwordx4 v[24:27], v4, s[8:11], s67 offen offset:0 sc1
  buffer_store_dwordx4 v[24:27], v4, s[8:11], s67 offen offset:2048 sc1
  buffer_store_dwordx4 v[24:27], v4, s[8:11], s64 offen offset:0 sc1
  buffer_store_dwordx4 v[24:27], v4, s[8:11], s64 offen offset:2048 sc1
  s_cmp_eq_u32 s31, 0
  s_cselect_b64 s[80:81], s[68:69], -1
  s_cselect_b64 s[88:89], 0, s[68:69]
  s_cselect_b64 s[82:83], s[70:71], -1
  s_cselect_b64 s[90:91], 0, s[70:71]
  s_cselect_b64 s[84:85], s[72:73], -1
  s_cselect_b64 s[92:93], 0, s[72:73]
  s_cselect_b64 s[86:87], s[74:75], -1
  s_cselect_b64 s[94:95], 0, s[74:75]
  s_lshl_b32 s29, s61, 7
  s_add_u32 s29, s29, 1384448
  v_mov_b32 v20, 1
  s_waitcnt vmcnt(0)
  s_mov_b64 exec, 1
  buffer_atomic_add v20, off, s[8:11], s29
  s_mov_b64 exec, -1
  v_mfma_f32_16x16x32_bf16 v[160:163], v[64:67], v[32:35], 0
  v_mfma_f32_16x16x32_bf16 v[160:163], v[68:71], v[36:39], v[160:163]
  v_mfma_f32_16x16x32_bf16 v[160:163], v[72:75], v[40:43], v[160:163]
  v_mfma_f32_16x16x32_bf16 v[160:163], v[76:79], v[44:47], v[160:163]
  v_mfma_f32_16x16x32_bf16 v[164:167], v[80:83], v[32:35], 0
  v_mfma_f32_16x16x32_bf16 v[164:167], v[84:87], v[36:39], v[164:167]
  v_mfma_f32_16x16x32_bf16 v[164:167], v[88:91], v[40:43], v[164:167]
  v_mfma_f32_16x16x32_bf16 v[164:167], v[92:95], v[44:47], v[164:167]
  v_cndmask_b32 v160, v5, v160, s[80:81]
  v_cndmask_b32 v161, v5, v161, s[82:83]
  v_cndmask_b32 v162, v5, v162, s[84:85]
  v_cndmask_b32 v163, v5, v163, s[86:87]
  s_nop 2
  v_cndmask_b32 v164, v5, v164, s[88:89]
  v_cndmask_b32 v165, v5, v165, s[90:91]
  v_cndmask_b32 v166, v5, v166, s[92:93]
  v_cndmask_b32 v167, v5, v167, s[94:95]
  v_max3_f32 v22, v160, v161, v162
  v_max3_f32 v22, v22, v164, v165
  v_max3_f32 v22, v22, v166, v167
  v_max_f32 v22, v22, v163
  s_lshl_b32 s29, s62, 7
  s_add_u32 s29, s29, 1376256
  s_add_u32 s30, s61, 1
  s_mov_b32 s34, 0
    L_at_pr:
  buffer_load_dword v20, off, s[8:11], s29 offset:0 sc1
  s_add_u32 s34, s34, 1
  s_cmp_gt_u32 s34, 131072
  s_cbranch_scc1 L_abort
  s_waitcnt vmcnt(0)
  v_readfirstlane_b32 s32, v20
  s_nop 0
  s_and_b32 s32, s32, 0xffff
  s_cmp_ge_u32 s32, s30
  s_cbranch_scc1 L_at_pr_ok
  s_sleep 16
  s_branch L_at_pr
    L_at_pr_ok:
  s_add_u32 s29, s63, 16777216
  s_add_u32 s30, s63, 134217728
  s_add_u32 s31, s30, 4096
  s_mov_b32 s34, 0
  s_mov_b64 vcc, -1
L_at_kv:
  s_mov_b64 exec, vcc
  buffer_load_dwordx4 v[128:131], v3, s[8:11], s29 offen offset:0 sc1
  buffer_load_dwordx4 v[132:135], v3, s[8:11], s29 offen offset:64 sc1
  buffer_load_dwordx4 v[136:139], v3, s[8:11], s29 offen offset:512 sc1
  buffer_load_dwordx4 v[140:143], v3, s[8:11], s29 offen offset:576 sc1
  buffer_load_dwordx4 v[144:147], v2, s[8:11], s30 offen offset:0 sc1
  buffer_load_dwordx4 v[148:151], v2, s[8:11], s30 offen offset:2048 sc1
  buffer_load_dwordx4 v[152:155], v2, s[8:11], s31 offen offset:0 sc1
  buffer_load_dwordx4 v[156:159], v2, s[8:11], s31 offen offset:2048 sc1
  s_mov_b64 exec, -1
  s_add_u32 s34, s34, 1
  s_cmp_gt_u32 s34, 131072
  s_cbranch_scc1 L_abort
  s_waitcnt vmcnt(0)
  v_mfma_f32_16x16x32_bf16 v[168:171], v[128:131], v[32:35], 0
  v_mfma_f32_16x16x32_bf16 v[168:171], v[132:135], v[36:39], v[168:171]
  v_mfma_f32_16x16x32_bf16 v[168:171], v[136:139], v[40:43], v[168:171]
  v_mfma_f32_16x16x32_bf16 v[168:171], v[140:143], v[44:47], v[168:171]
  v_bitop3_b32 v20, v128, v130, v132 bitop3:0x80
  v_bitop3_b32 v20, v20, v134, v136 bitop3:0x80
  v_bitop3_b32 v20, v20, v138, v140 bitop3:0x80
  v_bitop3_b32 v20, v20, v142, v144 bitop3:0x80
  v_bitop3_b32 v20, v20, v148, v152 bitop3:0x80
  v_bitop3_b32 v20, v20, v156, v156 bitop3:0x80
  v_and_b32 v20, 1, v20
  v_cmp_ne_u32 vcc, 1, v20
  s_cbranch_vccnz L_at_kv
  v_max3_f32 v20, v22, v168, v169
  v_mov_b32 v21, v20
  s_nop 1
  v_permlane16_swap_b32 v20, v21
  v_max_f32 v20, v20, v21
  v_mov_b32 v21, v20
  s_nop 1
  v_permlane32_swap_b32 v20, v21
  v_max_f32 v20, v20, v21
  v_mul_f32 v20, s65, v20
  v_fma_f32 v160, v160, s65, -v20
  v_fma_f32 v161, v161, s65, -v20
  v_fma_f32 v162, v162, s65, -v20
  v_fma_f32 v163, v163, s65, -v20
  v_fma_f32 v164, v164, s65, -v20
  v_fma_f32 v165, v165, s65, -v20
  v_fma_f32 v166, v166, s65, -v20
  v_fma_f32 v167, v167, s65, -v20
  v_fma_f32 v168, v168, s65, -v20
  v_fma_f32 v169, v169, s65, -v20
  v_exp_f32 v160, v160
  v_exp_f32 v161, v161
  v_exp_f32 v162, v162
  v_exp_f32 v163, v163
  v_exp_f32 v164, v164
  v_exp_f32 v165, v165
  v_exp_f32 v166, v166
  v_exp_f32 v167, v167
  v_exp_f32 v168, v168
  v_exp_f32 v169, v169
  v_cvt_pk_bf16_f32 v172, v160, v161
  v_cvt_pk_bf16_f32 v173, v162, v163
  v_cvt_pk_bf16_f32 v174, v164, v165
  v_cvt_pk_bf16_f32 v175, v166, v167
  v_cvt_pk_bf16_f32 v176, v168, v169
  v_cvt_pk_bf16_f32 v177, v168, v169
  v_mfma_f32_16x16x32_bf16 v[212:215], v[216:219], v[172:175], 0
  v_mfma_f32_16x16x32_bf16 v[180:183], v[96:99], v[172:175], 0
  v_mfma_f32_16x16x32_bf16 v[184:187], v[100:103], v[172:175], 0
  v_mfma_f32_16x16x16_bf16 v[212:215], v[220:221], v[176:177], v[212:215]
  v_mfma_f32_16x16x16_bf16 v[180:183], v[144:145], v[176:177], v[180:183]
  v_mfma_f32_16x16x16_bf16 v[184:187], v[146:147], v[176:177], v[184:187]
  v_mfma_f32_16x16x32_bf16 v[188:191], v[104:107], v[172:175], 0
  v_mfma_f32_16x16x32_bf16 v[192:195], v[108:111], v[172:175], 0
  v_rcp_f32 v212, v212
  v_mfma_f32_16x16x16_bf16 v[188:191], v[148:149], v[176:177], v[188:191]
  v_mfma_f32_16x16x16_bf16 v[192:195], v[150:151], v[176:177], v[192:195]
  v_mfma_f32_16x16x32_bf16 v[196:199], v[112:115], v[172:175], 0
  v_mfma_f32_16x16x32_bf16 v[200:203], v[116:119], v[172:175], 0
  v_mul_f32 v180, v180, v212
  v_mul_f32 v181, v181, v212
  v_mul_f32 v182, v182, v212
  v_mul_f32 v183, v183, v212
  v_mul_f32 v184, v184, v212
  v_mul_f32 v185, v185, v212
  v_mul_f32 v186, v186, v212
  v_mul_f32 v187, v187, v212
  v_cvt_pk_bf16_f32 v224, v180, v184
  v_cvt_pk_bf16_f32 v225, v181, v185
  v_cvt_pk_bf16_f32 v226, v182, v186
  v_cvt_pk_bf16_f32 v227, v183, v187
  v_or_b32 v224, 1, v224
  buffer_store_dwordx4 v[224:227], v4, s[8:11], s67 offen offset:0 sc1
  v_mfma_f32_16x16x16_bf16 v[196:199], v[152:153], v[176:177], v[196:199]
  v_mfma_f32_16x16x16_bf16 v[200:203], v[154:155], v[176:177], v[200:203]
  v_mfma_f32_16x16x32_bf16 v[204:207], v[120:123], v[172:175], 0
  v_mfma_f32_16x16x32_bf16 v[208:211], v[124:127], v[172:175], 0
  v_mul_f32 v188, v188, v212
  v_mul_f32 v189, v189, v212
  v_mul_f32 v190, v190, v212
  v_mul_f32 v191, v191, v212
  v_mul_f32 v192, v192, v212
  v_mul_f32 v193, v193, v212
  v_mul_f32 v194, v194, v212
  v_mul_f32 v195, v195, v212
  v_cvt_pk_bf16_f32 v228, v188, v192
  v_cvt_pk_bf16_f32 v229, v189, v193
  v_cvt_pk_bf16_f32 v230, v190, v194
  v_cvt_pk_bf16_f32 v231, v191, v195
  v_or_b32 v228, 1, v228
  buffer_store_dwordx4 v[228:231], v4, s[8:11], s67 offen offset:2048 sc1
  v_mfma_f32_16x16x16_bf16 v[204:207], v[156:157], v[176:177], v[204:207]
  v_mfma_f32_16x16x16_bf16 v[208:211], v[158:159], v[176:177], v[208:211]
  v_mul_f32 v196, v196, v212
  v_mul_f32 v197, v197, v212
  v_mul_f32 v198, v198, v212
  v_mul_f32 v199, v199, v212
  v_mul_f32 v200, v200, v212
  v_mul_f32 v201, v201, v212
  v_mul_f32 v202, v202, v212
  v_mul_f32 v203, v203, v212
  v_cvt_pk_bf16_f32 v232, v196, v200
  v_cvt_pk_bf16_f32 v233, v197, v201
  v_cvt_pk_bf16_f32 v234, v198, v202
  v_cvt_pk_bf16_f32 v235, v199, v203
  v_or_b32 v232, 1, v232
  buffer_store_dwordx4 v[232:235], v4, s[8:11], s64 offen offset:0 sc1
  v_mul_f32 v204, v204, v212
  v_mul_f32 v205, v205, v212
  v_mul_f32 v206, v206, v212
  v_mul_f32 v207, v207, v212
  v_mul_f32 v208, v208, v212
  v_mul_f32 v209, v209, v212
  v_mul_f32 v210, v210, v212
  v_mul_f32 v211, v211, v212
  v_cvt_pk_bf16_f32 v236, v204, v208
  v_cvt_pk_bf16_f32 v237, v205, v209
  v_cvt_pk_bf16_f32 v238, v206, v210
  v_cvt_pk_bf16_f32 v239, v207, v211
  v_or_b32 v236, 1, v236
  buffer_store_dwordx4 v[236:239], v4, s[8:11], s64 offen offset:2048 sc1
  s_add_u32 s60, s60, 392
  s_cmp_lt_u32 s60, 4096
  s_cbranch_scc1 L_at_loop
  s_waitcnt vmcnt(0)
  s_waitcnt vmcnt(0)
  s_endpgm
L_exit:
  s_endpgm
L_code_end:
.section .rodata,"a"
.p2align 6
.amdhsa_kernel gated_mix__memory_aug_recurrent_mem_tr__glu_gated_bilinear__prompt_kernel
  .amdhsa_next_free_vgpr 512
  .amdhsa_next_free_sgpr 102
  .amdhsa_accum_offset 256
  .amdhsa_group_segment_fixed_size 0
  .amdhsa_kernarg_size 120
  .amdhsa_user_sgpr_count 2
  .amdhsa_user_sgpr_kernarg_segment_ptr 1
  .amdhsa_system_sgpr_workgroup_id_x 1
  .amdhsa_float_denorm_mode_32 3
.end_amdhsa_kernel
```
